```python
import torch

def _softmax(x, axis=-1):
    return torch.softmax(x, dim=axis)
def _gelu(x):
    return torch.nn.functional.gelu(x, approximate="tanh")
def _silu(x):
    return torch.nn.functional.silu(x)
def _sigmoid(x):
    return torch.sigmoid(x)
def _layernorm(x, axis=-1, eps=1e-5):
    m = x.mean(dim=axis, keepdim=True)
    v = x.var(dim=axis, keepdim=True, unbiased=False)
    return (x - m) / torch.sqrt(v + eps)
def _scatter_add(tgt, idx, src, axis=0):
    return tgt.clone().index_add_(axis, idx, src)
def _segment_sum(src, seg, n):
    out = torch.zeros((n,) + src.shape[1:], dtype=src.dtype)
    return out.index_add_(0, seg, src)
def _pad(x, pw):
    flat = tuple(v for pair in reversed(pw) for v in pair)
    return torch.nn.functional.pad(x, flat)

kernel_name = 'parallel_sum__ssm_conv_h3__glu_gated_geglu__prompt'

def setup_inputs():

    _w = (lambda a: (lambda t: t.to(torch.bfloat16) if t.is_floating_point() else t)(torch.as_tensor(a)))
    def _A_setup():
        B, S, D = 1, 2048, 576
        ks = 4
        return {
            "q": _w((lambda *s: torch.randn(*s, dtype=torch.bfloat16) * 0.05)(B, S, D)),
            "k": _w((lambda *s: torch.randn(*s, dtype=torch.bfloat16) * 0.2)(B, S, D)),
            "v": _w((lambda *s: torch.randn(*s, dtype=torch.bfloat16) * 0.2)(B, S, D)),
            "shift_k": _w((lambda *s: torch.randn(*s, dtype=torch.bfloat16) * 0.2)(D, ks) * 0.5),
            "ssm_k": _w((lambda *s: torch.randn(*s, dtype=torch.bfloat16) * 0.4)(D, S) * (1.0 / S ** 0.5)),
            "ssm_D": _w((lambda *s: torch.randn(*s, dtype=torch.bfloat16) * 0.2)(D)),
        }
    _A_in = _A_setup()

    def _B_setup():
        B, S, Dm, Df = 1, 2048, 576, 4608
        return {
            "x": _w((lambda *s: torch.randn(*s, dtype=torch.bfloat16) * 0.05)(B, S, Dm)),
            "w_gate": _w((lambda *s: torch.randn(*s, dtype=torch.bfloat16) * 0.4)(Dm, Df) * (Dm ** -0.5)),
            "w_up": _w((lambda *s: torch.randn(*s, dtype=torch.bfloat16) * 0.4)(Dm, Df) * (Dm ** -0.5)),
            "w_down": _w((lambda *s: torch.randn(*s, dtype=torch.bfloat16) * 0.4)(Df, Dm) * (Df ** -0.5)),
        }
    _B_in = _B_setup()

    return {
        "A_q": _A_in["q"],
        "A_k": _A_in["k"],
        "A_v": _A_in["v"],
        "A_shift_k": _A_in["shift_k"],
        "A_ssm_k": _A_in["ssm_k"],
        "A_ssm_D": _A_in["ssm_D"],
        "B_x": _B_in["x"],
        "B_w_gate": _B_in["w_gate"],
        "B_w_up": _B_in["w_up"],
        "B_w_down": _B_in["w_down"],
    }

def reference(A_q, A_k, A_v, A_shift_k, A_ssm_k, A_ssm_D, B_x, B_w_gate, B_w_up, B_w_down):
    def _A_ref(q, k, v, shift_k, ssm_k, ssm_D):
        B, S, D = q.shape
        ks = shift_k.shape[-1]
        k_pad = _pad(k, ((0, 0), (ks - 1, 0), (0, 0)))
        k_shift = torch.zeros_like(k)
        for t in range(ks):
            k_shift = k_shift + k_pad[:, t:t + S, :] * shift_k[:, ks - 1 - t][None, None, :]
        kv = k_shift * v
        L = 2 * S
        kv_pad = _pad(kv, ((0, 0), (0, S), (0, 0)))
        kf_pad = _pad(ssm_k, ((0, 0), (0, S)))
        kv_f = (lambda x, axes=(-2,-1): torch.fft.rfft2(x.float(), dim=axes))(kv_pad[:, None, :, :], axes=(1, 2))
        kf_f = (lambda x, axes=(-2,-1): torch.fft.rfft2(x.float(), dim=axes))(kf_pad[:, None, :], axes=(1, 2))
        kf_f = (lambda x, *d: x.permute(*d))(kf_f, 1, 2, 0)
        y_f = kv_f * kf_f[None, :, :, :]
        y = (lambda x, s, axes=(-2,-1): torch.fft.irfft2(x, s=s, dim=axes).to(torch.bfloat16))(y_f, (1, L), axes=(1, 2))[:, 0, :S, :]
        y = y + kv * ssm_D[None, None, :]
        return q * y

    def _B_ref(x, w_gate, w_up, w_down):
        g = torch.einsum("bsd,df->bsf", x, w_gate)
        u = torch.einsum("bsd,df->bsf", x, w_up)
        h = _gelu(g) * u
        return torch.einsum("bsf,fd->bsd", h, w_down)

    x = A_q
    xn = _layernorm(x, axis=-1)
    return x + _A_ref(xn, A_k, A_v, A_shift_k, A_ssm_k, A_ssm_D) + _B_ref(xn, B_w_gate, B_w_up, B_w_down)
```

```asm
; @launch grid=(256,1,1) block=(512,1,1) lds=163840
.amdgcn_target "amdgcn-amd-amdhsa--gfx950"
.text
.globl parallel_sum__ssm_conv_h3__glu_gated_geglu__prompt_kernel
.p2align 8
.type parallel_sum__ssm_conv_h3__glu_gated_geglu__prompt_kernel,@function
parallel_sum__ssm_conv_h3__glu_gated_geglu__prompt_kernel:
  s_cmp_ge_u32 s2, 256
  s_cbranch_scc1 L_end
  s_load_dwordx16 s[60:75], s[0:1], 0
  s_load_dwordx8 s[76:83], s[0:1], 64
  s_load_dwordx2 s[84:85], s[0:1], 96
  v_lshrrev_b32 v40, 6, v0
  v_and_b32 v1, 63, v0
  v_readfirstlane_b32 s44, v40
  v_and_b32 v2, 15, v1
  v_lshrrev_b32 v3, 4, v1
  v_mov_b32 v20, 0x80000000
  s_and_b32 s46, s2, 3
  s_lshl_b32 s46, s46, 2
  s_bfe_u32 s53, s2, 0x20003
  s_add_u32 s46, s46, s53
  s_bfe_u32 s45, s2, 0x10002
  s_lshl_b32 s45, s45, 3
  s_lshr_b32 s53, s2, 5
  s_add_u32 s45, s45, s53
  s_lshr_b32 s50, s44, 2
  s_and_b32 s51, s44, 3
  s_lshl_b32 s47, s44, 10
  s_cmp_lg_u32 s44, 7
  s_cbranch_scc1 L_cpf0
  s_getpc_b64 s[4:5]
L_pc_1:
  s_lshr_b32 s53, s2, 3
  s_mul_i32 s53, s53, 2560
  v_lshlrev_b32 v40, 7, v1
  v_add_u32 v40, s53, v40
  v_min_u32 v40, L_end-L_pc_1-4, v40
  v_and_b32 v40, 0xfffffffc, v40
  v_mov_b32 v41, s5
  v_add_co_u32 v40, vcc, s4, v40
  s_nop 1
  v_addc_co_u32 v41, vcc, 0, v41, vcc
  s_mov_b64 exec, 1048575
  global_load_dword v15, v[40:41], off
  s_mov_b64 exec, -1
L_cpf0:
  s_lshl_b32 s53, s45, 7
  s_lshl_b32 s54, s46, 3
  s_add_u32 s53, s53, s54
  s_add_u32 s53, s53, s44
  s_mul_i32 s56, s53, 1152
  v_lshlrev_b32 v52, 4, v1
  v_add_u32 v53, 1024, v52
  v_cmp_gt_u32 vcc, 8, v1
  s_nop 1
  v_cndmask_b32 v53, v20, v53, vcc
  s_and_b32 s53, s45, 7
  s_lshl_b32 s54, s53, 2
  s_add_u32 s54, s54, s51
  s_mul_i32 s54, s54, 9216
  s_mul_i32 s55, s46, 576
  s_and_b32 s5, s55, 0xffffff80
  s_add_u32 s54, s54, s5
  v_lshlrev_b32 v40, 7, v1
  v_add_u32 v40, s54, v40
  v_cmp_gt_u32 vcc, 5, v1
  s_nop 1
  v_cndmask_b32 v13, v20, v40, vcc
  s_waitcnt lgkmcnt(0)
  s_mov_b32 s36, s60
  s_and_b32 s37, s61, 0xffff
  s_mov_b32 s38, 2359296
  s_mov_b32 s39, 0x20000
  buffer_load_dwordx4 v[24:27], v52, s[36:39], s56 offen
  buffer_load_dwordx4 v[28:31], v53, s[36:39], s56 offen
  s_mov_b32 s40, s82
  s_and_b32 s41, s83, 0xffff
  s_mov_b32 s42, 256
  s_mov_b32 s43, 0x20000
  s_memrealtime s[72:73]
  s_mov_b32 s12, s74
  s_and_b32 s13, s75, 0xffff
  s_mov_b32 s14, 5308416
  s_mov_b32 s15, 0x20000
  s_mov_b32 s16, s76
  s_and_b32 s17, s77, 0xffff
  s_mov_b32 s18, 5308416
  s_mov_b32 s19, 0x20000
  s_cmp_lt_u32 s44, 4
  s_cselect_b32 s28, s12, s16
  s_cselect_b32 s29, s13, s17
  s_cselect_b32 s30, s14, s18
  s_cselect_b32 s31, s15, s19
  s_waitcnt lgkmcnt(0)
  s_or_b32 s72, s72, 1
  s_cmp_eq_u32 s2, 0
  s_cselect_b32 s73, 0, 0x80000000
  v_mov_b32 v40, s72
  v_mov_b32 v41, s73
  v_cmp_eq_u32 vcc, 0, v0
  s_nop 1
  v_cndmask_b32 v41, v20, v41, vcc
  buffer_store_dword v40, v41, s[40:43], 0 offen sc1
  s_mov_b32 s3, 0
  buffer_load_dword v15, v13, s[28:31], s3 offen
  s_mov_b32 s3, 294912
  buffer_load_dword v15, v13, s[28:31], s3 offen
  s_mov_b32 s3, 589824
  buffer_load_dword v15, v13, s[28:31], s3 offen
  s_cmp_lt_u32 s51, 2
  s_cselect_b32 s28, s12, s16
  s_cselect_b32 s29, s13, s17
  s_cselect_b32 s30, s14, s18
  s_cselect_b32 s31, s15, s19
  s_mov_b32 s24, s84
  s_and_b32 s25, s85, 0xffff
  s_mov_b32 s26, 268435456
  s_mov_b32 s27, 0x20000
  s_add_u32 s8, s84, 244645888
  s_addc_u32 s9, s85, 0
  s_and_b32 s9, s9, 0xffff
  s_mov_b32 s10, 2359296
  s_mov_b32 s11, 0x20000
  s_lshl_b32 s53, s45, 7
  s_lshl_b32 s54, s51, 4
  s_add_u32 s53, s53, s54
  v_lshrrev_b32 v40, 2, v1
  v_add_u32 v40, s53, v40
  v_mul_u32_u24 v40, 1152, v40
  v_bfe_u32 v41, v1, 4, 1
  v_mul_u32_u24 v41, 3, v41
  v_and_b32 v42, 3, v1
  v_xor_b32 v41, v41, v42
  v_lshlrev_b32 v41, 4, v41
  v_add_u32 v12, v40, v41
  s_mul_i32 s55, s46, 576
  s_lshl_b32 s53, s51, 6
  v_add_u32 v41, s53, v1
  v_mul_u32_u24 v42, 1821, v41
  v_lshrrev_b32 v42, 16, v42
  v_mul_u32_u24 v43, 36, v42
  v_sub_u32 v43, v41, v43
  v_lshrrev_b32 v44, 2, v42
  v_and_b32 v44, 2, v44
  v_xor_b32 v43, v43, v44
  v_lshlrev_b32 v43, 4, v43
  v_mul_u32_u24 v42, 9216, v42
  v_add_u32 v42, v42, v43
  v_add_u32 v9, s55, v42
  v_add_u32 v41, 256, v41
  v_mul_u32_u24 v42, 1821, v41
  v_lshrrev_b32 v42, 16, v42
  v_mul_u32_u24 v43, 36, v42
  v_sub_u32 v43, v41, v43
  v_lshrrev_b32 v44, 2, v42
  v_and_b32 v44, 2, v44
  v_xor_b32 v43, v43, v44
  v_lshlrev_b32 v43, 4, v43
  v_mul_u32_u24 v42, 9216, v42
  v_add_u32 v42, v42, v43
  v_add_u32 v10, s55, v42
  v_add_u32 v41, 256, v41
  v_mul_u32_u24 v42, 1821, v41
  v_lshrrev_b32 v42, 16, v42
  v_mul_u32_u24 v43, 36, v42
  v_sub_u32 v43, v41, v43
  v_lshrrev_b32 v44, 2, v42
  v_and_b32 v44, 2, v44
  v_xor_b32 v43, v43, v44
  v_lshlrev_b32 v43, 4, v43
  v_mul_u32_u24 v42, 9216, v42
  v_add_u32 v42, v42, v43
  v_add_u32 v32, s55, v42
  v_add_u32 v41, 256, v41
  v_mul_u32_u24 v42, 1821, v41
  v_lshrrev_b32 v42, 16, v42
  v_mul_u32_u24 v43, 36, v42
  v_sub_u32 v43, v41, v43
  v_lshrrev_b32 v44, 2, v42
  v_and_b32 v44, 2, v44
  v_xor_b32 v43, v43, v44
  v_lshlrev_b32 v43, 4, v43
  v_mul_u32_u24 v42, 9216, v42
  v_add_u32 v42, v42, v43
  v_add_u32 v33, s55, v42
  v_add_u32 v41, 256, v41
  s_and_b32 s53, s51, 1
  s_add_u32 s53, s53, 16
  s_lshl_b32 s53, s53, 6
  v_add_u32 v41, s53, v1
  v_mul_u32_u24 v42, 1821, v41
  v_lshrrev_b32 v42, 16, v42
  v_mul_u32_u24 v43, 36, v42
  v_sub_u32 v43, v41, v43
  v_lshrrev_b32 v44, 2, v42
  v_and_b32 v44, 2, v44
  v_xor_b32 v43, v43, v44
  v_lshlrev_b32 v43, 4, v43
  v_mul_u32_u24 v42, 9216, v42
  v_add_u32 v42, v42, v43
  v_add_u32 v11, s55, v42
  s_lshl_b32 s48, s53, 4
  s_lshr_b32 s54, s51, 1
  s_mul_i32 s54, s54, 18432
  s_add_u32 s48, s48, s54
  s_and_b32 s54, s46, 3
  s_lshl_b32 s54, s54, 5
  s_lshl_b32 s5, s51, 3
  s_add_u32 s54, s54, s5
  s_lshl_b32 s5, s45, 7
  s_add_u32 s54, s54, s5
  v_add_u32 v40, s54, v1
  v_mul_u32_u24 v40, 1152, v40
  v_cmp_gt_u32 vcc, 8, v1
  s_nop 1
  v_cndmask_b32 v21, v20, v40, vcc
  v_mov_b32 v23, 0
  buffer_load_dword v23, v23, s[40:43], 0 offen sc1
  v_mov_b32 v40, 0x3f803f80
  v_mov_b32 v41, 0
  v_mov_b32 v42, 0
  s_waitcnt vmcnt(6)
  v_dot2_f32_bf16 v41, v24, v40, v41
  v_dot2_f32_bf16 v42, v24, v24, v42
  v_dot2_f32_bf16 v41, v25, v40, v41
  v_dot2_f32_bf16 v42, v25, v25, v42
  v_dot2_f32_bf16 v41, v26, v40, v41
  v_dot2_f32_bf16 v42, v26, v26, v42
  v_dot2_f32_bf16 v41, v27, v40, v41
  v_dot2_f32_bf16 v42, v27, v27, v42
  s_waitcnt vmcnt(5)
  v_dot2_f32_bf16 v41, v28, v40, v41
  v_dot2_f32_bf16 v42, v28, v28, v42
  v_dot2_f32_bf16 v41, v29, v40, v41
  v_dot2_f32_bf16 v42, v29, v29, v42
  v_dot2_f32_bf16 v41, v30, v40, v41
  v_dot2_f32_bf16 v42, v30, v30, v42
  v_dot2_f32_bf16 v41, v31, v40, v41
  v_dot2_f32_bf16 v42, v31, v31, v42
  s_nop 1
  v_add_f32_dpp v41, v41, v41 quad_perm:[1,0,3,2] row_mask:0xf bank_mask:0xf
  s_nop 1
  v_add_f32_dpp v41, v41, v41 quad_perm:[2,3,0,1] row_mask:0xf bank_mask:0xf
  s_nop 1
  v_add_f32_dpp v41, v41, v41 row_half_mirror row_mask:0xf bank_mask:0xf
  s_nop 1
  v_add_f32_dpp v41, v41, v41 row_mirror row_mask:0xf bank_mask:0xf
  v_mov_b32 v43, v41
  s_nop 1
  v_permlane16_swap_b32 v41, v43
  v_add_f32 v41, v41, v43
  v_mov_b32 v43, v41
  s_nop 1
  v_permlane32_swap_b32 v41, v43
  v_add_f32 v41, v41, v43
  v_add_f32_dpp v42, v42, v42 quad_perm:[1,0,3,2] row_mask:0xf bank_mask:0xf
  s_nop 1
  v_add_f32_dpp v42, v42, v42 quad_perm:[2,3,0,1] row_mask:0xf bank_mask:0xf
  s_nop 1
  v_add_f32_dpp v42, v42, v42 row_half_mirror row_mask:0xf bank_mask:0xf
  s_nop 1
  v_add_f32_dpp v42, v42, v42 row_mirror row_mask:0xf bank_mask:0xf
  v_mov_b32 v43, v42
  s_nop 1
  v_permlane16_swap_b32 v42, v43
  v_add_f32 v42, v42, v43
  v_mov_b32 v43, v42
  s_nop 1
  v_permlane32_swap_b32 v42, v43
  v_add_f32 v42, v42, v43
  v_mul_f32 v41, 0x3ae38e39, v41
  v_mul_f32 v42, 0x3ae38e39, v42
  v_fma_f32 v42, -v41, v41, v42
  v_max_f32 v42, 0, v42
  v_cvt_pk_bf16_f32 v43, v41, v42
  v_lshlrev_b32 v41, 16, v43
  v_and_b32 v42, 0xffff0000, v43
  v_add_f32 v42, 0x3727c5ac, v42
  v_cvt_pk_bf16_f32 v42, v42, v42
  v_lshlrev_b32 v42, 16, v42
  v_sqrt_f32 v42, v42
  s_nop 0
  v_cvt_pk_bf16_f32 v42, v42, v42
  v_lshlrev_b32 v42, 16, v42
  v_rcp_f32 v43, v42
  v_lshlrev_b32 v44, 16, v24
  v_and_b32 v45, 0xffff0000, v24
  v_sub_f32 v44, v44, v41
  v_sub_f32 v45, v45, v41
  v_cvt_pk_bf16_f32 v44, v44, v45
  v_and_b32 v45, 0xffff0000, v44
  v_lshlrev_b32 v44, 16, v44
  v_mul_f32 v44, v44, v43
  v_mul_f32 v45, v45, v43
  v_cvt_pk_bf16_f32 v24, v44, v45
  v_lshlrev_b32 v44, 16, v25
  v_and_b32 v45, 0xffff0000, v25
  v_sub_f32 v44, v44, v41
  v_sub_f32 v45, v45, v41
  v_cvt_pk_bf16_f32 v44, v44, v45
  v_and_b32 v45, 0xffff0000, v44
  v_lshlrev_b32 v44, 16, v44
  v_mul_f32 v44, v44, v43
  v_mul_f32 v45, v45, v43
  v_cvt_pk_bf16_f32 v25, v44, v45
  v_lshlrev_b32 v44, 16, v26
  v_and_b32 v45, 0xffff0000, v26
  v_sub_f32 v44, v44, v41
  v_sub_f32 v45, v45, v41
  v_cvt_pk_bf16_f32 v44, v44, v45
  v_and_b32 v45, 0xffff0000, v44
  v_lshlrev_b32 v44, 16, v44
  v_mul_f32 v44, v44, v43
  v_mul_f32 v45, v45, v43
  v_cvt_pk_bf16_f32 v26, v44, v45
  v_lshlrev_b32 v44, 16, v27
  v_and_b32 v45, 0xffff0000, v27
  v_sub_f32 v44, v44, v41
  v_sub_f32 v45, v45, v41
  v_cvt_pk_bf16_f32 v44, v44, v45
  v_and_b32 v45, 0xffff0000, v44
  v_lshlrev_b32 v44, 16, v44
  v_mul_f32 v44, v44, v43
  v_mul_f32 v45, v45, v43
  v_cvt_pk_bf16_f32 v27, v44, v45
  v_lshlrev_b32 v44, 16, v28
  v_and_b32 v45, 0xffff0000, v28
  v_sub_f32 v44, v44, v41
  v_sub_f32 v45, v45, v41
  v_cvt_pk_bf16_f32 v44, v44, v45
  v_and_b32 v45, 0xffff0000, v44
  v_lshlrev_b32 v44, 16, v44
  v_mul_f32 v44, v44, v43
  v_mul_f32 v45, v45, v43
  v_cvt_pk_bf16_f32 v28, v44, v45
  v_lshlrev_b32 v44, 16, v29
  v_and_b32 v45, 0xffff0000, v29
  v_sub_f32 v44, v44, v41
  v_sub_f32 v45, v45, v41
  v_cvt_pk_bf16_f32 v44, v44, v45
  v_and_b32 v45, 0xffff0000, v44
  v_lshlrev_b32 v44, 16, v44
  v_mul_f32 v44, v44, v43
  v_mul_f32 v45, v45, v43
  v_cvt_pk_bf16_f32 v29, v44, v45
  v_lshlrev_b32 v44, 16, v30
  v_and_b32 v45, 0xffff0000, v30
  v_sub_f32 v44, v44, v41
  v_sub_f32 v45, v45, v41
  v_cvt_pk_bf16_f32 v44, v44, v45
  v_and_b32 v45, 0xffff0000, v44
  v_lshlrev_b32 v44, 16, v44
  v_mul_f32 v44, v44, v43
  v_mul_f32 v45, v45, v43
  v_cvt_pk_bf16_f32 v30, v44, v45
  v_lshlrev_b32 v44, 16, v31
  v_and_b32 v45, 0xffff0000, v31
  v_sub_f32 v44, v44, v41
  v_sub_f32 v45, v45, v41
  v_cvt_pk_bf16_f32 v44, v44, v45
  v_and_b32 v45, 0xffff0000, v44
  v_lshlrev_b32 v44, 16, v44
  v_mul_f32 v44, v44, v43
  v_mul_f32 v45, v45, v43
  v_cvt_pk_bf16_f32 v31, v44, v45
  buffer_store_dwordx4 v[24:27], v52, s[8:11], s56 offen sc1
  buffer_store_dwordx4 v[28:31], v53, s[8:11], s56 offen sc1
  s_waitcnt vmcnt(2)
  v_readfirstlane_b32 s57, v23
  s_nop 3
  s_cmp_lg_u32 s57, 0
  s_cbranch_scc1 L_spind_3
  s_mov_b32 s54, 0x20000
L_spin_2:
  s_sleep 4
  v_mov_b32 v23, 0
  buffer_load_dword v23, v23, s[40:43], 0 offen sc1
  s_waitcnt vmcnt(0)
  v_readfirstlane_b32 s57, v23
  s_sub_u32 s54, s54, 1
  s_cmp_eq_u32 s54, 0
  s_cbranch_scc1 L_spind_3
  s_nop 0
  s_cmp_eq_u32 s57, 0
  s_cbranch_scc1 L_spin_2
L_spind_3:
  s_waitcnt vmcnt(0)
  s_barrier
  s_lshl_b32 s54, s45, 4
  s_add_u32 s54, s54, s46
  s_lshl_b32 s54, s54, 2
  s_add_u32 s54, s54, 244531200
  v_cmp_eq_u32 vcc, 0, v0
  s_nop 1
  v_cndmask_b32 v40, v20, v0, vcc
  v_mov_b32 v41, s57
  buffer_store_dword v41, v40, s[24:27], s54 offen sc1
  s_cmp_ge_u32 s44, 4
  s_cbranch_scc1 L_sk_5
  s_add_u32 m0, s47, 0
  s_mov_b32 s49, 0
  buffer_load_dwordx4 v9, s[12:15], s49 offen lds
L_sk_5:
  s_cmp_ge_u32 s44, 4
  s_cbranch_scc1 L_sk_6
  s_add_u32 m0, s47, 4096
  s_mov_b32 s49, 0
  buffer_load_dwordx4 v10, s[12:15], s49 offen lds
L_sk_6:
  s_cmp_ge_u32 s44, 4
  s_cbranch_scc1 L_sk_7
  s_add_u32 m0, s47, 8192
  s_mov_b32 s49, 0
  buffer_load_dwordx4 v32, s[12:15], s49 offen lds
L_sk_7:
  s_cmp_ge_u32 s44, 4
  s_cbranch_scc1 L_sk_8
  s_add_u32 m0, s47, 12288
  s_mov_b32 s49, 0
  buffer_load_dwordx4 v33, s[12:15], s49 offen lds
L_sk_8:
  s_cmp_ge_u32 s44, 4
  s_cbranch_scc1 L_sk_9
  s_add_u32 m0, s47, 18432
  s_mov_b32 s49, 0
  buffer_load_dwordx4 v9, s[16:19], s49 offen lds
L_sk_9:
  s_cmp_ge_u32 s44, 4
  s_cbranch_scc1 L_sk_10
  s_add_u32 m0, s47, 22528
  s_mov_b32 s49, 0
  buffer_load_dwordx4 v10, s[16:19], s49 offen lds
L_sk_10:
  s_cmp_ge_u32 s44, 4
  s_cbranch_scc1 L_sk_11
  s_add_u32 m0, s47, 26624
  s_mov_b32 s49, 0
  buffer_load_dwordx4 v32, s[16:19], s49 offen lds
L_sk_11:
  s_cmp_ge_u32 s44, 4
  s_cbranch_scc1 L_sk_12
  s_add_u32 m0, s47, 30720
  s_mov_b32 s49, 0
  buffer_load_dwordx4 v33, s[16:19], s49 offen lds
L_sk_12:
  s_cmp_ge_u32 s44, 4
  s_cbranch_scc1 L_sk_13
  s_add_u32 m0, s48, 0
  s_mov_b32 s49, 0
  buffer_load_dwordx4 v11, s[28:31], s49 offen lds
L_sk_13:
  s_cmp_ge_u32 s44, 4
  s_cbranch_scc1 L_sk_15
  s_add_u32 m0, s47, 36864
  s_mov_b32 s49, 294912
  buffer_load_dwordx4 v9, s[12:15], s49 offen lds
L_sk_15:
  s_cmp_ge_u32 s44, 4
  s_cbranch_scc1 L_sk_16
  s_add_u32 m0, s47, 40960
  s_mov_b32 s49, 294912
  buffer_load_dwordx4 v10, s[12:15], s49 offen lds
L_sk_16:
  s_cmp_ge_u32 s44, 4
  s_cbranch_scc1 L_sk_17
  s_add_u32 m0, s47, 45056
  s_mov_b32 s49, 294912
  buffer_load_dwordx4 v32, s[12:15], s49 offen lds
L_sk_17:
  s_cmp_ge_u32 s44, 4
  s_cbranch_scc1 L_sk_18
  s_add_u32 m0, s47, 49152
  s_mov_b32 s49, 294912
  buffer_load_dwordx4 v33, s[12:15], s49 offen lds
L_sk_18:
  s_cmp_ge_u32 s44, 4
  s_cbranch_scc1 L_sk_19
  s_add_u32 m0, s47, 55296
  s_mov_b32 s49, 294912
  buffer_load_dwordx4 v9, s[16:19], s49 offen lds
L_sk_19:
  s_cmp_ge_u32 s44, 4
  s_cbranch_scc1 L_sk_20
  s_add_u32 m0, s47, 59392
  s_mov_b32 s49, 294912
  buffer_load_dwordx4 v10, s[16:19], s49 offen lds
L_sk_20:
  s_cmp_ge_u32 s44, 4
  s_cbranch_scc1 L_sk_21
  s_add_u32 m0, s47, 63488
  s_mov_b32 s49, 294912
  buffer_load_dwordx4 v32, s[16:19], s49 offen lds
L_sk_21:
  s_cmp_ge_u32 s44, 4
  s_cbranch_scc1 L_sk_22
  s_add_u32 m0, s47, 67584
  s_mov_b32 s49, 294912
  buffer_load_dwordx4 v33, s[16:19], s49 offen lds
L_sk_22:
  s_cmp_ge_u32 s44, 4
  s_cbranch_scc1 L_sk_23
  s_add_u32 m0, s48, 36864
  s_mov_b32 s49, 294912
  buffer_load_dwordx4 v11, s[28:31], s49 offen lds
L_sk_23:
  s_cmp_ge_u32 s44, 4
  s_cbranch_scc1 L_sk_25
  s_add_u32 m0, s47, 73728
  s_mov_b32 s49, 589824
  buffer_load_dwordx4 v9, s[12:15], s49 offen lds
L_sk_25:
  s_cmp_ge_u32 s44, 4
  s_cbranch_scc1 L_sk_26
  s_add_u32 m0, s47, 77824
  s_mov_b32 s49, 589824
  buffer_load_dwordx4 v10, s[12:15], s49 offen lds
L_sk_26:
  s_cmp_ge_u32 s44, 4
  s_cbranch_scc1 L_sk_27
  s_add_u32 m0, s47, 81920
  s_mov_b32 s49, 589824
  buffer_load_dwordx4 v32, s[12:15], s49 offen lds
L_sk_27:
  s_cmp_ge_u32 s44, 4
  s_cbranch_scc1 L_sk_28
  s_add_u32 m0, s47, 86016
  s_mov_b32 s49, 589824
  buffer_load_dwordx4 v33, s[12:15], s49 offen lds
L_sk_28:
  s_cmp_ge_u32 s44, 4
  s_cbranch_scc1 L_sk_29
  s_add_u32 m0, s47, 92160
  s_mov_b32 s49, 589824
  buffer_load_dwordx4 v9, s[16:19], s49 offen lds
L_sk_29:
  s_cmp_ge_u32 s44, 4
  s_cbranch_scc1 L_sk_30
  s_add_u32 m0, s47, 96256
  s_mov_b32 s49, 589824
  buffer_load_dwordx4 v10, s[16:19], s49 offen lds
L_sk_30:
  s_cmp_ge_u32 s44, 4
  s_cbranch_scc1 L_sk_31
  s_add_u32 m0, s47, 100352
  s_mov_b32 s49, 589824
  buffer_load_dwordx4 v32, s[16:19], s49 offen lds
L_sk_31:
  s_cmp_ge_u32 s44, 4
  s_cbranch_scc1 L_sk_32
  s_add_u32 m0, s47, 104448
  s_mov_b32 s49, 589824
  buffer_load_dwordx4 v33, s[16:19], s49 offen lds
L_sk_32:
  s_cmp_ge_u32 s44, 4
  s_cbranch_scc1 L_sk_33
  s_add_u32 m0, s48, 73728
  s_mov_b32 s49, 589824
  buffer_load_dwordx4 v11, s[28:31], s49 offen lds
L_sk_33:
  s_mov_b32 s20, s78
  s_and_b32 s21, s79, 0xffff
  s_mov_b32 s22, 5308416
  s_mov_b32 s23, 0x20000
  s_mov_b32 s32, s80
  s_and_b32 s33, s81, 0xffff
  s_mov_b32 s34, 2359296
  s_mov_b32 s35, 0x20000
  v_bfe_u32 v40, v1, 2, 2
  v_lshlrev_b32 v41, 3, v3
  v_add_u32 v41, v41, v40
  v_mul_u32_u24 v41, 576, v41
  v_and_b32 v42, 3, v1
  v_lshlrev_b32 v42, 3, v42
  v_add_u32 v41, v41, v42
  v_and_b32 v43, 1, v3
  s_lshl_b32 s53, s51, 2
  v_add_u32 v44, s53, v43
  v_lshlrev_b32 v44, 5, v44
  v_add_u32 v4, v41, v44
  v_xor_b32 v44, 1, v43
  v_add_u32 v44, s53, v44
  v_lshlrev_b32 v44, 5, v44
  v_add_u32 v5, v41, v44
  s_lshr_b32 s53, s51, 1
  s_add_u32 s53, s53, 16
  v_xor_b32 v44, s53, v43
  v_lshlrev_b32 v44, 5, v44
  v_add_u32 v6, v41, v44
  v_bfe_u32 v40, v2, 2, 1
  v_mul_u32_u24 v40, 3, v40
  v_xor_b32 v40, v3, v40
  v_lshlrev_b32 v40, 4, v40
  s_lshl_b32 s53, s50, 6
  v_add_u32 v41, s53, v2
  v_lshlrev_b32 v41, 6, v41
  v_add_u32 v41, v41, v40
  v_add_u32 v41, 110592, v41
  s_and_b32 s72, s51, 1
  s_lshl_b32 s53, s72, 11
  v_add_u32 v7, s53, v41
  v_subrev_u32 v8, s53, v41
  s_lshl_b32 s54, s45, 4
  v_add_u32 v22, s54, v2
  v_lshlrev_b32 v22, 2, v22
  v_add_u32 v22, 16384, v22
  s_mov_b32 s53, 244514816
  buffer_load_dword v21, v22, s[24:27], s53 offen sc1
  s_waitcnt vmcnt(0)
  v_readfirstlane_b32 s53, v21
  v_cmp_ne_u32 vcc, s57, v21
  s_nop 3
  s_cmp_eq_u64 vcc, 0
  s_cbranch_scc1 L_spind_35
  s_mov_b32 s54, 0x20000
  s_mov_b32 s53, 244514816
L_spin_34:
  s_sleep 4
  buffer_load_dword v21, v22, s[24:27], s53 offen sc1
  s_waitcnt vmcnt(0)
  v_cmp_ne_u32 vcc, s57, v21
  s_nop 4
  s_sub_u32 s54, s54, 1
  s_cmp_eq_u32 s54, 0
  s_cbranch_scc1 L_spind_35
  s_cmp_lg_u64 vcc, 0
  s_cbranch_scc1 L_spin_34
L_spind_35:
  s_cmp_ge_u32 s44, 4
  s_cbranch_scc1 L_sk_36
  s_add_u32 m0, s47, 110592
  s_mov_b32 s4, 0
  buffer_load_dwordx4 v12, s[8:11], s4 offen sc1 lds
L_sk_36:
  s_cmp_ge_u32 s44, 4
  s_cbranch_scc1 L_sk_37
  s_add_u32 m0, s47, 114688
  s_mov_b32 s4, 73728
  buffer_load_dwordx4 v12, s[8:11], s4 offen sc1 lds
L_sk_37:
  s_cmp_ge_u32 s44, 4
  s_cbranch_scc1 L_sk_38
  s_add_u32 m0, s47, 118784
  s_mov_b32 s4, 64
  buffer_load_dwordx4 v12, s[8:11], s4 offen sc1 lds
L_sk_38:
  s_cmp_ge_u32 s44, 4
  s_cbranch_scc1 L_sk_39
  s_add_u32 m0, s47, 122880
  s_mov_b32 s4, 73792
  buffer_load_dwordx4 v12, s[8:11], s4 offen sc1 lds
L_sk_39:
  s_cmp_ge_u32 s44, 4
  s_cbranch_scc1 L_sk_40
  s_add_u32 m0, s47, 126976
  s_mov_b32 s4, 128
  buffer_load_dwordx4 v12, s[8:11], s4 offen sc1 lds
L_sk_40:
  s_cmp_ge_u32 s44, 4
  s_cbranch_scc1 L_sk_41
  s_add_u32 m0, s47, 131072
  s_mov_b32 s4, 73856
  buffer_load_dwordx4 v12, s[8:11], s4 offen sc1 lds
L_sk_41:
  s_waitcnt vmcnt(4)
  s_barrier
  ds_read_b128 v[80:83], v7 offset:0
  ds_read_b128 v[84:87], v7 offset:1024
  ds_read_b128 v[88:91], v8 offset:2048
  ds_read_b128 v[92:95], v8 offset:3072
  ds_read_b64_tr_b16 v[56:57], v6 offset:0
  ds_read_b64_tr_b16 v[58:59], v6 offset:2304
  ds_read_b64_tr_b16 v[60:61], v6 offset:18432
  ds_read_b64_tr_b16 v[62:63], v6 offset:20736
  ds_read_b64_tr_b16 v[64:65], v4 offset:0
  ds_read_b64_tr_b16 v[66:67], v4 offset:2304
  s_cmp_ge_u32 s44, 4
  s_cbranch_scc1 L_g1B
  s_waitcnt lgkmcnt(4)
  v_mfma_f32_16x16x32_bf16 v[240:243], v[56:59], v[80:83], 0
  v_mfma_f32_16x16x32_bf16 v[244:247], v[56:59], v[84:87], 0
  ds_read_b64_tr_b16 v[68:69], v4 offset:18432
  ds_read_b64_tr_b16 v[70:71], v4 offset:20736
  s_waitcnt lgkmcnt(4)
  v_mfma_f32_16x16x32_bf16 v[248:251], v[60:63], v[80:83], 0
  v_mfma_f32_16x16x32_bf16 v[252:255], v[60:63], v[84:87], 0
  s_waitcnt lgkmcnt(2)
  v_mfma_f32_16x16x32_bf16 v[112:115], v[64:67], v[80:83], 0
  v_mfma_f32_16x16x32_bf16 v[116:119], v[64:67], v[84:87], 0
  ds_read_b64_tr_b16 v[72:73], v5 offset:0
  ds_read_b64_tr_b16 v[74:75], v5 offset:2304
  v_mfma_f32_16x16x32_bf16 v[120:123], v[64:67], v[88:91], 0
  v_mfma_f32_16x16x32_bf16 v[124:127], v[64:67], v[92:95], 0
  s_waitcnt lgkmcnt(2)
  v_mfma_f32_16x16x32_bf16 v[128:131], v[68:71], v[80:83], 0
  v_mfma_f32_16x16x32_bf16 v[132:135], v[68:71], v[84:87], 0
  ds_read_b64_tr_b16 v[76:77], v5 offset:18432
  ds_read_b64_tr_b16 v[78:79], v5 offset:20736
  v_mfma_f32_16x16x32_bf16 v[136:139], v[68:71], v[88:91], 0
  v_mfma_f32_16x16x32_bf16 v[140:143], v[68:71], v[92:95], 0
  s_waitcnt lgkmcnt(2)
  v_mfma_f32_16x16x32_bf16 v[144:147], v[72:75], v[80:83], 0
  ds_read_b64_tr_b16 v[56:57], v4 offset:64
  ds_read_b64_tr_b16 v[58:59], v4 offset:2368
  v_mfma_f32_16x16x32_bf16 v[148:151], v[72:75], v[84:87], 0
  v_mfma_f32_16x16x32_bf16 v[152:155], v[72:75], v[88:91], 0
  v_mfma_f32_16x16x32_bf16 v[156:159], v[72:75], v[92:95], 0
  ds_read_b64_tr_b16 v[60:61], v4 offset:18496
  ds_read_b64_tr_b16 v[62:63], v4 offset:20800
  s_waitcnt lgkmcnt(4)
  v_mfma_f32_16x16x32_bf16 v[160:163], v[76:79], v[80:83], 0
  v_mfma_f32_16x16x32_bf16 v[164:167], v[76:79], v[84:87], 0
  ds_read_b64_tr_b16 v[64:65], v5 offset:64
  ds_read_b64_tr_b16 v[66:67], v5 offset:2368
  v_mfma_f32_16x16x32_bf16 v[168:171], v[76:79], v[88:91], 0
  v_mfma_f32_16x16x32_bf16 v[172:175], v[76:79], v[92:95], 0
  ds_read_b64_tr_b16 v[68:69], v5 offset:18496
  ds_read_b64_tr_b16 v[70:71], v5 offset:20800
  s_waitcnt lgkmcnt(6)
  v_mfma_f32_16x16x32_bf16 v[176:179], v[56:59], v[80:83], 0
  v_mfma_f32_16x16x32_bf16 v[180:183], v[56:59], v[84:87], 0
  v_mfma_f32_16x16x32_bf16 v[184:187], v[56:59], v[88:91], 0
  v_mfma_f32_16x16x32_bf16 v[188:191], v[56:59], v[92:95], 0
  s_waitcnt lgkmcnt(4)
  v_mfma_f32_16x16x32_bf16 v[192:195], v[60:63], v[80:83], 0
  v_mfma_f32_16x16x32_bf16 v[196:199], v[60:63], v[84:87], 0
  v_mfma_f32_16x16x32_bf16 v[200:203], v[60:63], v[88:91], 0
  v_mfma_f32_16x16x32_bf16 v[204:207], v[60:63], v[92:95], 0
  s_waitcnt lgkmcnt(0)
  s_waitcnt vmcnt(2)
  s_barrier
  v_add_u32 v6, 36864, v6
  v_add_u32 v4, 36864, v4
  v_add_u32 v5, 36864, v5
  v_mfma_f32_16x16x32_bf16 v[208:211], v[64:67], v[80:83], 0
  ds_read_b128 v[96:99], v7 offset:8192
  ds_read_b128 v[100:103], v7 offset:9216
  v_mfma_f32_16x16x32_bf16 v[212:215], v[64:67], v[84:87], 0
  ds_read_b128 v[104:107], v8 offset:10240
  ds_read_b128 v[108:111], v8 offset:11264
  ds_read_b64_tr_b16 v[72:73], v6 offset:0
  ds_read_b64_tr_b16 v[74:75], v6 offset:2304
  s_add_u32 m0, s47, 110592
  s_mov_b32 s4, 192
  buffer_load_dwordx4 v12, s[8:11], s4 offen sc1 lds
  v_mfma_f32_16x16x32_bf16 v[216:219], v[64:67], v[88:91], 0
  v_mfma_f32_16x16x32_bf16 v[220:223], v[64:67], v[92:95], 0
  ds_read_b64_tr_b16 v[76:77], v6 offset:18432
  ds_read_b64_tr_b16 v[78:79], v6 offset:20736
  s_add_u32 m0, s47, 114688
  s_mov_b32 s4, 73920
  buffer_load_dwordx4 v12, s[8:11], s4 offen sc1 lds
  v_mfma_f32_16x16x32_bf16 v[224:227], v[68:71], v[80:83], 0
  v_mfma_f32_16x16x32_bf16 v[228:231], v[68:71], v[84:87], 0
  ds_read_b64_tr_b16 v[56:57], v4 offset:0
  ds_read_b64_tr_b16 v[58:59], v4 offset:2304
  s_add_u32 m0, s47, 0
  s_mov_b32 s49, 884736
  buffer_load_dwordx4 v9, s[12:15], s49 offen lds
  v_mfma_f32_16x16x32_bf16 v[232:235], v[68:71], v[88:91], 0
  v_mfma_f32_16x16x32_bf16 v[236:239], v[68:71], v[92:95], 0
  s_waitcnt lgkmcnt(4)
  v_mfma_f32_16x16x32_bf16 v[240:243], v[72:75], v[96:99], v[240:243]
  s_add_u32 m0, s47, 4096
  s_mov_b32 s49, 884736
  buffer_load_dwordx4 v10, s[12:15], s49 offen lds
  s_and_b32 s53, s45, 7
  v_mfma_f32_16x16x32_bf16 v[244:247], v[72:75], v[100:103], v[244:247]
  ds_read_b64_tr_b16 v[60:61], v4 offset:18432
  ds_read_b64_tr_b16 v[62:63], v4 offset:20736
  s_waitcnt lgkmcnt(4)
  v_mfma_f32_16x16x32_bf16 v[248:251], v[76:79], v[96:99], v[248:251]
  s_add_u32 m0, s47, 8192
  s_mov_b32 s49, 884736
  buffer_load_dwordx4 v32, s[12:15], s49 offen lds
  s_lshl_b32 s54, s53, 2
  v_mfma_f32_16x16x32_bf16 v[252:255], v[76:79], v[100:103], v[252:255]
  s_waitcnt lgkmcnt(2)
  v_mfma_f32_16x16x32_bf16 v[112:115], v[56:59], v[96:99], v[112:115]
  s_add_u32 s54, s54, s51
  v_mfma_f32_16x16x32_bf16 v[116:119], v[56:59], v[100:103], v[116:119]
  ds_read_b64_tr_b16 v[64:65], v5 offset:0
  ds_read_b64_tr_b16 v[66:67], v5 offset:2304
  s_add_u32 m0, s47, 12288
  s_mov_b32 s49, 884736
  buffer_load_dwordx4 v33, s[12:15], s49 offen lds
  v_mfma_f32_16x16x32_bf16 v[120:123], v[56:59], v[104:107], v[120:123]
  s_mul_i32 s54, s54, 9
  v_mfma_f32_16x16x32_bf16 v[124:127], v[56:59], v[108:111], v[124:127]
  s_waitcnt lgkmcnt(2)
  v_mfma_f32_16x16x32_bf16 v[128:131], v[60:63], v[96:99], v[128:131]
  s_add_u32 m0, s47, 18432
  s_mov_b32 s49, 884736
  buffer_load_dwordx4 v9, s[16:19], s49 offen lds
  v_add_u32 v52, s54, v1
  v_mfma_f32_16x16x32_bf16 v[132:135], v[60:63], v[100:103], v[132:135]
  ds_read_b64_tr_b16 v[68:69], v5 offset:18432
  ds_read_b64_tr_b16 v[70:71], v5 offset:20736
  v_mfma_f32_16x16x32_bf16 v[136:139], v[60:63], v[104:107], v[136:139]
  s_mul_i32 s55, s46, 288
  v_mfma_f32_16x16x32_bf16 v[140:143], v[60:63], v[108:111], v[140:143]
  s_add_u32 m0, s47, 22528
  s_mov_b32 s49, 884736
  buffer_load_dwordx4 v10, s[16:19], s49 offen lds
  s_waitcnt lgkmcnt(2)
  v_mfma_f32_16x16x32_bf16 v[144:147], v[64:67], v[96:99], v[144:147]
  ds_read_b64_tr_b16 v[72:73], v4 offset:64
  ds_read_b64_tr_b16 v[74:75], v4 offset:2368
  v_mfma_f32_16x16x32_bf16 v[148:151], v[64:67], v[100:103], v[148:151]
  s_add_u32 m0, s47, 26624
  s_mov_b32 s49, 884736
  buffer_load_dwordx4 v32, s[16:19], s49 offen lds
  v_add_u32 v53, s55, v52
  v_mfma_f32_16x16x32_bf16 v[152:155], v[64:67], v[104:107], v[152:155]
  v_mfma_f32_16x16x32_bf16 v[156:159], v[64:67], v[108:111], v[156:159]
  ds_read_b64_tr_b16 v[76:77], v4 offset:18496
  ds_read_b64_tr_b16 v[78:79], v4 offset:20800
  v_mul_u32_u24 v53, 1152, v53
  s_waitcnt lgkmcnt(4)
  v_mfma_f32_16x16x32_bf16 v[160:163], v[68:71], v[96:99], v[160:163]
  s_add_u32 m0, s47, 30720
  s_mov_b32 s49, 884736
  buffer_load_dwordx4 v33, s[16:19], s49 offen lds
  v_mfma_f32_16x16x32_bf16 v[164:167], v[68:71], v[100:103], v[164:167]
  ds_read_b64_tr_b16 v[56:57], v5 offset:64
  ds_read_b64_tr_b16 v[58:59], v5 offset:2368
  v_cmp_gt_u32 vcc, 9, v1
  v_mfma_f32_16x16x32_bf16 v[168:171], v[68:71], v[104:107], v[168:171]
  v_mfma_f32_16x16x32_bf16 v[172:175], v[68:71], v[108:111], v[172:175]
  ds_read_b64_tr_b16 v[60:61], v5 offset:18496
  ds_read_b64_tr_b16 v[62:63], v5 offset:20800
  s_add_u32 m0, s48, 0
  s_mov_b32 s49, 884736
  buffer_load_dwordx4 v11, s[28:31], s49 offen lds
  v_cndmask_b32 v53, v20, v53, vcc
  s_waitcnt lgkmcnt(6)
  v_mfma_f32_16x16x32_bf16 v[176:179], v[72:75], v[96:99], v[176:179]
  v_mfma_f32_16x16x32_bf16 v[180:183], v[72:75], v[100:103], v[180:183]
  v_cmp_gt_u32 vcc, 288, v52
  v_mfma_f32_16x16x32_bf16 v[184:187], v[72:75], v[104:107], v[184:187]
  v_mfma_f32_16x16x32_bf16 v[188:191], v[72:75], v[108:111], v[188:191]
  v_cndmask_b32 v14, v20, v53, vcc
  s_waitcnt lgkmcnt(4)
  v_mfma_f32_16x16x32_bf16 v[192:195], v[76:79], v[96:99], v[192:195]
  v_mfma_f32_16x16x32_bf16 v[196:199], v[76:79], v[100:103], v[196:199]
  v_mfma_f32_16x16x32_bf16 v[200:203], v[76:79], v[104:107], v[200:203]
  v_mfma_f32_16x16x32_bf16 v[204:207], v[76:79], v[108:111], v[204:207]
  s_waitcnt lgkmcnt(0)
  s_waitcnt vmcnt(11)
  s_barrier
  v_add_u32 v6, 36864, v6
  v_add_u32 v4, 36864, v4
  v_add_u32 v5, 36864, v5
  v_mfma_f32_16x16x32_bf16 v[208:211], v[56:59], v[96:99], v[208:211]
  ds_read_b128 v[80:83], v7 offset:16384
  ds_read_b128 v[84:87], v7 offset:17408
  v_mfma_f32_16x16x32_bf16 v[212:215], v[56:59], v[100:103], v[212:215]
  ds_read_b128 v[88:91], v8 offset:18432
  ds_read_b128 v[92:95], v8 offset:19456
  ds_read_b64_tr_b16 v[64:65], v6 offset:0
  ds_read_b64_tr_b16 v[66:67], v6 offset:2304
  s_add_u32 m0, s47, 118784
  s_mov_b32 s4, 256
  buffer_load_dwordx4 v12, s[8:11], s4 offen sc1 lds
  v_mfma_f32_16x16x32_bf16 v[216:219], v[56:59], v[104:107], v[216:219]
  v_mfma_f32_16x16x32_bf16 v[220:223], v[56:59], v[108:111], v[220:223]
  ds_read_b64_tr_b16 v[68:69], v6 offset:18432
  ds_read_b64_tr_b16 v[70:71], v6 offset:20736
  s_add_u32 m0, s47, 122880
  s_mov_b32 s4, 73984
  buffer_load_dwordx4 v12, s[8:11], s4 offen sc1 lds
  v_mfma_f32_16x16x32_bf16 v[224:227], v[60:63], v[96:99], v[224:227]
  v_mfma_f32_16x16x32_bf16 v[228:231], v[60:63], v[100:103], v[228:231]
  ds_read_b64_tr_b16 v[72:73], v4 offset:0
  ds_read_b64_tr_b16 v[74:75], v4 offset:2304
  s_add_u32 m0, s47, 36864
  s_mov_b32 s49, 1179648
  buffer_load_dwordx4 v9, s[12:15], s49 offen lds
  v_mfma_f32_16x16x32_bf16 v[232:235], v[60:63], v[104:107], v[232:235]
  v_mfma_f32_16x16x32_bf16 v[236:239], v[60:63], v[108:111], v[236:239]
  s_waitcnt lgkmcnt(4)
  v_mfma_f32_16x16x32_bf16 v[240:243], v[64:67], v[80:83], v[240:243]
  s_add_u32 m0, s47, 40960
  s_mov_b32 s49, 1179648
  buffer_load_dwordx4 v10, s[12:15], s49 offen lds
  s_mul_i32 s53, s46, 288
  s_lshl_b32 s54, s44, 3
  v_mfma_f32_16x16x32_bf16 v[244:247], v[64:67], v[84:87], v[244:247]
  ds_read_b64_tr_b16 v[76:77], v4 offset:18432
  ds_read_b64_tr_b16 v[78:79], v4 offset:20736
  s_add_u32 s53, s53, s54
  s_waitcnt lgkmcnt(4)
  v_mfma_f32_16x16x32_bf16 v[248:251], v[68:71], v[80:83], v[248:251]
  s_add_u32 m0, s47, 45056
  s_mov_b32 s49, 1179648
  buffer_load_dwordx4 v32, s[12:15], s49 offen lds
  v_lshrrev_b32 v52, 3, v1
  v_add_u32 v53, s53, v52
  v_mfma_f32_16x16x32_bf16 v[252:255], v[68:71], v[84:87], v[252:255]
  v_mul_u32_u24 v53, 1152, v53
  s_waitcnt lgkmcnt(2)
  v_mfma_f32_16x16x32_bf16 v[112:115], v[72:75], v[80:83], v[112:115]
  v_bfe_u32 v54, v1, 1, 2
  v_bfe_u32 v55, v1, 4, 1
  v_mfma_f32_16x16x32_bf16 v[116:119], v[72:75], v[84:87], v[116:119]
  ds_read_b64_tr_b16 v[56:57], v5 offset:0
  ds_read_b64_tr_b16 v[58:59], v5 offset:2304
  s_add_u32 m0, s47, 49152
  s_mov_b32 s49, 1179648
  buffer_load_dwordx4 v33, s[12:15], s49 offen lds
  s_and_b32 s54, s44, 1
  v_mfma_f32_16x16x32_bf16 v[120:123], v[72:75], v[88:91], v[120:123]
  s_lshl_b32 s54, s54, 1
  v_mfma_f32_16x16x32_bf16 v[124:127], v[72:75], v[92:95], v[124:127]
  v_or_b32 v16, s54, v55
  v_xor_b32 v16, v54, v16
  s_waitcnt lgkmcnt(2)
  v_mfma_f32_16x16x32_bf16 v[128:131], v[76:79], v[80:83], v[128:131]
  s_add_u32 m0, s47, 55296
  s_mov_b32 s49, 1179648
  buffer_load_dwordx4 v9, s[16:19], s49 offen lds
  v_lshlrev_b32 v16, 5, v16
  v_mfma_f32_16x16x32_bf16 v[132:135], v[76:79], v[84:87], v[132:135]
  ds_read_b64_tr_b16 v[60:61], v5 offset:18432
  ds_read_b64_tr_b16 v[62:63], v5 offset:20736
  v_and_b32 v17, 1, v1
  v_lshlrev_b32 v17, 4, v17
  v_mfma_f32_16x16x32_bf16 v[136:139], v[76:79], v[88:91], v[136:139]
  v_add_u32 v16, v16, v17
  v_mfma_f32_16x16x32_bf16 v[140:143], v[76:79], v[92:95], v[140:143]
  s_add_u32 m0, s47, 59392
  s_mov_b32 s49, 1179648
  buffer_load_dwordx4 v10, s[16:19], s49 offen lds
  v_add_u32 v16, v53, v16
  s_lshr_b32 s53, s44, 1
  s_waitcnt lgkmcnt(2)
  v_mfma_f32_16x16x32_bf16 v[144:147], v[56:59], v[80:83], v[144:147]
  ds_read_b64_tr_b16 v[64:65], v4 offset:64
  ds_read_b64_tr_b16 v[66:67], v4 offset:2368
  s_add_u32 s53, s53, 32
  v_mfma_f32_16x16x32_bf16 v[148:151], v[56:59], v[84:87], v[148:151]
  s_add_u32 m0, s47, 63488
  s_mov_b32 s49, 1179648
  buffer_load_dwordx4 v32, s[16:19], s49 offen lds
  s_and_b32 s54, s44, 1
  v_mfma_f32_16x16x32_bf16 v[152:155], v[56:59], v[88:91], v[152:155]
  s_lshl_b32 s52, s53, 10
  s_lshl_b32 s55, s54, 9
  v_mfma_f32_16x16x32_bf16 v[156:159], v[56:59], v[92:95], v[156:159]
  ds_read_b64_tr_b16 v[68:69], v4 offset:18496
  ds_read_b64_tr_b16 v[70:71], v4 offset:20800
  s_add_u32 s52, s52, s55
  s_waitcnt lgkmcnt(4)
  v_mfma_f32_16x16x32_bf16 v[160:163], v[60:63], v[80:83], v[160:163]
  s_add_u32 m0, s47, 67584
  s_mov_b32 s49, 1179648
  buffer_load_dwordx4 v33, s[16:19], s49 offen lds
  s_lshl_b32 s55, s53, 3
  s_lshl_b32 s54, s54, 2
  v_mfma_f32_16x16x32_bf16 v[164:167], v[60:63], v[84:87], v[164:167]
  ds_read_b64_tr_b16 v[72:73], v5 offset:64
  ds_read_b64_tr_b16 v[74:75], v5 offset:2368
  s_add_u32 s55, s55, s54
  v_mfma_f32_16x16x32_bf16 v[168:171], v[60:63], v[88:91], v[168:171]
  s_mul_i32 s54, s46, 288
  s_add_u32 s55, s55, s54
  v_mfma_f32_16x16x32_bf16 v[172:175], v[60:63], v[92:95], v[172:175]
  ds_read_b64_tr_b16 v[76:77], v5 offset:18496
  ds_read_b64_tr_b16 v[78:79], v5 offset:20800
  s_add_u32 m0, s48, 36864
  s_mov_b32 s49, 1179648
  buffer_load_dwordx4 v11, s[28:31], s49 offen lds
  v_add_u32 v53, s55, v52
  s_waitcnt lgkmcnt(6)
  v_mfma_f32_16x16x32_bf16 v[176:179], v[64:67], v[80:83], v[176:179]
  v_mul_u32_u24 v53, 1152, v53
  v_mfma_f32_16x16x32_bf16 v[180:183], v[64:67], v[84:87], v[180:183]
  s_and_b32 s53, s53, 1
  s_lshl_b32 s53, s53, 1
  v_mfma_f32_16x16x32_bf16 v[184:187], v[64:67], v[88:91], v[184:187]
  v_or_b32 v52, s53, v55
  v_mfma_f32_16x16x32_bf16 v[188:191], v[64:67], v[92:95], v[188:191]
  v_xor_b32 v52, v54, v52
  v_lshlrev_b32 v52, 5, v52
  s_waitcnt lgkmcnt(4)
  v_mfma_f32_16x16x32_bf16 v[192:195], v[68:71], v[80:83], v[192:195]
  v_add_u32 v52, v52, v17
  v_mfma_f32_16x16x32_bf16 v[196:199], v[68:71], v[84:87], v[196:199]
  v_add_u32 v17, v53, v52
  v_mfma_f32_16x16x32_bf16 v[200:203], v[68:71], v[88:91], v[200:203]
  v_mfma_f32_16x16x32_bf16 v[204:207], v[68:71], v[92:95], v[204:207]
  s_waitcnt lgkmcnt(0)
  s_waitcnt vmcnt(11)
  s_barrier
  v_subrev_u32 v6, 73728, v6
  v_subrev_u32 v4, 73728, v4
  v_subrev_u32 v5, 73728, v5
  v_mfma_f32_16x16x32_bf16 v[208:211], v[72:75], v[80:83], v[208:211]
  ds_read_b128 v[96:99], v7 offset:0
  ds_read_b128 v[100:103], v7 offset:1024
  v_mfma_f32_16x16x32_bf16 v[212:215], v[72:75], v[84:87], v[212:215]
  ds_read_b128 v[104:107], v8 offset:2048
  ds_read_b128 v[108:111], v8 offset:3072
  ds_read_b64_tr_b16 v[56:57], v6 offset:0
  ds_read_b64_tr_b16 v[58:59], v6 offset:2304
  s_add_u32 m0, s47, 126976
  s_mov_b32 s4, 320
  buffer_load_dwordx4 v12, s[8:11], s4 offen sc1 lds
  v_mfma_f32_16x16x32_bf16 v[216:219], v[72:75], v[88:91], v[216:219]
  v_mfma_f32_16x16x32_bf16 v[220:223], v[72:75], v[92:95], v[220:223]
  ds_read_b64_tr_b16 v[60:61], v6 offset:18432
  ds_read_b64_tr_b16 v[62:63], v6 offset:20736
  s_add_u32 m0, s47, 131072
  s_mov_b32 s4, 74048
  buffer_load_dwordx4 v12, s[8:11], s4 offen sc1 lds
  v_mfma_f32_16x16x32_bf16 v[224:227], v[76:79], v[80:83], v[224:227]
  v_mfma_f32_16x16x32_bf16 v[228:231], v[76:79], v[84:87], v[228:231]
  ds_read_b64_tr_b16 v[64:65], v4 offset:0
  ds_read_b64_tr_b16 v[66:67], v4 offset:2304
  s_add_u32 m0, s47, 73728
  s_mov_b32 s49, 1474560
  buffer_load_dwordx4 v9, s[12:15], s49 offen lds
  v_mfma_f32_16x16x32_bf16 v[232:235], v[76:79], v[88:91], v[232:235]
  v_mfma_f32_16x16x32_bf16 v[236:239], v[76:79], v[92:95], v[236:239]
  s_waitcnt lgkmcnt(4)
  v_mfma_f32_16x16x32_bf16 v[240:243], v[56:59], v[96:99], v[240:243]
  s_add_u32 m0, s47, 77824
  s_mov_b32 s49, 1474560
  buffer_load_dwordx4 v10, s[12:15], s49 offen lds
  v_bfe_u32 v52, v1, 2, 2
  v_lshlrev_b32 v53, 3, v3
  v_mfma_f32_16x16x32_bf16 v[244:247], v[56:59], v[100:103], v[244:247]
  ds_read_b64_tr_b16 v[68:69], v4 offset:18432
  ds_read_b64_tr_b16 v[70:71], v4 offset:20736
  v_add_u32 v53, v53, v52
  s_waitcnt lgkmcnt(4)
  v_mfma_f32_16x16x32_bf16 v[248:251], v[60:63], v[96:99], v[248:251]
  s_add_u32 m0, s47, 81920
  s_mov_b32 s49, 1474560
  buffer_load_dwordx4 v32, s[12:15], s49 offen lds
  v_lshlrev_b32 v53, 7, v53
  v_mfma_f32_16x16x32_bf16 v[252:255], v[60:63], v[100:103], v[252:255]
  v_lshrrev_b32 v54, 1, v52
  v_and_b32 v55, 1, v3
  s_waitcnt lgkmcnt(2)
  v_mfma_f32_16x16x32_bf16 v[112:115], v[64:67], v[96:99], v[112:115]
  v_lshlrev_b32 v55, 1, v55
  v_mfma_f32_16x16x32_bf16 v[116:119], v[64:67], v[100:103], v[116:119]
  ds_read_b64_tr_b16 v[72:73], v5 offset:0
  ds_read_b64_tr_b16 v[74:75], v5 offset:2304
  s_add_u32 m0, s47, 86016
  s_mov_b32 s49, 1474560
  buffer_load_dwordx4 v33, s[12:15], s49 offen lds
  v_or_b32 v54, v54, v55
  v_mfma_f32_16x16x32_bf16 v[120:123], v[64:67], v[104:107], v[120:123]
  v_xor_b32 v54, s51, v54
  v_lshlrev_b32 v54, 5, v54
  v_mfma_f32_16x16x32_bf16 v[124:127], v[64:67], v[108:111], v[124:127]
  v_add_u32 v53, v53, v54
  s_waitcnt lgkmcnt(2)
  v_mfma_f32_16x16x32_bf16 v[128:131], v[68:71], v[96:99], v[128:131]
  s_add_u32 m0, s47, 92160
  s_mov_b32 s49, 1474560
  buffer_load_dwordx4 v9, s[16:19], s49 offen lds
  v_and_b32 v54, 3, v1
  v_mfma_f32_16x16x32_bf16 v[132:135], v[68:71], v[100:103], v[132:135]
  ds_read_b64_tr_b16 v[76:77], v5 offset:18432
  ds_read_b64_tr_b16 v[78:79], v5 offset:20736
  v_lshlrev_b32 v54, 3, v54
  v_add_u32 v18, v53, v54
  v_mfma_f32_16x16x32_bf16 v[136:139], v[68:71], v[104:107], v[136:139]
  v_and_b32 v52, 1, v3
  v_mfma_f32_16x16x32_bf16 v[140:143], v[68:71], v[108:111], v[140:143]
  s_add_u32 m0, s47, 96256
  s_mov_b32 s49, 1474560
  buffer_load_dwordx4 v10, s[16:19], s49 offen lds
  v_lshlrev_b32 v52, 1, v52
  s_waitcnt lgkmcnt(2)
  v_mfma_f32_16x16x32_bf16 v[144:147], v[72:75], v[96:99], v[144:147]
  ds_read_b64_tr_b16 v[56:57], v4 offset:64
  ds_read_b64_tr_b16 v[58:59], v4 offset:2368
  v_lshrrev_b32 v53, 3, v2
  v_mfma_f32_16x16x32_bf16 v[148:151], v[72:75], v[100:103], v[148:151]
  s_add_u32 m0, s47, 100352
  s_mov_b32 s49, 1474560
  buffer_load_dwordx4 v32, s[16:19], s49 offen lds
  v_add_u32 v52, v52, v53
  s_lshl_b32 s53, s50, 3
  v_mfma_f32_16x16x32_bf16 v[152:155], v[72:75], v[104:107], v[152:155]
  v_add_u32 v52, s53, v52
  v_mfma_f32_16x16x32_bf16 v[156:159], v[72:75], v[108:111], v[156:159]
  ds_read_b64_tr_b16 v[60:61], v4 offset:18496
  ds_read_b64_tr_b16 v[62:63], v4 offset:20800
  s_mov_b32 s53, 147456
  s_waitcnt lgkmcnt(4)
  v_mfma_f32_16x16x32_bf16 v[160:163], v[76:79], v[96:99], v[160:163]
  s_add_u32 m0, s47, 104448
  s_mov_b32 s49, 1474560
  buffer_load_dwordx4 v33, s[16:19], s49 offen lds
  v_mul_lo_u32 v52, v52, s53
  v_lshrrev_b32 v53, 1, v3
  v_mfma_f32_16x16x32_bf16 v[164:167], v[76:79], v[100:103], v[164:167]
  ds_read_b64_tr_b16 v[64:65], v5 offset:64
  ds_read_b64_tr_b16 v[66:67], v5 offset:2368
  v_lshlrev_b32 v53, 7, v53
  v_mfma_f32_16x16x32_bf16 v[168:171], v[76:79], v[104:107], v[168:171]
  v_and_b32 v54, 7, v2
  v_mfma_f32_16x16x32_bf16 v[172:175], v[76:79], v[108:111], v[172:175]
  ds_read_b64_tr_b16 v[68:69], v5 offset:18496
  ds_read_b64_tr_b16 v[70:71], v5 offset:20800
  s_add_u32 m0, s48, 73728
  s_mov_b32 s49, 1474560
  buffer_load_dwordx4 v11, s[28:31], s49 offen lds
  v_lshlrev_b32 v54, 4, v54
  v_add_u32 v53, v53, v54
  s_waitcnt lgkmcnt(6)
  v_mfma_f32_16x16x32_bf16 v[176:179], v[56:59], v[96:99], v[176:179]
  s_lshl_b32 s53, s51, 8
  v_mfma_f32_16x16x32_bf16 v[180:183], v[56:59], v[100:103], v[180:183]
  v_add_u32 v53, s53, v53
  v_mfma_f32_16x16x32_bf16 v[184:187], v[56:59], v[104:107], v[184:187]
  v_add_u32 v19, v52, v53
  s_mul_i32 s56, s45, 2359296
  v_mfma_f32_16x16x32_bf16 v[188:191], v[56:59], v[108:111], v[188:191]
  s_lshl_b32 s53, s46, 10
  s_waitcnt lgkmcnt(4)
  v_mfma_f32_16x16x32_bf16 v[192:195], v[60:63], v[96:99], v[192:195]
  s_add_u32 s56, s56, s53
  v_mfma_f32_16x16x32_bf16 v[196:199], v[60:63], v[100:103], v[196:199]
  s_add_u32 s56, s56, 201326592
  v_mfma_f32_16x16x32_bf16 v[200:203], v[60:63], v[104:107], v[200:203]
  v_mfma_f32_16x16x32_bf16 v[204:207], v[60:63], v[108:111], v[204:207]
  s_waitcnt lgkmcnt(0)
  s_waitcnt vmcnt(11)
  s_barrier
  v_add_u32 v6, 36864, v6
  v_add_u32 v4, 36864, v4
  v_add_u32 v5, 36864, v5
  v_mfma_f32_16x16x32_bf16 v[208:211], v[64:67], v[96:99], v[208:211]
  ds_read_b128 v[80:83], v7 offset:8192
  ds_read_b128 v[84:87], v7 offset:9216
  v_mfma_f32_16x16x32_bf16 v[212:215], v[64:67], v[100:103], v[212:215]
  ds_read_b128 v[88:91], v8 offset:10240
  ds_read_b128 v[92:95], v8 offset:11264
  ds_read_b64_tr_b16 v[72:73], v6 offset:0
  ds_read_b64_tr_b16 v[74:75], v6 offset:2304
  s_add_u32 m0, s47, 110592
  s_mov_b32 s4, 384
  buffer_load_dwordx4 v12, s[8:11], s4 offen sc1 lds
  v_mfma_f32_16x16x32_bf16 v[216:219], v[64:67], v[104:107], v[216:219]
  v_mfma_f32_16x16x32_bf16 v[220:223], v[64:67], v[108:111], v[220:223]
  ds_read_b64_tr_b16 v[76:77], v6 offset:18432
  ds_read_b64_tr_b16 v[78:79], v6 offset:20736
  s_add_u32 m0, s47, 114688
  s_mov_b32 s4, 74112
  buffer_load_dwordx4 v12, s[8:11], s4 offen sc1 lds
  v_mfma_f32_16x16x32_bf16 v[224:227], v[68:71], v[96:99], v[224:227]
  v_mfma_f32_16x16x32_bf16 v[228:231], v[68:71], v[100:103], v[228:231]
  ds_read_b64_tr_b16 v[56:57], v4 offset:0
  ds_read_b64_tr_b16 v[58:59], v4 offset:2304
  s_add_u32 m0, s47, 0
  s_mov_b32 s49, 1769472
  buffer_load_dwordx4 v9, s[12:15], s49 offen lds
  v_mfma_f32_16x16x32_bf16 v[232:235], v[68:71], v[104:107], v[232:235]
  v_mfma_f32_16x16x32_bf16 v[236:239], v[68:71], v[108:111], v[236:239]
  s_waitcnt lgkmcnt(4)
  v_mfma_f32_16x16x32_bf16 v[240:243], v[72:75], v[80:83], v[240:243]
  s_add_u32 m0, s47, 4096
  s_mov_b32 s49, 1769472
  buffer_load_dwordx4 v10, s[12:15], s49 offen lds
  v_mfma_f32_16x16x32_bf16 v[244:247], v[72:75], v[84:87], v[244:247]
  ds_read_b64_tr_b16 v[60:61], v4 offset:18432
  ds_read_b64_tr_b16 v[62:63], v4 offset:20736
  s_waitcnt lgkmcnt(4)
  v_mfma_f32_16x16x32_bf16 v[248:251], v[76:79], v[80:83], v[248:251]
  s_add_u32 m0, s47, 8192
  s_mov_b32 s49, 1769472
  buffer_load_dwordx4 v32, s[12:15], s49 offen lds
  v_mfma_f32_16x16x32_bf16 v[252:255], v[76:79], v[84:87], v[252:255]
  s_waitcnt lgkmcnt(2)
  v_mfma_f32_16x16x32_bf16 v[112:115], v[56:59], v[80:83], v[112:115]
  v_mfma_f32_16x16x32_bf16 v[116:119], v[56:59], v[84:87], v[116:119]
  ds_read_b64_tr_b16 v[64:65], v5 offset:0
  ds_read_b64_tr_b16 v[66:67], v5 offset:2304
  s_add_u32 m0, s47, 12288
  s_mov_b32 s49, 1769472
  buffer_load_dwordx4 v33, s[12:15], s49 offen lds
  v_mfma_f32_16x16x32_bf16 v[120:123], v[56:59], v[88:91], v[120:123]
  v_mfma_f32_16x16x32_bf16 v[124:127], v[56:59], v[92:95], v[124:127]
  s_waitcnt lgkmcnt(2)
  v_mfma_f32_16x16x32_bf16 v[128:131], v[60:63], v[80:83], v[128:131]
  s_add_u32 m0, s47, 18432
  s_mov_b32 s49, 1769472
  buffer_load_dwordx4 v9, s[16:19], s49 offen lds
  v_mfma_f32_16x16x32_bf16 v[132:135], v[60:63], v[84:87], v[132:135]
  ds_read_b64_tr_b16 v[68:69], v5 offset:18432
  ds_read_b64_tr_b16 v[70:71], v5 offset:20736
  v_mfma_f32_16x16x32_bf16 v[136:139], v[60:63], v[88:91], v[136:139]
  v_mfma_f32_16x16x32_bf16 v[140:143], v[60:63], v[92:95], v[140:143]
  s_add_u32 m0, s47, 22528
  s_mov_b32 s49, 1769472
  buffer_load_dwordx4 v10, s[16:19], s49 offen lds
  s_waitcnt lgkmcnt(2)
  v_mfma_f32_16x16x32_bf16 v[144:147], v[64:67], v[80:83], v[144:147]
  ds_read_b64_tr_b16 v[72:73], v4 offset:64
  ds_read_b64_tr_b16 v[74:75], v4 offset:2368
  v_mfma_f32_16x16x32_bf16 v[148:151], v[64:67], v[84:87], v[148:151]
  s_add_u32 m0, s47, 26624
  s_mov_b32 s49, 1769472
  buffer_load_dwordx4 v32, s[16:19], s49 offen lds
  v_mfma_f32_16x16x32_bf16 v[152:155], v[64:67], v[88:91], v[152:155]
  v_mfma_f32_16x16x32_bf16 v[156:159], v[64:67], v[92:95], v[156:159]
  ds_read_b64_tr_b16 v[76:77], v4 offset:18496
  ds_read_b64_tr_b16 v[78:79], v4 offset:20800
  s_waitcnt lgkmcnt(4)
  v_mfma_f32_16x16x32_bf16 v[160:163], v[68:71], v[80:83], v[160:163]
  s_add_u32 m0, s47, 30720
  s_mov_b32 s49, 1769472
  buffer_load_dwordx4 v33, s[16:19], s49 offen lds
  v_mfma_f32_16x16x32_bf16 v[164:167], v[68:71], v[84:87], v[164:167]
  ds_read_b64_tr_b16 v[56:57], v5 offset:64
  ds_read_b64_tr_b16 v[58:59], v5 offset:2368
  v_mfma_f32_16x16x32_bf16 v[168:171], v[68:71], v[88:91], v[168:171]
  v_mfma_f32_16x16x32_bf16 v[172:175], v[68:71], v[92:95], v[172:175]
  ds_read_b64_tr_b16 v[60:61], v5 offset:18496
  ds_read_b64_tr_b16 v[62:63], v5 offset:20800
  s_add_u32 m0, s48, 0
  s_mov_b32 s49, 1769472
  buffer_load_dwordx4 v11, s[28:31], s49 offen lds
  s_waitcnt lgkmcnt(6)
  v_mfma_f32_16x16x32_bf16 v[176:179], v[72:75], v[80:83], v[176:179]
  v_mfma_f32_16x16x32_bf16 v[180:183], v[72:75], v[84:87], v[180:183]
  v_mfma_f32_16x16x32_bf16 v[184:187], v[72:75], v[88:91], v[184:187]
  v_mfma_f32_16x16x32_bf16 v[188:191], v[72:75], v[92:95], v[188:191]
  s_waitcnt lgkmcnt(4)
  v_mfma_f32_16x16x32_bf16 v[192:195], v[76:79], v[80:83], v[192:195]
  v_mfma_f32_16x16x32_bf16 v[196:199], v[76:79], v[84:87], v[196:199]
  v_mfma_f32_16x16x32_bf16 v[200:203], v[76:79], v[88:91], v[200:203]
  v_mfma_f32_16x16x32_bf16 v[204:207], v[76:79], v[92:95], v[204:207]
  s_waitcnt lgkmcnt(0)
  s_waitcnt vmcnt(11)
  s_barrier
  v_add_u32 v6, 36864, v6
  v_add_u32 v4, 36864, v4
  v_add_u32 v5, 36864, v5
  v_mfma_f32_16x16x32_bf16 v[208:211], v[56:59], v[80:83], v[208:211]
  ds_read_b128 v[96:99], v7 offset:16384
  ds_read_b128 v[100:103], v7 offset:17408
  v_mfma_f32_16x16x32_bf16 v[212:215], v[56:59], v[84:87], v[212:215]
  ds_read_b128 v[104:107], v8 offset:18432
  ds_read_b128 v[108:111], v8 offset:19456
  ds_read_b64_tr_b16 v[64:65], v6 offset:0
  ds_read_b64_tr_b16 v[66:67], v6 offset:2304
  s_add_u32 m0, s47, 118784
  s_mov_b32 s4, 448
  buffer_load_dwordx4 v12, s[8:11], s4 offen sc1 lds
  v_mfma_f32_16x16x32_bf16 v[216:219], v[56:59], v[88:91], v[216:219]
  v_mfma_f32_16x16x32_bf16 v[220:223], v[56:59], v[92:95], v[220:223]
  ds_read_b64_tr_b16 v[68:69], v6 offset:18432
  ds_read_b64_tr_b16 v[70:71], v6 offset:20736
  s_add_u32 m0, s47, 122880
  s_mov_b32 s4, 74176
  buffer_load_dwordx4 v12, s[8:11], s4 offen sc1 lds
  v_mfma_f32_16x16x32_bf16 v[224:227], v[60:63], v[80:83], v[224:227]
  v_mfma_f32_16x16x32_bf16 v[228:231], v[60:63], v[84:87], v[228:231]
  ds_read_b64_tr_b16 v[72:73], v4 offset:0
  ds_read_b64_tr_b16 v[74:75], v4 offset:2304
  s_add_u32 m0, s47, 36864
  s_mov_b32 s49, 2064384
  buffer_load_dwordx4 v9, s[12:15], s49 offen lds
  v_mfma_f32_16x16x32_bf16 v[232:235], v[60:63], v[88:91], v[232:235]
  v_mfma_f32_16x16x32_bf16 v[236:239], v[60:63], v[92:95], v[236:239]
  s_waitcnt lgkmcnt(4)
  v_mfma_f32_16x16x32_bf16 v[240:243], v[64:67], v[96:99], v[240:243]
  s_add_u32 m0, s47, 40960
  s_mov_b32 s49, 2064384
  buffer_load_dwordx4 v10, s[12:15], s49 offen lds
  v_mfma_f32_16x16x32_bf16 v[244:247], v[64:67], v[100:103], v[244:247]
  ds_read_b64_tr_b16 v[76:77], v4 offset:18432
  ds_read_b64_tr_b16 v[78:79], v4 offset:20736
  s_waitcnt lgkmcnt(4)
  v_mfma_f32_16x16x32_bf16 v[248:251], v[68:71], v[96:99], v[248:251]
  s_add_u32 m0, s47, 45056
  s_mov_b32 s49, 2064384
  buffer_load_dwordx4 v32, s[12:15], s49 offen lds
  v_mfma_f32_16x16x32_bf16 v[252:255], v[68:71], v[100:103], v[252:255]
  s_waitcnt lgkmcnt(2)
  v_mfma_f32_16x16x32_bf16 v[112:115], v[72:75], v[96:99], v[112:115]
  v_mfma_f32_16x16x32_bf16 v[116:119], v[72:75], v[100:103], v[116:119]
  ds_read_b64_tr_b16 v[56:57], v5 offset:0
  ds_read_b64_tr_b16 v[58:59], v5 offset:2304
  s_add_u32 m0, s47, 49152
  s_mov_b32 s49, 2064384
  buffer_load_dwordx4 v33, s[12:15], s49 offen lds
  v_mfma_f32_16x16x32_bf16 v[120:123], v[72:75], v[104:107], v[120:123]
  v_mfma_f32_16x16x32_bf16 v[124:127], v[72:75], v[108:111], v[124:127]
  s_waitcnt lgkmcnt(2)
  v_mfma_f32_16x16x32_bf16 v[128:131], v[76:79], v[96:99], v[128:131]
  s_add_u32 m0, s47, 55296
  s_mov_b32 s49, 2064384
  buffer_load_dwordx4 v9, s[16:19], s49 offen lds
  v_mfma_f32_16x16x32_bf16 v[132:135], v[76:79], v[100:103], v[132:135]
  ds_read_b64_tr_b16 v[60:61], v5 offset:18432
  ds_read_b64_tr_b16 v[62:63], v5 offset:20736
  v_mfma_f32_16x16x32_bf16 v[136:139], v[76:79], v[104:107], v[136:139]
  v_mfma_f32_16x16x32_bf16 v[140:143], v[76:79], v[108:111], v[140:143]
  s_add_u32 m0, s47, 59392
  s_mov_b32 s49, 2064384
  buffer_load_dwordx4 v10, s[16:19], s49 offen lds
  s_waitcnt lgkmcnt(2)
  v_mfma_f32_16x16x32_bf16 v[144:147], v[56:59], v[96:99], v[144:147]
  ds_read_b64_tr_b16 v[64:65], v4 offset:64
  ds_read_b64_tr_b16 v[66:67], v4 offset:2368
  v_mfma_f32_16x16x32_bf16 v[148:151], v[56:59], v[100:103], v[148:151]
  s_add_u32 m0, s47, 63488
  s_mov_b32 s49, 2064384
  buffer_load_dwordx4 v32, s[16:19], s49 offen lds
  v_mfma_f32_16x16x32_bf16 v[152:155], v[56:59], v[104:107], v[152:155]
  v_mfma_f32_16x16x32_bf16 v[156:159], v[56:59], v[108:111], v[156:159]
  ds_read_b64_tr_b16 v[68:69], v4 offset:18496
  ds_read_b64_tr_b16 v[70:71], v4 offset:20800
  s_waitcnt lgkmcnt(4)
  v_mfma_f32_16x16x32_bf16 v[160:163], v[60:63], v[96:99], v[160:163]
  s_add_u32 m0, s47, 67584
  s_mov_b32 s49, 2064384
  buffer_load_dwordx4 v33, s[16:19], s49 offen lds
  v_mfma_f32_16x16x32_bf16 v[164:167], v[60:63], v[100:103], v[164:167]
  ds_read_b64_tr_b16 v[72:73], v5 offset:64
  ds_read_b64_tr_b16 v[74:75], v5 offset:2368
  v_mfma_f32_16x16x32_bf16 v[168:171], v[60:63], v[104:107], v[168:171]
  v_mfma_f32_16x16x32_bf16 v[172:175], v[60:63], v[108:111], v[172:175]
  ds_read_b64_tr_b16 v[76:77], v5 offset:18496
  ds_read_b64_tr_b16 v[78:79], v5 offset:20800
  s_add_u32 m0, s48, 36864
  s_mov_b32 s49, 2064384
  buffer_load_dwordx4 v11, s[28:31], s49 offen lds
  s_waitcnt lgkmcnt(6)
  v_mfma_f32_16x16x32_bf16 v[176:179], v[64:67], v[96:99], v[176:179]
  v_mfma_f32_16x16x32_bf16 v[180:183], v[64:67], v[100:103], v[180:183]
  v_mfma_f32_16x16x32_bf16 v[184:187], v[64:67], v[104:107], v[184:187]
  v_mfma_f32_16x16x32_bf16 v[188:191], v[64:67], v[108:111], v[188:191]
  s_waitcnt lgkmcnt(4)
  v_mfma_f32_16x16x32_bf16 v[192:195], v[68:71], v[96:99], v[192:195]
  v_mfma_f32_16x16x32_bf16 v[196:199], v[68:71], v[100:103], v[196:199]
  v_mfma_f32_16x16x32_bf16 v[200:203], v[68:71], v[104:107], v[200:203]
  v_mfma_f32_16x16x32_bf16 v[204:207], v[68:71], v[108:111], v[204:207]
  s_waitcnt lgkmcnt(0)
  s_waitcnt vmcnt(11)
  s_barrier
  v_subrev_u32 v6, 73728, v6
  v_subrev_u32 v4, 73728, v4
  v_subrev_u32 v5, 73728, v5
  v_mfma_f32_16x16x32_bf16 v[208:211], v[72:75], v[96:99], v[208:211]
  ds_read_b128 v[80:83], v7 offset:0
  ds_read_b128 v[84:87], v7 offset:1024
  v_mfma_f32_16x16x32_bf16 v[212:215], v[72:75], v[100:103], v[212:215]
  ds_read_b128 v[88:91], v8 offset:2048
  ds_read_b128 v[92:95], v8 offset:3072
  ds_read_b64_tr_b16 v[56:57], v6 offset:0
  ds_read_b64_tr_b16 v[58:59], v6 offset:2304
  s_add_u32 m0, s47, 126976
  s_mov_b32 s4, 512
  buffer_load_dwordx4 v12, s[8:11], s4 offen sc1 lds
  v_mfma_f32_16x16x32_bf16 v[216:219], v[72:75], v[104:107], v[216:219]
  v_mfma_f32_16x16x32_bf16 v[220:223], v[72:75], v[108:111], v[220:223]
  ds_read_b64_tr_b16 v[60:61], v6 offset:18432
  ds_read_b64_tr_b16 v[62:63], v6 offset:20736
  s_add_u32 m0, s47, 131072
  s_mov_b32 s4, 74240
  buffer_load_dwordx4 v12, s[8:11], s4 offen sc1 lds
  v_mfma_f32_16x16x32_bf16 v[224:227], v[76:79], v[96:99], v[224:227]
  v_mfma_f32_16x16x32_bf16 v[228:231], v[76:79], v[100:103], v[228:231]
  ds_read_b64_tr_b16 v[64:65], v4 offset:0
  ds_read_b64_tr_b16 v[66:67], v4 offset:2304
  s_add_u32 m0, s47, 73728
  s_mov_b32 s49, 2359296
  buffer_load_dwordx4 v9, s[12:15], s49 offen lds
  v_mfma_f32_16x16x32_bf16 v[232:235], v[76:79], v[104:107], v[232:235]
  v_mfma_f32_16x16x32_bf16 v[236:239], v[76:79], v[108:111], v[236:239]
  s_waitcnt lgkmcnt(4)
  v_mfma_f32_16x16x32_bf16 v[240:243], v[56:59], v[80:83], v[240:243]
  s_add_u32 m0, s47, 77824
  s_mov_b32 s49, 2359296
  buffer_load_dwordx4 v10, s[12:15], s49 offen lds
  v_mfma_f32_16x16x32_bf16 v[244:247], v[56:59], v[84:87], v[244:247]
  ds_read_b64_tr_b16 v[68:69], v4 offset:18432
  ds_read_b64_tr_b16 v[70:71], v4 offset:20736
  s_waitcnt lgkmcnt(4)
  v_mfma_f32_16x16x32_bf16 v[248:251], v[60:63], v[80:83], v[248:251]
  s_add_u32 m0, s47, 81920
  s_mov_b32 s49, 2359296
  buffer_load_dwordx4 v32, s[12:15], s49 offen lds
  v_mfma_f32_16x16x32_bf16 v[252:255], v[60:63], v[84:87], v[252:255]
  s_waitcnt lgkmcnt(2)
  v_mfma_f32_16x16x32_bf16 v[112:115], v[64:67], v[80:83], v[112:115]
  v_mfma_f32_16x16x32_bf16 v[116:119], v[64:67], v[84:87], v[116:119]
  ds_read_b64_tr_b16 v[72:73], v5 offset:0
  ds_read_b64_tr_b16 v[74:75], v5 offset:2304
  s_add_u32 m0, s47, 86016
  s_mov_b32 s49, 2359296
  buffer_load_dwordx4 v33, s[12:15], s49 offen lds
  v_mfma_f32_16x16x32_bf16 v[120:123], v[64:67], v[88:91], v[120:123]
  v_mfma_f32_16x16x32_bf16 v[124:127], v[64:67], v[92:95], v[124:127]
  s_waitcnt lgkmcnt(2)
  v_mfma_f32_16x16x32_bf16 v[128:131], v[68:71], v[80:83], v[128:131]
  s_add_u32 m0, s47, 92160
  s_mov_b32 s49, 2359296
  buffer_load_dwordx4 v9, s[16:19], s49 offen lds
  v_mfma_f32_16x16x32_bf16 v[132:135], v[68:71], v[84:87], v[132:135]
  ds_read_b64_tr_b16 v[76:77], v5 offset:18432
  ds_read_b64_tr_b16 v[78:79], v5 offset:20736
  v_mfma_f32_16x16x32_bf16 v[136:139], v[68:71], v[88:91], v[136:139]
  v_mfma_f32_16x16x32_bf16 v[140:143], v[68:71], v[92:95], v[140:143]
  s_add_u32 m0, s47, 96256
  s_mov_b32 s49, 2359296
  buffer_load_dwordx4 v10, s[16:19], s49 offen lds
  s_waitcnt lgkmcnt(2)
  v_mfma_f32_16x16x32_bf16 v[144:147], v[72:75], v[80:83], v[144:147]
  ds_read_b64_tr_b16 v[56:57], v4 offset:64
  ds_read_b64_tr_b16 v[58:59], v4 offset:2368
  v_mfma_f32_16x16x32_bf16 v[148:151], v[72:75], v[84:87], v[148:151]
  s_add_u32 m0, s47, 100352
  s_mov_b32 s49, 2359296
  buffer_load_dwordx4 v32, s[16:19], s49 offen lds
  v_mfma_f32_16x16x32_bf16 v[152:155], v[72:75], v[88:91], v[152:155]
  v_mfma_f32_16x16x32_bf16 v[156:159], v[72:75], v[92:95], v[156:159]
  ds_read_b64_tr_b16 v[60:61], v4 offset:18496
  ds_read_b64_tr_b16 v[62:63], v4 offset:20800
  s_waitcnt lgkmcnt(4)
  v_mfma_f32_16x16x32_bf16 v[160:163], v[76:79], v[80:83], v[160:163]
  s_add_u32 m0, s47, 104448
  s_mov_b32 s49, 2359296
  buffer_load_dwordx4 v33, s[16:19], s49 offen lds
  v_mfma_f32_16x16x32_bf16 v[164:167], v[76:79], v[84:87], v[164:167]
  ds_read_b64_tr_b16 v[64:65], v5 offset:64
  ds_read_b64_tr_b16 v[66:67], v5 offset:2368
  v_mfma_f32_16x16x32_bf16 v[168:171], v[76:79], v[88:91], v[168:171]
  v_mfma_f32_16x16x32_bf16 v[172:175], v[76:79], v[92:95], v[172:175]
  ds_read_b64_tr_b16 v[68:69], v5 offset:18496
  ds_read_b64_tr_b16 v[70:71], v5 offset:20800
  s_add_u32 m0, s48, 73728
  s_mov_b32 s49, 2359296
  buffer_load_dwordx4 v11, s[28:31], s49 offen lds
  s_waitcnt lgkmcnt(6)
  v_mfma_f32_16x16x32_bf16 v[176:179], v[56:59], v[80:83], v[176:179]
  v_mfma_f32_16x16x32_bf16 v[180:183], v[56:59], v[84:87], v[180:183]
  v_mfma_f32_16x16x32_bf16 v[184:187], v[56:59], v[88:91], v[184:187]
  v_mfma_f32_16x16x32_bf16 v[188:191], v[56:59], v[92:95], v[188:191]
  s_waitcnt lgkmcnt(4)
  v_mfma_f32_16x16x32_bf16 v[192:195], v[60:63], v[80:83], v[192:195]
  v_mfma_f32_16x16x32_bf16 v[196:199], v[60:63], v[84:87], v[196:199]
  v_mfma_f32_16x16x32_bf16 v[200:203], v[60:63], v[88:91], v[200:203]
  v_mfma_f32_16x16x32_bf16 v[204:207], v[60:63], v[92:95], v[204:207]
  s_waitcnt lgkmcnt(0)
  s_waitcnt vmcnt(11)
  s_barrier
  v_add_u32 v6, 36864, v6
  v_add_u32 v4, 36864, v4
  v_add_u32 v5, 36864, v5
  v_mfma_f32_16x16x32_bf16 v[208:211], v[64:67], v[80:83], v[208:211]
  ds_read_b128 v[96:99], v7 offset:8192
  ds_read_b128 v[100:103], v7 offset:9216
  v_mfma_f32_16x16x32_bf16 v[212:215], v[64:67], v[84:87], v[212:215]
  ds_read_b128 v[104:107], v8 offset:10240
  ds_read_b128 v[108:111], v8 offset:11264
  ds_read_b64_tr_b16 v[72:73], v6 offset:0
  ds_read_b64_tr_b16 v[74:75], v6 offset:2304
  s_add_u32 m0, s47, 110592
  s_mov_b32 s4, 576
  buffer_load_dwordx4 v12, s[8:11], s4 offen sc1 lds
  v_mfma_f32_16x16x32_bf16 v[216:219], v[64:67], v[88:91], v[216:219]
  v_mfma_f32_16x16x32_bf16 v[220:223], v[64:67], v[92:95], v[220:223]
  ds_read_b64_tr_b16 v[76:77], v6 offset:18432
  ds_read_b64_tr_b16 v[78:79], v6 offset:20736
  s_add_u32 m0, s47, 114688
  s_mov_b32 s4, 74304
  buffer_load_dwordx4 v12, s[8:11], s4 offen sc1 lds
  v_mfma_f32_16x16x32_bf16 v[224:227], v[68:71], v[80:83], v[224:227]
  v_mfma_f32_16x16x32_bf16 v[228:231], v[68:71], v[84:87], v[228:231]
  ds_read_b64_tr_b16 v[56:57], v4 offset:0
  ds_read_b64_tr_b16 v[58:59], v4 offset:2304
  s_add_u32 m0, s47, 0
  s_mov_b32 s49, 2654208
  buffer_load_dwordx4 v9, s[12:15], s49 offen lds
  v_mfma_f32_16x16x32_bf16 v[232:235], v[68:71], v[88:91], v[232:235]
  v_mfma_f32_16x16x32_bf16 v[236:239], v[68:71], v[92:95], v[236:239]
  s_waitcnt lgkmcnt(4)
  v_mfma_f32_16x16x32_bf16 v[240:243], v[72:75], v[96:99], v[240:243]
  s_add_u32 m0, s47, 4096
  s_mov_b32 s49, 2654208
  buffer_load_dwordx4 v10, s[12:15], s49 offen lds
  v_mfma_f32_16x16x32_bf16 v[244:247], v[72:75], v[100:103], v[244:247]
  ds_read_b64_tr_b16 v[60:61], v4 offset:18432
  ds_read_b64_tr_b16 v[62:63], v4 offset:20736
  s_waitcnt lgkmcnt(4)
  v_mfma_f32_16x16x32_bf16 v[248:251], v[76:79], v[96:99], v[248:251]
  s_add_u32 m0, s47, 8192
  s_mov_b32 s49, 2654208
  buffer_load_dwordx4 v32, s[12:15], s49 offen lds
  v_mfma_f32_16x16x32_bf16 v[252:255], v[76:79], v[100:103], v[252:255]
  s_waitcnt lgkmcnt(2)
  v_mfma_f32_16x16x32_bf16 v[112:115], v[56:59], v[96:99], v[112:115]
  v_mfma_f32_16x16x32_bf16 v[116:119], v[56:59], v[100:103], v[116:119]
  ds_read_b64_tr_b16 v[64:65], v5 offset:0
  ds_read_b64_tr_b16 v[66:67], v5 offset:2304
  s_add_u32 m0, s47, 12288
  s_mov_b32 s49, 2654208
  buffer_load_dwordx4 v33, s[12:15], s49 offen lds
  v_mfma_f32_16x16x32_bf16 v[120:123], v[56:59], v[104:107], v[120:123]
  v_mfma_f32_16x16x32_bf16 v[124:127], v[56:59], v[108:111], v[124:127]
  s_waitcnt lgkmcnt(2)
  v_mfma_f32_16x16x32_bf16 v[128:131], v[60:63], v[96:99], v[128:131]
  s_add_u32 m0, s47, 18432
  s_mov_b32 s49, 2654208
  buffer_load_dwordx4 v9, s[16:19], s49 offen lds
  v_mfma_f32_16x16x32_bf16 v[132:135], v[60:63], v[100:103], v[132:135]
  ds_read_b64_tr_b16 v[68:69], v5 offset:18432
  ds_read_b64_tr_b16 v[70:71], v5 offset:20736
  v_mfma_f32_16x16x32_bf16 v[136:139], v[60:63], v[104:107], v[136:139]
  v_mfma_f32_16x16x32_bf16 v[140:143], v[60:63], v[108:111], v[140:143]
  s_add_u32 m0, s47, 22528
  s_mov_b32 s49, 2654208
  buffer_load_dwordx4 v10, s[16:19], s49 offen lds
  s_waitcnt lgkmcnt(2)
  v_mfma_f32_16x16x32_bf16 v[144:147], v[64:67], v[96:99], v[144:147]
  ds_read_b64_tr_b16 v[72:73], v4 offset:64
  ds_read_b64_tr_b16 v[74:75], v4 offset:2368
  v_mfma_f32_16x16x32_bf16 v[148:151], v[64:67], v[100:103], v[148:151]
  s_add_u32 m0, s47, 26624
  s_mov_b32 s49, 2654208
  buffer_load_dwordx4 v32, s[16:19], s49 offen lds
  v_mfma_f32_16x16x32_bf16 v[152:155], v[64:67], v[104:107], v[152:155]
  v_mfma_f32_16x16x32_bf16 v[156:159], v[64:67], v[108:111], v[156:159]
  ds_read_b64_tr_b16 v[76:77], v4 offset:18496
  ds_read_b64_tr_b16 v[78:79], v4 offset:20800
  s_waitcnt lgkmcnt(4)
  v_mfma_f32_16x16x32_bf16 v[160:163], v[68:71], v[96:99], v[160:163]
  s_add_u32 m0, s47, 30720
  s_mov_b32 s49, 2654208
  buffer_load_dwordx4 v33, s[16:19], s49 offen lds
  v_mfma_f32_16x16x32_bf16 v[164:167], v[68:71], v[100:103], v[164:167]
  ds_read_b64_tr_b16 v[56:57], v5 offset:64
  ds_read_b64_tr_b16 v[58:59], v5 offset:2368
  v_mfma_f32_16x16x32_bf16 v[168:171], v[68:71], v[104:107], v[168:171]
  v_mfma_f32_16x16x32_bf16 v[172:175], v[68:71], v[108:111], v[172:175]
  ds_read_b64_tr_b16 v[60:61], v5 offset:18496
  ds_read_b64_tr_b16 v[62:63], v5 offset:20800
  s_add_u32 m0, s48, 0
  s_mov_b32 s49, 2654208
  buffer_load_dwordx4 v11, s[28:31], s49 offen lds
  s_waitcnt lgkmcnt(6)
  v_mfma_f32_16x16x32_bf16 v[176:179], v[72:75], v[96:99], v[176:179]
  v_mfma_f32_16x16x32_bf16 v[180:183], v[72:75], v[100:103], v[180:183]
  v_mfma_f32_16x16x32_bf16 v[184:187], v[72:75], v[104:107], v[184:187]
  v_mfma_f32_16x16x32_bf16 v[188:191], v[72:75], v[108:111], v[188:191]
  s_waitcnt lgkmcnt(4)
  v_mfma_f32_16x16x32_bf16 v[192:195], v[76:79], v[96:99], v[192:195]
  v_mfma_f32_16x16x32_bf16 v[196:199], v[76:79], v[100:103], v[196:199]
  v_mfma_f32_16x16x32_bf16 v[200:203], v[76:79], v[104:107], v[200:203]
  v_mfma_f32_16x16x32_bf16 v[204:207], v[76:79], v[108:111], v[204:207]
  s_waitcnt lgkmcnt(0)
  s_waitcnt vmcnt(11)
  s_barrier
  v_add_u32 v6, 36864, v6
  v_add_u32 v4, 36864, v4
  v_add_u32 v5, 36864, v5
  v_mfma_f32_16x16x32_bf16 v[208:211], v[56:59], v[96:99], v[208:211]
  ds_read_b128 v[80:83], v7 offset:16384
  ds_read_b128 v[84:87], v7 offset:17408
  v_mfma_f32_16x16x32_bf16 v[212:215], v[56:59], v[100:103], v[212:215]
  ds_read_b128 v[88:91], v8 offset:18432
  ds_read_b128 v[92:95], v8 offset:19456
  ds_read_b64_tr_b16 v[64:65], v6 offset:0
  ds_read_b64_tr_b16 v[66:67], v6 offset:2304
  s_add_u32 m0, s47, 118784
  s_mov_b32 s4, 640
  buffer_load_dwordx4 v12, s[8:11], s4 offen sc1 lds
  v_mfma_f32_16x16x32_bf16 v[216:219], v[56:59], v[104:107], v[216:219]
  v_mfma_f32_16x16x32_bf16 v[220:223], v[56:59], v[108:111], v[220:223]
  ds_read_b64_tr_b16 v[68:69], v6 offset:18432
  ds_read_b64_tr_b16 v[70:71], v6 offset:20736
  s_add_u32 m0, s47, 122880
  s_mov_b32 s4, 74368
  buffer_load_dwordx4 v12, s[8:11], s4 offen sc1 lds
  v_mfma_f32_16x16x32_bf16 v[224:227], v[60:63], v[96:99], v[224:227]
  v_mfma_f32_16x16x32_bf16 v[228:231], v[60:63], v[100:103], v[228:231]
  ds_read_b64_tr_b16 v[72:73], v4 offset:0
  ds_read_b64_tr_b16 v[74:75], v4 offset:2304
  s_add_u32 m0, s47, 36864
  s_mov_b32 s49, 2949120
  buffer_load_dwordx4 v9, s[12:15], s49 offen lds
  v_mfma_f32_16x16x32_bf16 v[232:235], v[60:63], v[104:107], v[232:235]
  v_mfma_f32_16x16x32_bf16 v[236:239], v[60:63], v[108:111], v[236:239]
  s_waitcnt lgkmcnt(4)
  v_mfma_f32_16x16x32_bf16 v[240:243], v[64:67], v[80:83], v[240:243]
  s_add_u32 m0, s47, 40960
  s_mov_b32 s49, 2949120
  buffer_load_dwordx4 v10, s[12:15], s49 offen lds
  v_mfma_f32_16x16x32_bf16 v[244:247], v[64:67], v[84:87], v[244:247]
  ds_read_b64_tr_b16 v[76:77], v4 offset:18432
  ds_read_b64_tr_b16 v[78:79], v4 offset:20736
  s_waitcnt lgkmcnt(4)
  v_mfma_f32_16x16x32_bf16 v[248:251], v[68:71], v[80:83], v[248:251]
  s_add_u32 m0, s47, 45056
  s_mov_b32 s49, 2949120
  buffer_load_dwordx4 v32, s[12:15], s49 offen lds
  v_mfma_f32_16x16x32_bf16 v[252:255], v[68:71], v[84:87], v[252:255]
  s_waitcnt lgkmcnt(2)
  v_mfma_f32_16x16x32_bf16 v[112:115], v[72:75], v[80:83], v[112:115]
  v_mfma_f32_16x16x32_bf16 v[116:119], v[72:75], v[84:87], v[116:119]
  ds_read_b64_tr_b16 v[56:57], v5 offset:0
  ds_read_b64_tr_b16 v[58:59], v5 offset:2304
  s_add_u32 m0, s47, 49152
  s_mov_b32 s49, 2949120
  buffer_load_dwordx4 v33, s[12:15], s49 offen lds
  v_mfma_f32_16x16x32_bf16 v[120:123], v[72:75], v[88:91], v[120:123]
  v_mfma_f32_16x16x32_bf16 v[124:127], v[72:75], v[92:95], v[124:127]
  s_waitcnt lgkmcnt(2)
  v_mfma_f32_16x16x32_bf16 v[128:131], v[76:79], v[80:83], v[128:131]
  s_add_u32 m0, s47, 55296
  s_mov_b32 s49, 2949120
  buffer_load_dwordx4 v9, s[16:19], s49 offen lds
  v_mfma_f32_16x16x32_bf16 v[132:135], v[76:79], v[84:87], v[132:135]
  ds_read_b64_tr_b16 v[60:61], v5 offset:18432
  ds_read_b64_tr_b16 v[62:63], v5 offset:20736
  v_mfma_f32_16x16x32_bf16 v[136:139], v[76:79], v[88:91], v[136:139]
  v_mfma_f32_16x16x32_bf16 v[140:143], v[76:79], v[92:95], v[140:143]
  s_add_u32 m0, s47, 59392
  s_mov_b32 s49, 2949120
  buffer_load_dwordx4 v10, s[16:19], s49 offen lds
  s_waitcnt lgkmcnt(2)
  v_mfma_f32_16x16x32_bf16 v[144:147], v[56:59], v[80:83], v[144:147]
  ds_read_b64_tr_b16 v[64:65], v4 offset:64
  ds_read_b64_tr_b16 v[66:67], v4 offset:2368
  v_mfma_f32_16x16x32_bf16 v[148:151], v[56:59], v[84:87], v[148:151]
  s_add_u32 m0, s47, 63488
  s_mov_b32 s49, 2949120
  buffer_load_dwordx4 v32, s[16:19], s49 offen lds
  v_mfma_f32_16x16x32_bf16 v[152:155], v[56:59], v[88:91], v[152:155]
  v_mfma_f32_16x16x32_bf16 v[156:159], v[56:59], v[92:95], v[156:159]
  ds_read_b64_tr_b16 v[68:69], v4 offset:18496
  ds_read_b64_tr_b16 v[70:71], v4 offset:20800
  s_waitcnt lgkmcnt(4)
  v_mfma_f32_16x16x32_bf16 v[160:163], v[60:63], v[80:83], v[160:163]
  s_add_u32 m0, s47, 67584
  s_mov_b32 s49, 2949120
  buffer_load_dwordx4 v33, s[16:19], s49 offen lds
  v_mfma_f32_16x16x32_bf16 v[164:167], v[60:63], v[84:87], v[164:167]
  ds_read_b64_tr_b16 v[72:73], v5 offset:64
  ds_read_b64_tr_b16 v[74:75], v5 offset:2368
  v_mfma_f32_16x16x32_bf16 v[168:171], v[60:63], v[88:91], v[168:171]
  v_mfma_f32_16x16x32_bf16 v[172:175], v[60:63], v[92:95], v[172:175]
  ds_read_b64_tr_b16 v[76:77], v5 offset:18496
  ds_read_b64_tr_b16 v[78:79], v5 offset:20800
  s_add_u32 m0, s48, 36864
  s_mov_b32 s49, 2949120
  buffer_load_dwordx4 v11, s[28:31], s49 offen lds
  s_waitcnt lgkmcnt(6)
  v_mfma_f32_16x16x32_bf16 v[176:179], v[64:67], v[80:83], v[176:179]
  v_mfma_f32_16x16x32_bf16 v[180:183], v[64:67], v[84:87], v[180:183]
  v_mfma_f32_16x16x32_bf16 v[184:187], v[64:67], v[88:91], v[184:187]
  v_mfma_f32_16x16x32_bf16 v[188:191], v[64:67], v[92:95], v[188:191]
  s_waitcnt lgkmcnt(4)
  v_mfma_f32_16x16x32_bf16 v[192:195], v[68:71], v[80:83], v[192:195]
  v_mfma_f32_16x16x32_bf16 v[196:199], v[68:71], v[84:87], v[196:199]
  v_mfma_f32_16x16x32_bf16 v[200:203], v[68:71], v[88:91], v[200:203]
  v_mfma_f32_16x16x32_bf16 v[204:207], v[68:71], v[92:95], v[204:207]
  s_waitcnt lgkmcnt(0)
  s_waitcnt vmcnt(11)
  s_barrier
  v_subrev_u32 v6, 73728, v6
  v_subrev_u32 v4, 73728, v4
  v_subrev_u32 v5, 73728, v5
  v_mfma_f32_16x16x32_bf16 v[208:211], v[72:75], v[80:83], v[208:211]
  ds_read_b128 v[96:99], v7 offset:0
  ds_read_b128 v[100:103], v7 offset:1024
  v_mfma_f32_16x16x32_bf16 v[212:215], v[72:75], v[84:87], v[212:215]
  ds_read_b128 v[104:107], v8 offset:2048
  ds_read_b128 v[108:111], v8 offset:3072
  ds_read_b64_tr_b16 v[56:57], v6 offset:0
  ds_read_b64_tr_b16 v[58:59], v6 offset:2304
  s_add_u32 m0, s47, 126976
  s_mov_b32 s4, 704
  buffer_load_dwordx4 v12, s[8:11], s4 offen sc1 lds
  v_mfma_f32_16x16x32_bf16 v[216:219], v[72:75], v[88:91], v[216:219]
  v_mfma_f32_16x16x32_bf16 v[220:223], v[72:75], v[92:95], v[220:223]
  ds_read_b64_tr_b16 v[60:61], v6 offset:18432
  ds_read_b64_tr_b16 v[62:63], v6 offset:20736
  s_add_u32 m0, s47, 131072
  s_mov_b32 s4, 74432
  buffer_load_dwordx4 v12, s[8:11], s4 offen sc1 lds
  v_mfma_f32_16x16x32_bf16 v[224:227], v[76:79], v[80:83], v[224:227]
  v_mfma_f32_16x16x32_bf16 v[228:231], v[76:79], v[84:87], v[228:231]
  ds_read_b64_tr_b16 v[64:65], v4 offset:0
  ds_read_b64_tr_b16 v[66:67], v4 offset:2304
  s_add_u32 m0, s47, 73728
  s_mov_b32 s49, 3244032
  buffer_load_dwordx4 v9, s[12:15], s49 offen lds
  v_mfma_f32_16x16x32_bf16 v[232:235], v[76:79], v[88:91], v[232:235]
  v_mfma_f32_16x16x32_bf16 v[236:239], v[76:79], v[92:95], v[236:239]
  s_waitcnt lgkmcnt(4)
  v_mfma_f32_16x16x32_bf16 v[240:243], v[56:59], v[96:99], v[240:243]
  s_add_u32 m0, s47, 77824
  s_mov_b32 s49, 3244032
  buffer_load_dwordx4 v10, s[12:15], s49 offen lds
  v_mfma_f32_16x16x32_bf16 v[244:247], v[56:59], v[100:103], v[244:247]
  ds_read_b64_tr_b16 v[68:69], v4 offset:18432
  ds_read_b64_tr_b16 v[70:71], v4 offset:20736
  s_waitcnt lgkmcnt(4)
  v_mfma_f32_16x16x32_bf16 v[248:251], v[60:63], v[96:99], v[248:251]
  s_add_u32 m0, s47, 81920
  s_mov_b32 s49, 3244032
  buffer_load_dwordx4 v32, s[12:15], s49 offen lds
  v_mfma_f32_16x16x32_bf16 v[252:255], v[60:63], v[100:103], v[252:255]
  s_waitcnt lgkmcnt(2)
  v_mfma_f32_16x16x32_bf16 v[112:115], v[64:67], v[96:99], v[112:115]
  v_mfma_f32_16x16x32_bf16 v[116:119], v[64:67], v[100:103], v[116:119]
  ds_read_b64_tr_b16 v[72:73], v5 offset:0
  ds_read_b64_tr_b16 v[74:75], v5 offset:2304
  s_add_u32 m0, s47, 86016
  s_mov_b32 s49, 3244032
  buffer_load_dwordx4 v33, s[12:15], s49 offen lds
  v_mfma_f32_16x16x32_bf16 v[120:123], v[64:67], v[104:107], v[120:123]
  v_mfma_f32_16x16x32_bf16 v[124:127], v[64:67], v[108:111], v[124:127]
  s_waitcnt lgkmcnt(2)
  v_mfma_f32_16x16x32_bf16 v[128:131], v[68:71], v[96:99], v[128:131]
  s_add_u32 m0, s47, 92160
  s_mov_b32 s49, 3244032
  buffer_load_dwordx4 v9, s[16:19], s49 offen lds
  v_mfma_f32_16x16x32_bf16 v[132:135], v[68:71], v[100:103], v[132:135]
  ds_read_b64_tr_b16 v[76:77], v5 offset:18432
  ds_read_b64_tr_b16 v[78:79], v5 offset:20736
  v_mfma_f32_16x16x32_bf16 v[136:139], v[68:71], v[104:107], v[136:139]
  v_mfma_f32_16x16x32_bf16 v[140:143], v[68:71], v[108:111], v[140:143]
  s_add_u32 m0, s47, 96256
  s_mov_b32 s49, 3244032
  buffer_load_dwordx4 v10, s[16:19], s49 offen lds
  s_waitcnt lgkmcnt(2)
  v_mfma_f32_16x16x32_bf16 v[144:147], v[72:75], v[96:99], v[144:147]
  ds_read_b64_tr_b16 v[56:57], v4 offset:64
  ds_read_b64_tr_b16 v[58:59], v4 offset:2368
  v_mfma_f32_16x16x32_bf16 v[148:151], v[72:75], v[100:103], v[148:151]
  s_add_u32 m0, s47, 100352
  s_mov_b32 s49, 3244032
  buffer_load_dwordx4 v32, s[16:19], s49 offen lds
  v_mfma_f32_16x16x32_bf16 v[152:155], v[72:75], v[104:107], v[152:155]
  v_mfma_f32_16x16x32_bf16 v[156:159], v[72:75], v[108:111], v[156:159]
  ds_read_b64_tr_b16 v[60:61], v4 offset:18496
  ds_read_b64_tr_b16 v[62:63], v4 offset:20800
  s_waitcnt lgkmcnt(4)
  v_mfma_f32_16x16x32_bf16 v[160:163], v[76:79], v[96:99], v[160:163]
  s_add_u32 m0, s47, 104448
  s_mov_b32 s49, 3244032
  buffer_load_dwordx4 v33, s[16:19], s49 offen lds
  v_mfma_f32_16x16x32_bf16 v[164:167], v[76:79], v[100:103], v[164:167]
  ds_read_b64_tr_b16 v[64:65], v5 offset:64
  ds_read_b64_tr_b16 v[66:67], v5 offset:2368
  v_mfma_f32_16x16x32_bf16 v[168:171], v[76:79], v[104:107], v[168:171]
  v_mfma_f32_16x16x32_bf16 v[172:175], v[76:79], v[108:111], v[172:175]
  ds_read_b64_tr_b16 v[68:69], v5 offset:18496
  ds_read_b64_tr_b16 v[70:71], v5 offset:20800
  s_add_u32 m0, s48, 73728
  s_mov_b32 s49, 3244032
  buffer_load_dwordx4 v11, s[28:31], s49 offen lds
  s_waitcnt lgkmcnt(6)
  v_mfma_f32_16x16x32_bf16 v[176:179], v[56:59], v[96:99], v[176:179]
  v_mfma_f32_16x16x32_bf16 v[180:183], v[56:59], v[100:103], v[180:183]
  v_mfma_f32_16x16x32_bf16 v[184:187], v[56:59], v[104:107], v[184:187]
  v_mfma_f32_16x16x32_bf16 v[188:191], v[56:59], v[108:111], v[188:191]
  s_waitcnt lgkmcnt(4)
  v_mfma_f32_16x16x32_bf16 v[192:195], v[60:63], v[96:99], v[192:195]
  v_mfma_f32_16x16x32_bf16 v[196:199], v[60:63], v[100:103], v[196:199]
  v_mfma_f32_16x16x32_bf16 v[200:203], v[60:63], v[104:107], v[200:203]
  v_mfma_f32_16x16x32_bf16 v[204:207], v[60:63], v[108:111], v[204:207]
  s_waitcnt lgkmcnt(0)
  s_waitcnt vmcnt(11)
  s_barrier
  v_add_u32 v6, 36864, v6
  v_add_u32 v4, 36864, v4
  v_add_u32 v5, 36864, v5
  v_mfma_f32_16x16x32_bf16 v[208:211], v[64:67], v[96:99], v[208:211]
  ds_read_b128 v[80:83], v7 offset:8192
  ds_read_b128 v[84:87], v7 offset:9216
  v_mfma_f32_16x16x32_bf16 v[212:215], v[64:67], v[100:103], v[212:215]
  ds_read_b128 v[88:91], v8 offset:10240
  ds_read_b128 v[92:95], v8 offset:11264
  ds_read_b64_tr_b16 v[72:73], v6 offset:0
  ds_read_b64_tr_b16 v[74:75], v6 offset:2304
  s_add_u32 m0, s47, 110592
  s_mov_b32 s4, 768
  buffer_load_dwordx4 v12, s[8:11], s4 offen sc1 lds
  v_mfma_f32_16x16x32_bf16 v[216:219], v[64:67], v[104:107], v[216:219]
  v_mfma_f32_16x16x32_bf16 v[220:223], v[64:67], v[108:111], v[220:223]
  ds_read_b64_tr_b16 v[76:77], v6 offset:18432
  ds_read_b64_tr_b16 v[78:79], v6 offset:20736
  s_add_u32 m0, s47, 114688
  s_mov_b32 s4, 74496
  buffer_load_dwordx4 v12, s[8:11], s4 offen sc1 lds
  v_mfma_f32_16x16x32_bf16 v[224:227], v[68:71], v[96:99], v[224:227]
  v_mfma_f32_16x16x32_bf16 v[228:231], v[68:71], v[100:103], v[228:231]
  ds_read_b64_tr_b16 v[56:57], v4 offset:0
  ds_read_b64_tr_b16 v[58:59], v4 offset:2304
  s_add_u32 m0, s47, 0
  s_mov_b32 s49, 3538944
  buffer_load_dwordx4 v9, s[12:15], s49 offen lds
  v_mfma_f32_16x16x32_bf16 v[232:235], v[68:71], v[104:107], v[232:235]
  v_mfma_f32_16x16x32_bf16 v[236:239], v[68:71], v[108:111], v[236:239]
  s_waitcnt lgkmcnt(4)
  v_mfma_f32_16x16x32_bf16 v[240:243], v[72:75], v[80:83], v[240:243]
  s_add_u32 m0, s47, 4096
  s_mov_b32 s49, 3538944
  buffer_load_dwordx4 v10, s[12:15], s49 offen lds
  v_mfma_f32_16x16x32_bf16 v[244:247], v[72:75], v[84:87], v[244:247]
  ds_read_b64_tr_b16 v[60:61], v4 offset:18432
  ds_read_b64_tr_b16 v[62:63], v4 offset:20736
  s_waitcnt lgkmcnt(4)
  v_mfma_f32_16x16x32_bf16 v[248:251], v[76:79], v[80:83], v[248:251]
  s_add_u32 m0, s47, 8192
  s_mov_b32 s49, 3538944
  buffer_load_dwordx4 v32, s[12:15], s49 offen lds
  v_mfma_f32_16x16x32_bf16 v[252:255], v[76:79], v[84:87], v[252:255]
  s_waitcnt lgkmcnt(2)
  v_mfma_f32_16x16x32_bf16 v[112:115], v[56:59], v[80:83], v[112:115]
  v_mfma_f32_16x16x32_bf16 v[116:119], v[56:59], v[84:87], v[116:119]
  ds_read_b64_tr_b16 v[64:65], v5 offset:0
  ds_read_b64_tr_b16 v[66:67], v5 offset:2304
  s_add_u32 m0, s47, 12288
  s_mov_b32 s49, 3538944
  buffer_load_dwordx4 v33, s[12:15], s49 offen lds
  v_mfma_f32_16x16x32_bf16 v[120:123], v[56:59], v[88:91], v[120:123]
  v_mfma_f32_16x16x32_bf16 v[124:127], v[56:59], v[92:95], v[124:127]
  s_waitcnt lgkmcnt(2)
  v_mfma_f32_16x16x32_bf16 v[128:131], v[60:63], v[80:83], v[128:131]
  s_add_u32 m0, s47, 18432
  s_mov_b32 s49, 3538944
  buffer_load_dwordx4 v9, s[16:19], s49 offen lds
  v_mfma_f32_16x16x32_bf16 v[132:135], v[60:63], v[84:87], v[132:135]
  ds_read_b64_tr_b16 v[68:69], v5 offset:18432
  ds_read_b64_tr_b16 v[70:71], v5 offset:20736
  v_mfma_f32_16x16x32_bf16 v[136:139], v[60:63], v[88:91], v[136:139]
  v_mfma_f32_16x16x32_bf16 v[140:143], v[60:63], v[92:95], v[140:143]
  s_add_u32 m0, s47, 22528
  s_mov_b32 s49, 3538944
  buffer_load_dwordx4 v10, s[16:19], s49 offen lds
  s_waitcnt lgkmcnt(2)
  v_mfma_f32_16x16x32_bf16 v[144:147], v[64:67], v[80:83], v[144:147]
  ds_read_b64_tr_b16 v[72:73], v4 offset:64
  ds_read_b64_tr_b16 v[74:75], v4 offset:2368
  v_mfma_f32_16x16x32_bf16 v[148:151], v[64:67], v[84:87], v[148:151]
  s_add_u32 m0, s47, 26624
  s_mov_b32 s49, 3538944
  buffer_load_dwordx4 v32, s[16:19], s49 offen lds
  v_mfma_f32_16x16x32_bf16 v[152:155], v[64:67], v[88:91], v[152:155]
  v_mfma_f32_16x16x32_bf16 v[156:159], v[64:67], v[92:95], v[156:159]
  ds_read_b64_tr_b16 v[76:77], v4 offset:18496
  ds_read_b64_tr_b16 v[78:79], v4 offset:20800
  s_waitcnt lgkmcnt(4)
  v_mfma_f32_16x16x32_bf16 v[160:163], v[68:71], v[80:83], v[160:163]
  s_add_u32 m0, s47, 30720
  s_mov_b32 s49, 3538944
  buffer_load_dwordx4 v33, s[16:19], s49 offen lds
  v_mfma_f32_16x16x32_bf16 v[164:167], v[68:71], v[84:87], v[164:167]
  ds_read_b64_tr_b16 v[56:57], v5 offset:64
  ds_read_b64_tr_b16 v[58:59], v5 offset:2368
  v_mfma_f32_16x16x32_bf16 v[168:171], v[68:71], v[88:91], v[168:171]
  v_mfma_f32_16x16x32_bf16 v[172:175], v[68:71], v[92:95], v[172:175]
  ds_read_b64_tr_b16 v[60:61], v5 offset:18496
  ds_read_b64_tr_b16 v[62:63], v5 offset:20800
  s_add_u32 m0, s48, 0
  s_mov_b32 s49, 3538944
  buffer_load_dwordx4 v11, s[28:31], s49 offen lds
  s_waitcnt lgkmcnt(6)
  v_mfma_f32_16x16x32_bf16 v[176:179], v[72:75], v[80:83], v[176:179]
  v_mfma_f32_16x16x32_bf16 v[180:183], v[72:75], v[84:87], v[180:183]
  v_mfma_f32_16x16x32_bf16 v[184:187], v[72:75], v[88:91], v[184:187]
  v_mfma_f32_16x16x32_bf16 v[188:191], v[72:75], v[92:95], v[188:191]
  s_waitcnt lgkmcnt(4)
  v_mfma_f32_16x16x32_bf16 v[192:195], v[76:79], v[80:83], v[192:195]
  v_mfma_f32_16x16x32_bf16 v[196:199], v[76:79], v[84:87], v[196:199]
  v_mfma_f32_16x16x32_bf16 v[200:203], v[76:79], v[88:91], v[200:203]
  v_mfma_f32_16x16x32_bf16 v[204:207], v[76:79], v[92:95], v[204:207]
  s_waitcnt lgkmcnt(0)
  s_waitcnt vmcnt(11)
  s_barrier
  v_add_u32 v6, 36864, v6
  v_add_u32 v4, 36864, v4
  v_add_u32 v5, 36864, v5
  v_mfma_f32_16x16x32_bf16 v[208:211], v[56:59], v[80:83], v[208:211]
  ds_read_b128 v[96:99], v7 offset:16384
  ds_read_b128 v[100:103], v7 offset:17408
  v_mfma_f32_16x16x32_bf16 v[212:215], v[56:59], v[84:87], v[212:215]
  ds_read_b128 v[104:107], v8 offset:18432
  ds_read_b128 v[108:111], v8 offset:19456
  ds_read_b64_tr_b16 v[64:65], v6 offset:0
  ds_read_b64_tr_b16 v[66:67], v6 offset:2304
  s_add_u32 m0, s47, 118784
  s_mov_b32 s4, 832
  buffer_load_dwordx4 v12, s[8:11], s4 offen sc1 lds
  v_mfma_f32_16x16x32_bf16 v[216:219], v[56:59], v[88:91], v[216:219]
  v_mfma_f32_16x16x32_bf16 v[220:223], v[56:59], v[92:95], v[220:223]
  ds_read_b64_tr_b16 v[68:69], v6 offset:18432
  ds_read_b64_tr_b16 v[70:71], v6 offset:20736
  s_add_u32 m0, s47, 122880
  s_mov_b32 s4, 74560
  buffer_load_dwordx4 v12, s[8:11], s4 offen sc1 lds
  v_mfma_f32_16x16x32_bf16 v[224:227], v[60:63], v[80:83], v[224:227]
  v_mfma_f32_16x16x32_bf16 v[228:231], v[60:63], v[84:87], v[228:231]
  ds_read_b64_tr_b16 v[72:73], v4 offset:0
  ds_read_b64_tr_b16 v[74:75], v4 offset:2304
  s_add_u32 m0, s47, 36864
  s_mov_b32 s49, 3833856
  buffer_load_dwordx4 v9, s[12:15], s49 offen lds
  v_mfma_f32_16x16x32_bf16 v[232:235], v[60:63], v[88:91], v[232:235]
  v_mfma_f32_16x16x32_bf16 v[236:239], v[60:63], v[92:95], v[236:239]
  s_waitcnt lgkmcnt(4)
  v_mfma_f32_16x16x32_bf16 v[240:243], v[64:67], v[96:99], v[240:243]
  s_add_u32 m0, s47, 40960
  s_mov_b32 s49, 3833856
  buffer_load_dwordx4 v10, s[12:15], s49 offen lds
  v_mfma_f32_16x16x32_bf16 v[244:247], v[64:67], v[100:103], v[244:247]
  ds_read_b64_tr_b16 v[76:77], v4 offset:18432
  ds_read_b64_tr_b16 v[78:79], v4 offset:20736
  s_waitcnt lgkmcnt(4)
  v_mfma_f32_16x16x32_bf16 v[248:251], v[68:71], v[96:99], v[248:251]
  s_add_u32 m0, s47, 45056
  s_mov_b32 s49, 3833856
  buffer_load_dwordx4 v32, s[12:15], s49 offen lds
  v_mfma_f32_16x16x32_bf16 v[252:255], v[68:71], v[100:103], v[252:255]
  s_waitcnt lgkmcnt(2)
  v_mfma_f32_16x16x32_bf16 v[112:115], v[72:75], v[96:99], v[112:115]
  v_mfma_f32_16x16x32_bf16 v[116:119], v[72:75], v[100:103], v[116:119]
  ds_read_b64_tr_b16 v[56:57], v5 offset:0
  ds_read_b64_tr_b16 v[58:59], v5 offset:2304
  s_add_u32 m0, s47, 49152
  s_mov_b32 s49, 3833856
  buffer_load_dwordx4 v33, s[12:15], s49 offen lds
  v_mfma_f32_16x16x32_bf16 v[120:123], v[72:75], v[104:107], v[120:123]
  v_mfma_f32_16x16x32_bf16 v[124:127], v[72:75], v[108:111], v[124:127]
  s_waitcnt lgkmcnt(2)
  v_mfma_f32_16x16x32_bf16 v[128:131], v[76:79], v[96:99], v[128:131]
  s_add_u32 m0, s47, 55296
  s_mov_b32 s49, 3833856
  buffer_load_dwordx4 v9, s[16:19], s49 offen lds
  v_mfma_f32_16x16x32_bf16 v[132:135], v[76:79], v[100:103], v[132:135]
  ds_read_b64_tr_b16 v[60:61], v5 offset:18432
  ds_read_b64_tr_b16 v[62:63], v5 offset:20736
  v_mfma_f32_16x16x32_bf16 v[136:139], v[76:79], v[104:107], v[136:139]
  v_mfma_f32_16x16x32_bf16 v[140:143], v[76:79], v[108:111], v[140:143]
  s_add_u32 m0, s47, 59392
  s_mov_b32 s49, 3833856
  buffer_load_dwordx4 v10, s[16:19], s49 offen lds
  s_waitcnt lgkmcnt(2)
  v_mfma_f32_16x16x32_bf16 v[144:147], v[56:59], v[96:99], v[144:147]
  ds_read_b64_tr_b16 v[64:65], v4 offset:64
  ds_read_b64_tr_b16 v[66:67], v4 offset:2368
  v_mfma_f32_16x16x32_bf16 v[148:151], v[56:59], v[100:103], v[148:151]
  s_add_u32 m0, s47, 63488
  s_mov_b32 s49, 3833856
  buffer_load_dwordx4 v32, s[16:19], s49 offen lds
  v_mfma_f32_16x16x32_bf16 v[152:155], v[56:59], v[104:107], v[152:155]
  v_mfma_f32_16x16x32_bf16 v[156:159], v[56:59], v[108:111], v[156:159]
  ds_read_b64_tr_b16 v[68:69], v4 offset:18496
  ds_read_b64_tr_b16 v[70:71], v4 offset:20800
  s_waitcnt lgkmcnt(4)
  v_mfma_f32_16x16x32_bf16 v[160:163], v[60:63], v[96:99], v[160:163]
  s_add_u32 m0, s47, 67584
  s_mov_b32 s49, 3833856
  buffer_load_dwordx4 v33, s[16:19], s49 offen lds
  v_mfma_f32_16x16x32_bf16 v[164:167], v[60:63], v[100:103], v[164:167]
  ds_read_b64_tr_b16 v[72:73], v5 offset:64
  ds_read_b64_tr_b16 v[74:75], v5 offset:2368
  v_mfma_f32_16x16x32_bf16 v[168:171], v[60:63], v[104:107], v[168:171]
  v_mfma_f32_16x16x32_bf16 v[172:175], v[60:63], v[108:111], v[172:175]
  ds_read_b64_tr_b16 v[76:77], v5 offset:18496
  ds_read_b64_tr_b16 v[78:79], v5 offset:20800
  s_add_u32 m0, s48, 36864
  s_mov_b32 s49, 3833856
  buffer_load_dwordx4 v11, s[28:31], s49 offen lds
  s_waitcnt lgkmcnt(6)
  v_mfma_f32_16x16x32_bf16 v[176:179], v[64:67], v[96:99], v[176:179]
  v_mfma_f32_16x16x32_bf16 v[180:183], v[64:67], v[100:103], v[180:183]
  v_mfma_f32_16x16x32_bf16 v[184:187], v[64:67], v[104:107], v[184:187]
  v_mfma_f32_16x16x32_bf16 v[188:191], v[64:67], v[108:111], v[188:191]
  s_waitcnt lgkmcnt(4)
  v_mfma_f32_16x16x32_bf16 v[192:195], v[68:71], v[96:99], v[192:195]
  v_mfma_f32_16x16x32_bf16 v[196:199], v[68:71], v[100:103], v[196:199]
  v_mfma_f32_16x16x32_bf16 v[200:203], v[68:71], v[104:107], v[200:203]
  v_mfma_f32_16x16x32_bf16 v[204:207], v[68:71], v[108:111], v[204:207]
  s_waitcnt lgkmcnt(0)
  s_waitcnt vmcnt(11)
  s_barrier
  v_subrev_u32 v6, 73728, v6
  v_subrev_u32 v4, 73728, v4
  v_subrev_u32 v5, 73728, v5
  v_mfma_f32_16x16x32_bf16 v[208:211], v[72:75], v[96:99], v[208:211]
  ds_read_b128 v[80:83], v7 offset:0
  ds_read_b128 v[84:87], v7 offset:1024
  v_mfma_f32_16x16x32_bf16 v[212:215], v[72:75], v[100:103], v[212:215]
  ds_read_b128 v[88:91], v8 offset:2048
  ds_read_b128 v[92:95], v8 offset:3072
  ds_read_b64_tr_b16 v[56:57], v6 offset:0
  ds_read_b64_tr_b16 v[58:59], v6 offset:2304
  s_add_u32 m0, s47, 126976
  s_mov_b32 s4, 896
  buffer_load_dwordx4 v12, s[8:11], s4 offen sc1 lds
  v_mfma_f32_16x16x32_bf16 v[216:219], v[72:75], v[104:107], v[216:219]
  v_mfma_f32_16x16x32_bf16 v[220:223], v[72:75], v[108:111], v[220:223]
  ds_read_b64_tr_b16 v[60:61], v6 offset:18432
  ds_read_b64_tr_b16 v[62:63], v6 offset:20736
  s_add_u32 m0, s47, 131072
  s_mov_b32 s4, 74624
  buffer_load_dwordx4 v12, s[8:11], s4 offen sc1 lds
  v_mfma_f32_16x16x32_bf16 v[224:227], v[76:79], v[96:99], v[224:227]
  v_mfma_f32_16x16x32_bf16 v[228:231], v[76:79], v[100:103], v[228:231]
  ds_read_b64_tr_b16 v[64:65], v4 offset:0
  ds_read_b64_tr_b16 v[66:67], v4 offset:2304
  s_add_u32 m0, s47, 73728
  s_mov_b32 s49, 4128768
  buffer_load_dwordx4 v9, s[12:15], s49 offen lds
  v_mfma_f32_16x16x32_bf16 v[232:235], v[76:79], v[104:107], v[232:235]
  v_mfma_f32_16x16x32_bf16 v[236:239], v[76:79], v[108:111], v[236:239]
  s_waitcnt lgkmcnt(4)
  v_mfma_f32_16x16x32_bf16 v[240:243], v[56:59], v[80:83], v[240:243]
  s_add_u32 m0, s47, 77824
  s_mov_b32 s49, 4128768
  buffer_load_dwordx4 v10, s[12:15], s49 offen lds
  v_mfma_f32_16x16x32_bf16 v[244:247], v[56:59], v[84:87], v[244:247]
  ds_read_b64_tr_b16 v[68:69], v4 offset:18432
  ds_read_b64_tr_b16 v[70:71], v4 offset:20736
  s_waitcnt lgkmcnt(4)
  v_mfma_f32_16x16x32_bf16 v[248:251], v[60:63], v[80:83], v[248:251]
  s_add_u32 m0, s47, 81920
  s_mov_b32 s49, 4128768
  buffer_load_dwordx4 v32, s[12:15], s49 offen lds
  v_mfma_f32_16x16x32_bf16 v[252:255], v[60:63], v[84:87], v[252:255]
  s_waitcnt lgkmcnt(2)
  v_mfma_f32_16x16x32_bf16 v[112:115], v[64:67], v[80:83], v[112:115]
  v_mfma_f32_16x16x32_bf16 v[116:119], v[64:67], v[84:87], v[116:119]
  ds_read_b64_tr_b16 v[72:73], v5 offset:0
  ds_read_b64_tr_b16 v[74:75], v5 offset:2304
  s_add_u32 m0, s47, 86016
  s_mov_b32 s49, 4128768
  buffer_load_dwordx4 v33, s[12:15], s49 offen lds
  v_mfma_f32_16x16x32_bf16 v[120:123], v[64:67], v[88:91], v[120:123]
  v_mfma_f32_16x16x32_bf16 v[124:127], v[64:67], v[92:95], v[124:127]
  s_waitcnt lgkmcnt(2)
  v_mfma_f32_16x16x32_bf16 v[128:131], v[68:71], v[80:83], v[128:131]
  s_add_u32 m0, s47, 92160
  s_mov_b32 s49, 4128768
  buffer_load_dwordx4 v9, s[16:19], s49 offen lds
  v_mfma_f32_16x16x32_bf16 v[132:135], v[68:71], v[84:87], v[132:135]
  ds_read_b64_tr_b16 v[76:77], v5 offset:18432
  ds_read_b64_tr_b16 v[78:79], v5 offset:20736
  v_mfma_f32_16x16x32_bf16 v[136:139], v[68:71], v[88:91], v[136:139]
  v_mfma_f32_16x16x32_bf16 v[140:143], v[68:71], v[92:95], v[140:143]
  s_add_u32 m0, s47, 96256
  s_mov_b32 s49, 4128768
  buffer_load_dwordx4 v10, s[16:19], s49 offen lds
  s_waitcnt lgkmcnt(2)
  v_mfma_f32_16x16x32_bf16 v[144:147], v[72:75], v[80:83], v[144:147]
  ds_read_b64_tr_b16 v[56:57], v4 offset:64
  ds_read_b64_tr_b16 v[58:59], v4 offset:2368
  v_mfma_f32_16x16x32_bf16 v[148:151], v[72:75], v[84:87], v[148:151]
  s_add_u32 m0, s47, 100352
  s_mov_b32 s49, 4128768
  buffer_load_dwordx4 v32, s[16:19], s49 offen lds
  v_mfma_f32_16x16x32_bf16 v[152:155], v[72:75], v[88:91], v[152:155]
  v_mfma_f32_16x16x32_bf16 v[156:159], v[72:75], v[92:95], v[156:159]
  ds_read_b64_tr_b16 v[60:61], v4 offset:18496
  ds_read_b64_tr_b16 v[62:63], v4 offset:20800
  s_waitcnt lgkmcnt(4)
  v_mfma_f32_16x16x32_bf16 v[160:163], v[76:79], v[80:83], v[160:163]
  s_add_u32 m0, s47, 104448
  s_mov_b32 s49, 4128768
  buffer_load_dwordx4 v33, s[16:19], s49 offen lds
  v_mfma_f32_16x16x32_bf16 v[164:167], v[76:79], v[84:87], v[164:167]
  ds_read_b64_tr_b16 v[64:65], v5 offset:64
  ds_read_b64_tr_b16 v[66:67], v5 offset:2368
  v_mfma_f32_16x16x32_bf16 v[168:171], v[76:79], v[88:91], v[168:171]
  v_mfma_f32_16x16x32_bf16 v[172:175], v[76:79], v[92:95], v[172:175]
  ds_read_b64_tr_b16 v[68:69], v5 offset:18496
  ds_read_b64_tr_b16 v[70:71], v5 offset:20800
  s_add_u32 m0, s48, 73728
  s_mov_b32 s49, 4128768
  buffer_load_dwordx4 v11, s[28:31], s49 offen lds
  s_waitcnt lgkmcnt(6)
  v_mfma_f32_16x16x32_bf16 v[176:179], v[56:59], v[80:83], v[176:179]
  v_mfma_f32_16x16x32_bf16 v[180:183], v[56:59], v[84:87], v[180:183]
  v_mfma_f32_16x16x32_bf16 v[184:187], v[56:59], v[88:91], v[184:187]
  v_mfma_f32_16x16x32_bf16 v[188:191], v[56:59], v[92:95], v[188:191]
  s_waitcnt lgkmcnt(4)
  v_mfma_f32_16x16x32_bf16 v[192:195], v[60:63], v[80:83], v[192:195]
  v_mfma_f32_16x16x32_bf16 v[196:199], v[60:63], v[84:87], v[196:199]
  v_mfma_f32_16x16x32_bf16 v[200:203], v[60:63], v[88:91], v[200:203]
  v_mfma_f32_16x16x32_bf16 v[204:207], v[60:63], v[92:95], v[204:207]
  s_waitcnt lgkmcnt(0)
  s_waitcnt vmcnt(11)
  s_barrier
  v_add_u32 v6, 36864, v6
  v_add_u32 v4, 36864, v4
  v_add_u32 v5, 36864, v5
  v_mfma_f32_16x16x32_bf16 v[208:211], v[64:67], v[80:83], v[208:211]
  ds_read_b128 v[96:99], v7 offset:8192
  ds_read_b128 v[100:103], v7 offset:9216
  v_mfma_f32_16x16x32_bf16 v[212:215], v[64:67], v[84:87], v[212:215]
  ds_read_b128 v[104:107], v8 offset:10240
  ds_read_b128 v[108:111], v8 offset:11264
  ds_read_b64_tr_b16 v[72:73], v6 offset:0
  ds_read_b64_tr_b16 v[74:75], v6 offset:2304
  s_add_u32 m0, s47, 110592
  s_mov_b32 s4, 960
  buffer_load_dwordx4 v12, s[8:11], s4 offen sc1 lds
  v_mfma_f32_16x16x32_bf16 v[216:219], v[64:67], v[88:91], v[216:219]
  v_mfma_f32_16x16x32_bf16 v[220:223], v[64:67], v[92:95], v[220:223]
  ds_read_b64_tr_b16 v[76:77], v6 offset:18432
  ds_read_b64_tr_b16 v[78:79], v6 offset:20736
  s_add_u32 m0, s47, 114688
  s_mov_b32 s4, 74688
  buffer_load_dwordx4 v12, s[8:11], s4 offen sc1 lds
  v_mfma_f32_16x16x32_bf16 v[224:227], v[68:71], v[80:83], v[224:227]
  v_mfma_f32_16x16x32_bf16 v[228:231], v[68:71], v[84:87], v[228:231]
  ds_read_b64_tr_b16 v[56:57], v4 offset:0
  ds_read_b64_tr_b16 v[58:59], v4 offset:2304
  s_add_u32 m0, s47, 0
  s_mov_b32 s49, 4423680
  buffer_load_dwordx4 v9, s[12:15], s49 offen lds
  v_mfma_f32_16x16x32_bf16 v[232:235], v[68:71], v[88:91], v[232:235]
  v_mfma_f32_16x16x32_bf16 v[236:239], v[68:71], v[92:95], v[236:239]
  s_waitcnt lgkmcnt(4)
  v_mfma_f32_16x16x32_bf16 v[240:243], v[72:75], v[96:99], v[240:243]
  s_add_u32 m0, s47, 4096
  s_mov_b32 s49, 4423680
  buffer_load_dwordx4 v10, s[12:15], s49 offen lds
  v_mfma_f32_16x16x32_bf16 v[244:247], v[72:75], v[100:103], v[244:247]
  ds_read_b64_tr_b16 v[60:61], v4 offset:18432
  ds_read_b64_tr_b16 v[62:63], v4 offset:20736
  s_waitcnt lgkmcnt(4)
  v_mfma_f32_16x16x32_bf16 v[248:251], v[76:79], v[96:99], v[248:251]
  s_add_u32 m0, s47, 8192
  s_mov_b32 s49, 4423680
  buffer_load_dwordx4 v32, s[12:15], s49 offen lds
  v_mfma_f32_16x16x32_bf16 v[252:255], v[76:79], v[100:103], v[252:255]
  s_waitcnt lgkmcnt(2)
  v_mfma_f32_16x16x32_bf16 v[112:115], v[56:59], v[96:99], v[112:115]
  v_mfma_f32_16x16x32_bf16 v[116:119], v[56:59], v[100:103], v[116:119]
  ds_read_b64_tr_b16 v[64:65], v5 offset:0
  ds_read_b64_tr_b16 v[66:67], v5 offset:2304
  s_add_u32 m0, s47, 12288
  s_mov_b32 s49, 4423680
  buffer_load_dwordx4 v33, s[12:15], s49 offen lds
  v_mfma_f32_16x16x32_bf16 v[120:123], v[56:59], v[104:107], v[120:123]
  v_mfma_f32_16x16x32_bf16 v[124:127], v[56:59], v[108:111], v[124:127]
  s_waitcnt lgkmcnt(2)
  v_mfma_f32_16x16x32_bf16 v[128:131], v[60:63], v[96:99], v[128:131]
  s_add_u32 m0, s47, 18432
  s_mov_b32 s49, 4423680
  buffer_load_dwordx4 v9, s[16:19], s49 offen lds
  v_mfma_f32_16x16x32_bf16 v[132:135], v[60:63], v[100:103], v[132:135]
  ds_read_b64_tr_b16 v[68:69], v5 offset:18432
  ds_read_b64_tr_b16 v[70:71], v5 offset:20736
  v_mfma_f32_16x16x32_bf16 v[136:139], v[60:63], v[104:107], v[136:139]
  v_mfma_f32_16x16x32_bf16 v[140:143], v[60:63], v[108:111], v[140:143]
  s_add_u32 m0, s47, 22528
  s_mov_b32 s49, 4423680
  buffer_load_dwordx4 v10, s[16:19], s49 offen lds
  s_waitcnt lgkmcnt(2)
  v_mfma_f32_16x16x32_bf16 v[144:147], v[64:67], v[96:99], v[144:147]
  ds_read_b64_tr_b16 v[72:73], v4 offset:64
  ds_read_b64_tr_b16 v[74:75], v4 offset:2368
  v_mfma_f32_16x16x32_bf16 v[148:151], v[64:67], v[100:103], v[148:151]
  s_add_u32 m0, s47, 26624
  s_mov_b32 s49, 4423680
  buffer_load_dwordx4 v32, s[16:19], s49 offen lds
  v_mfma_f32_16x16x32_bf16 v[152:155], v[64:67], v[104:107], v[152:155]
  v_mfma_f32_16x16x32_bf16 v[156:159], v[64:67], v[108:111], v[156:159]
  ds_read_b64_tr_b16 v[76:77], v4 offset:18496
  ds_read_b64_tr_b16 v[78:79], v4 offset:20800
  s_waitcnt lgkmcnt(4)
  v_mfma_f32_16x16x32_bf16 v[160:163], v[68:71], v[96:99], v[160:163]
  s_add_u32 m0, s47, 30720
  s_mov_b32 s49, 4423680
  buffer_load_dwordx4 v33, s[16:19], s49 offen lds
  v_mfma_f32_16x16x32_bf16 v[164:167], v[68:71], v[100:103], v[164:167]
  ds_read_b64_tr_b16 v[56:57], v5 offset:64
  ds_read_b64_tr_b16 v[58:59], v5 offset:2368
  v_mfma_f32_16x16x32_bf16 v[168:171], v[68:71], v[104:107], v[168:171]
  v_mfma_f32_16x16x32_bf16 v[172:175], v[68:71], v[108:111], v[172:175]
  ds_read_b64_tr_b16 v[60:61], v5 offset:18496
  ds_read_b64_tr_b16 v[62:63], v5 offset:20800
  s_add_u32 m0, s48, 0
  s_mov_b32 s49, 4423680
  buffer_load_dwordx4 v11, s[28:31], s49 offen lds
  s_waitcnt lgkmcnt(6)
  v_mfma_f32_16x16x32_bf16 v[176:179], v[72:75], v[96:99], v[176:179]
  v_mfma_f32_16x16x32_bf16 v[180:183], v[72:75], v[100:103], v[180:183]
  v_mfma_f32_16x16x32_bf16 v[184:187], v[72:75], v[104:107], v[184:187]
  v_mfma_f32_16x16x32_bf16 v[188:191], v[72:75], v[108:111], v[188:191]
  s_waitcnt lgkmcnt(4)
  v_mfma_f32_16x16x32_bf16 v[192:195], v[76:79], v[96:99], v[192:195]
  v_mfma_f32_16x16x32_bf16 v[196:199], v[76:79], v[100:103], v[196:199]
  v_mfma_f32_16x16x32_bf16 v[200:203], v[76:79], v[104:107], v[200:203]
  v_mfma_f32_16x16x32_bf16 v[204:207], v[76:79], v[108:111], v[204:207]
  s_waitcnt lgkmcnt(0)
  s_waitcnt vmcnt(11)
  s_barrier
  v_add_u32 v6, 36864, v6
  v_add_u32 v4, 36864, v4
  v_add_u32 v5, 36864, v5
  v_mfma_f32_16x16x32_bf16 v[208:211], v[56:59], v[96:99], v[208:211]
  ds_read_b128 v[80:83], v7 offset:16384
  ds_read_b128 v[84:87], v7 offset:17408
  v_mfma_f32_16x16x32_bf16 v[212:215], v[56:59], v[100:103], v[212:215]
  ds_read_b128 v[88:91], v8 offset:18432
  ds_read_b128 v[92:95], v8 offset:19456
  ds_read_b64_tr_b16 v[64:65], v6 offset:0
  ds_read_b64_tr_b16 v[66:67], v6 offset:2304
  s_add_u32 m0, s47, 118784
  s_mov_b32 s4, 1024
  buffer_load_dwordx4 v12, s[8:11], s4 offen sc1 lds
  v_mfma_f32_16x16x32_bf16 v[216:219], v[56:59], v[104:107], v[216:219]
  v_mfma_f32_16x16x32_bf16 v[220:223], v[56:59], v[108:111], v[220:223]
  ds_read_b64_tr_b16 v[68:69], v6 offset:18432
  ds_read_b64_tr_b16 v[70:71], v6 offset:20736
  s_add_u32 m0, s47, 122880
  s_mov_b32 s4, 74752
  buffer_load_dwordx4 v12, s[8:11], s4 offen sc1 lds
  v_mfma_f32_16x16x32_bf16 v[224:227], v[60:63], v[96:99], v[224:227]
  v_mfma_f32_16x16x32_bf16 v[228:231], v[60:63], v[100:103], v[228:231]
  ds_read_b64_tr_b16 v[72:73], v4 offset:0
  ds_read_b64_tr_b16 v[74:75], v4 offset:2304
  s_add_u32 m0, s47, 36864
  s_mov_b32 s49, 4718592
  buffer_load_dwordx4 v9, s[12:15], s49 offen lds
  v_mfma_f32_16x16x32_bf16 v[232:235], v[60:63], v[104:107], v[232:235]
  v_mfma_f32_16x16x32_bf16 v[236:239], v[60:63], v[108:111], v[236:239]
  s_waitcnt lgkmcnt(4)
  v_mfma_f32_16x16x32_bf16 v[240:243], v[64:67], v[80:83], v[240:243]
  s_add_u32 m0, s47, 40960
  s_mov_b32 s49, 4718592
  buffer_load_dwordx4 v10, s[12:15], s49 offen lds
  v_mfma_f32_16x16x32_bf16 v[244:247], v[64:67], v[84:87], v[244:247]
  ds_read_b64_tr_b16 v[76:77], v4 offset:18432
  ds_read_b64_tr_b16 v[78:79], v4 offset:20736
  s_waitcnt lgkmcnt(4)
  v_mfma_f32_16x16x32_bf16 v[248:251], v[68:71], v[80:83], v[248:251]
  s_add_u32 m0, s47, 45056
  s_mov_b32 s49, 4718592
  buffer_load_dwordx4 v32, s[12:15], s49 offen lds
  v_mfma_f32_16x16x32_bf16 v[252:255], v[68:71], v[84:87], v[252:255]
  s_waitcnt lgkmcnt(2)
  v_mfma_f32_16x16x32_bf16 v[112:115], v[72:75], v[80:83], v[112:115]
  v_mfma_f32_16x16x32_bf16 v[116:119], v[72:75], v[84:87], v[116:119]
  ds_read_b64_tr_b16 v[56:57], v5 offset:0
  ds_read_b64_tr_b16 v[58:59], v5 offset:2304
  s_add_u32 m0, s47, 49152
  s_mov_b32 s49, 4718592
  buffer_load_dwordx4 v33, s[12:15], s49 offen lds
  v_mfma_f32_16x16x32_bf16 v[120:123], v[72:75], v[88:91], v[120:123]
  v_mfma_f32_16x16x32_bf16 v[124:127], v[72:75], v[92:95], v[124:127]
  s_waitcnt lgkmcnt(2)
  v_mfma_f32_16x16x32_bf16 v[128:131], v[76:79], v[80:83], v[128:131]
  s_add_u32 m0, s47, 55296
  s_mov_b32 s49, 4718592
  buffer_load_dwordx4 v9, s[16:19], s49 offen lds
  v_mfma_f32_16x16x32_bf16 v[132:135], v[76:79], v[84:87], v[132:135]
  ds_read_b64_tr_b16 v[60:61], v5 offset:18432
  ds_read_b64_tr_b16 v[62:63], v5 offset:20736
  v_mfma_f32_16x16x32_bf16 v[136:139], v[76:79], v[88:91], v[136:139]
  v_mfma_f32_16x16x32_bf16 v[140:143], v[76:79], v[92:95], v[140:143]
  s_add_u32 m0, s47, 59392
  s_mov_b32 s49, 4718592
  buffer_load_dwordx4 v10, s[16:19], s49 offen lds
  s_waitcnt lgkmcnt(2)
  v_mfma_f32_16x16x32_bf16 v[144:147], v[56:59], v[80:83], v[144:147]
  ds_read_b64_tr_b16 v[64:65], v4 offset:64
  ds_read_b64_tr_b16 v[66:67], v4 offset:2368
  v_mfma_f32_16x16x32_bf16 v[148:151], v[56:59], v[84:87], v[148:151]
  s_add_u32 m0, s47, 63488
  s_mov_b32 s49, 4718592
  buffer_load_dwordx4 v32, s[16:19], s49 offen lds
  v_mfma_f32_16x16x32_bf16 v[152:155], v[56:59], v[88:91], v[152:155]
  v_mfma_f32_16x16x32_bf16 v[156:159], v[56:59], v[92:95], v[156:159]
  ds_read_b64_tr_b16 v[68:69], v4 offset:18496
  ds_read_b64_tr_b16 v[70:71], v4 offset:20800
  s_waitcnt lgkmcnt(4)
  v_mfma_f32_16x16x32_bf16 v[160:163], v[60:63], v[80:83], v[160:163]
  s_add_u32 m0, s47, 67584
  s_mov_b32 s49, 4718592
  buffer_load_dwordx4 v33, s[16:19], s49 offen lds
  v_mfma_f32_16x16x32_bf16 v[164:167], v[60:63], v[84:87], v[164:167]
  ds_read_b64_tr_b16 v[72:73], v5 offset:64
  ds_read_b64_tr_b16 v[74:75], v5 offset:2368
  v_mfma_f32_16x16x32_bf16 v[168:171], v[60:63], v[88:91], v[168:171]
  v_mfma_f32_16x16x32_bf16 v[172:175], v[60:63], v[92:95], v[172:175]
  ds_read_b64_tr_b16 v[76:77], v5 offset:18496
  ds_read_b64_tr_b16 v[78:79], v5 offset:20800
  s_add_u32 m0, s48, 36864
  s_mov_b32 s49, 4718592
  buffer_load_dwordx4 v11, s[28:31], s49 offen lds
  s_waitcnt lgkmcnt(6)
  v_mfma_f32_16x16x32_bf16 v[176:179], v[64:67], v[80:83], v[176:179]
  v_mfma_f32_16x16x32_bf16 v[180:183], v[64:67], v[84:87], v[180:183]
  v_mfma_f32_16x16x32_bf16 v[184:187], v[64:67], v[88:91], v[184:187]
  v_mfma_f32_16x16x32_bf16 v[188:191], v[64:67], v[92:95], v[188:191]
  s_waitcnt lgkmcnt(4)
  v_mfma_f32_16x16x32_bf16 v[192:195], v[68:71], v[80:83], v[192:195]
  v_mfma_f32_16x16x32_bf16 v[196:199], v[68:71], v[84:87], v[196:199]
  v_mfma_f32_16x16x32_bf16 v[200:203], v[68:71], v[88:91], v[200:203]
  v_mfma_f32_16x16x32_bf16 v[204:207], v[68:71], v[92:95], v[204:207]
  s_waitcnt lgkmcnt(0)
  s_waitcnt vmcnt(11)
  s_barrier
  v_subrev_u32 v6, 73728, v6
  v_subrev_u32 v4, 73728, v4
  v_subrev_u32 v5, 73728, v5
  v_mfma_f32_16x16x32_bf16 v[208:211], v[72:75], v[80:83], v[208:211]
  ds_read_b128 v[96:99], v7 offset:0
  ds_read_b128 v[100:103], v7 offset:1024
  v_mfma_f32_16x16x32_bf16 v[212:215], v[72:75], v[84:87], v[212:215]
  ds_read_b128 v[104:107], v8 offset:2048
  ds_read_b128 v[108:111], v8 offset:3072
  ds_read_b64_tr_b16 v[56:57], v6 offset:0
  ds_read_b64_tr_b16 v[58:59], v6 offset:2304
  s_add_u32 m0, s47, 126976
  s_mov_b32 s4, 1088
  buffer_load_dwordx4 v12, s[8:11], s4 offen sc1 lds
  v_mfma_f32_16x16x32_bf16 v[216:219], v[72:75], v[88:91], v[216:219]
  v_mfma_f32_16x16x32_bf16 v[220:223], v[72:75], v[92:95], v[220:223]
  ds_read_b64_tr_b16 v[60:61], v6 offset:18432
  ds_read_b64_tr_b16 v[62:63], v6 offset:20736
  s_add_u32 m0, s47, 131072
  s_mov_b32 s4, 74816
  buffer_load_dwordx4 v12, s[8:11], s4 offen sc1 lds
  v_mfma_f32_16x16x32_bf16 v[224:227], v[76:79], v[80:83], v[224:227]
  v_mfma_f32_16x16x32_bf16 v[228:231], v[76:79], v[84:87], v[228:231]
  ds_read_b64_tr_b16 v[64:65], v4 offset:0
  ds_read_b64_tr_b16 v[66:67], v4 offset:2304
  s_add_u32 m0, s47, 73728
  s_mov_b32 s49, 5013504
  buffer_load_dwordx4 v9, s[12:15], s49 offen lds
  v_mfma_f32_16x16x32_bf16 v[232:235], v[76:79], v[88:91], v[232:235]
  v_mfma_f32_16x16x32_bf16 v[236:239], v[76:79], v[92:95], v[236:239]
  s_waitcnt lgkmcnt(4)
  v_mfma_f32_16x16x32_bf16 v[240:243], v[56:59], v[96:99], v[240:243]
  s_add_u32 m0, s47, 77824
  s_mov_b32 s49, 5013504
  buffer_load_dwordx4 v10, s[12:15], s49 offen lds
  v_mfma_f32_16x16x32_bf16 v[244:247], v[56:59], v[100:103], v[244:247]
  ds_read_b64_tr_b16 v[68:69], v4 offset:18432
  ds_read_b64_tr_b16 v[70:71], v4 offset:20736
  s_waitcnt lgkmcnt(4)
  v_mfma_f32_16x16x32_bf16 v[248:251], v[60:63], v[96:99], v[248:251]
  s_add_u32 m0, s47, 81920
  s_mov_b32 s49, 5013504
  buffer_load_dwordx4 v32, s[12:15], s49 offen lds
  v_mfma_f32_16x16x32_bf16 v[252:255], v[60:63], v[100:103], v[252:255]
  s_waitcnt lgkmcnt(2)
  v_mfma_f32_16x16x32_bf16 v[112:115], v[64:67], v[96:99], v[112:115]
  v_mfma_f32_16x16x32_bf16 v[116:119], v[64:67], v[100:103], v[116:119]
  ds_read_b64_tr_b16 v[72:73], v5 offset:0
  ds_read_b64_tr_b16 v[74:75], v5 offset:2304
  s_add_u32 m0, s47, 86016
  s_mov_b32 s49, 5013504
  buffer_load_dwordx4 v33, s[12:15], s49 offen lds
  v_mfma_f32_16x16x32_bf16 v[120:123], v[64:67], v[104:107], v[120:123]
  v_mfma_f32_16x16x32_bf16 v[124:127], v[64:67], v[108:111], v[124:127]
  s_waitcnt lgkmcnt(2)
  v_mfma_f32_16x16x32_bf16 v[128:131], v[68:71], v[96:99], v[128:131]
  s_add_u32 m0, s47, 92160
  s_mov_b32 s49, 5013504
  buffer_load_dwordx4 v9, s[16:19], s49 offen lds
  v_mfma_f32_16x16x32_bf16 v[132:135], v[68:71], v[100:103], v[132:135]
  ds_read_b64_tr_b16 v[76:77], v5 offset:18432
  ds_read_b64_tr_b16 v[78:79], v5 offset:20736
  v_mfma_f32_16x16x32_bf16 v[136:139], v[68:71], v[104:107], v[136:139]
  v_mfma_f32_16x16x32_bf16 v[140:143], v[68:71], v[108:111], v[140:143]
  s_add_u32 m0, s47, 96256
  s_mov_b32 s49, 5013504
  buffer_load_dwordx4 v10, s[16:19], s49 offen lds
  s_waitcnt lgkmcnt(2)
  v_mfma_f32_16x16x32_bf16 v[144:147], v[72:75], v[96:99], v[144:147]
  ds_read_b64_tr_b16 v[56:57], v4 offset:64
  ds_read_b64_tr_b16 v[58:59], v4 offset:2368
  v_mfma_f32_16x16x32_bf16 v[148:151], v[72:75], v[100:103], v[148:151]
  s_add_u32 m0, s47, 100352
  s_mov_b32 s49, 5013504
  buffer_load_dwordx4 v32, s[16:19], s49 offen lds
  v_mfma_f32_16x16x32_bf16 v[152:155], v[72:75], v[104:107], v[152:155]
  v_mfma_f32_16x16x32_bf16 v[156:159], v[72:75], v[108:111], v[156:159]
  ds_read_b64_tr_b16 v[60:61], v4 offset:18496
  ds_read_b64_tr_b16 v[62:63], v4 offset:20800
  s_waitcnt lgkmcnt(4)
  v_mfma_f32_16x16x32_bf16 v[160:163], v[76:79], v[96:99], v[160:163]
  s_add_u32 m0, s47, 104448
  s_mov_b32 s49, 5013504
  buffer_load_dwordx4 v33, s[16:19], s49 offen lds
  v_mfma_f32_16x16x32_bf16 v[164:167], v[76:79], v[100:103], v[164:167]
  ds_read_b64_tr_b16 v[64:65], v5 offset:64
  ds_read_b64_tr_b16 v[66:67], v5 offset:2368
  v_mfma_f32_16x16x32_bf16 v[168:171], v[76:79], v[104:107], v[168:171]
  v_mfma_f32_16x16x32_bf16 v[172:175], v[76:79], v[108:111], v[172:175]
  ds_read_b64_tr_b16 v[68:69], v5 offset:18496
  ds_read_b64_tr_b16 v[70:71], v5 offset:20800
  s_add_u32 m0, s48, 73728
  s_mov_b32 s49, 5013504
  buffer_load_dwordx4 v11, s[28:31], s49 offen lds
  s_waitcnt lgkmcnt(6)
  v_mfma_f32_16x16x32_bf16 v[176:179], v[56:59], v[96:99], v[176:179]
  v_mfma_f32_16x16x32_bf16 v[180:183], v[56:59], v[100:103], v[180:183]
  v_mfma_f32_16x16x32_bf16 v[184:187], v[56:59], v[104:107], v[184:187]
  v_mfma_f32_16x16x32_bf16 v[188:191], v[56:59], v[108:111], v[188:191]
  s_waitcnt lgkmcnt(4)
  v_mfma_f32_16x16x32_bf16 v[192:195], v[60:63], v[96:99], v[192:195]
  v_mfma_f32_16x16x32_bf16 v[196:199], v[60:63], v[100:103], v[196:199]
  v_mfma_f32_16x16x32_bf16 v[200:203], v[60:63], v[104:107], v[200:203]
  v_mfma_f32_16x16x32_bf16 v[204:207], v[60:63], v[108:111], v[204:207]
  s_waitcnt lgkmcnt(0)
  s_waitcnt vmcnt(11)
  s_barrier
  v_add_u32 v6, 36864, v6
  v_add_u32 v4, 36864, v4
  v_add_u32 v5, 36864, v5
  v_mfma_f32_16x16x32_bf16 v[208:211], v[64:67], v[96:99], v[208:211]
  ds_read_b128 v[80:83], v7 offset:8192
  ds_read_b128 v[84:87], v7 offset:9216
  v_mfma_f32_16x16x32_bf16 v[212:215], v[64:67], v[100:103], v[212:215]
  ds_read_b128 v[88:91], v8 offset:10240
  ds_read_b128 v[92:95], v8 offset:11264
  ds_read_b64_tr_b16 v[72:73], v6 offset:0
  ds_read_b64_tr_b16 v[74:75], v6 offset:2304
  s_add_u32 m0, s47, 0
  s_mov_b32 s49, 0
  buffer_load_dwordx4 v16, s[20:23], s49 offen lds
  v_mfma_f32_16x16x32_bf16 v[216:219], v[64:67], v[104:107], v[216:219]
  v_mfma_f32_16x16x32_bf16 v[220:223], v[64:67], v[108:111], v[220:223]
  ds_read_b64_tr_b16 v[76:77], v6 offset:18432
  ds_read_b64_tr_b16 v[78:79], v6 offset:20736
  s_add_u32 m0, s47, 4096
  s_mov_b32 s49, 36864
  buffer_load_dwordx4 v16, s[20:23], s49 offen lds
  v_mfma_f32_16x16x32_bf16 v[224:227], v[68:71], v[96:99], v[224:227]
  v_mfma_f32_16x16x32_bf16 v[228:231], v[68:71], v[100:103], v[228:231]
  ds_read_b64_tr_b16 v[56:57], v4 offset:0
  ds_read_b64_tr_b16 v[58:59], v4 offset:2304
  s_add_u32 m0, s47, 8192
  s_mov_b32 s49, 73728
  buffer_load_dwordx4 v16, s[20:23], s49 offen lds
  v_mfma_f32_16x16x32_bf16 v[232:235], v[68:71], v[104:107], v[232:235]
  v_mfma_f32_16x16x32_bf16 v[236:239], v[68:71], v[108:111], v[236:239]
  s_waitcnt lgkmcnt(4)
  v_mfma_f32_16x16x32_bf16 v[240:243], v[72:75], v[80:83], v[240:243]
  s_add_u32 m0, s47, 12288
  s_mov_b32 s49, 110592
  buffer_load_dwordx4 v16, s[20:23], s49 offen lds
  v_mfma_f32_16x16x32_bf16 v[244:247], v[72:75], v[84:87], v[244:247]
  ds_read_b64_tr_b16 v[60:61], v4 offset:18432
  ds_read_b64_tr_b16 v[62:63], v4 offset:20736
  s_waitcnt lgkmcnt(4)
  v_mfma_f32_16x16x32_bf16 v[248:251], v[76:79], v[80:83], v[248:251]
  v_mfma_f32_16x16x32_bf16 v[252:255], v[76:79], v[84:87], v[252:255]
  s_add_u32 m0, s47, 16384
  s_mov_b32 s49, 147456
  buffer_load_dwordx4 v16, s[20:23], s49 offen lds
  s_waitcnt lgkmcnt(2)
  v_mfma_f32_16x16x32_bf16 v[112:115], v[56:59], v[80:83], v[112:115]
  v_mfma_f32_16x16x32_bf16 v[116:119], v[56:59], v[84:87], v[116:119]
  ds_read_b64_tr_b16 v[64:65], v5 offset:0
  ds_read_b64_tr_b16 v[66:67], v5 offset:2304
  v_mfma_f32_16x16x32_bf16 v[120:123], v[56:59], v[88:91], v[120:123]
  v_mfma_f32_16x16x32_bf16 v[124:127], v[56:59], v[92:95], v[124:127]
  s_add_u32 m0, s47, 20480
  s_mov_b32 s49, 184320
  buffer_load_dwordx4 v16, s[20:23], s49 offen lds
  s_waitcnt lgkmcnt(2)
  v_mfma_f32_16x16x32_bf16 v[128:131], v[60:63], v[80:83], v[128:131]
  v_mfma_f32_16x16x32_bf16 v[132:135], v[60:63], v[84:87], v[132:135]
  ds_read_b64_tr_b16 v[68:69], v5 offset:18432
  ds_read_b64_tr_b16 v[70:71], v5 offset:20736
  v_mfma_f32_16x16x32_bf16 v[136:139], v[60:63], v[88:91], v[136:139]
  v_mfma_f32_16x16x32_bf16 v[140:143], v[60:63], v[92:95], v[140:143]
  s_add_u32 m0, s47, 24576
  s_mov_b32 s49, 221184
  buffer_load_dwordx4 v16, s[20:23], s49 offen lds
  s_waitcnt lgkmcnt(2)
  v_mfma_f32_16x16x32_bf16 v[144:147], v[64:67], v[80:83], v[144:147]
  ds_read_b64_tr_b16 v[72:73], v4 offset:64
  ds_read_b64_tr_b16 v[74:75], v4 offset:2368
  v_mfma_f32_16x16x32_bf16 v[148:151], v[64:67], v[84:87], v[148:151]
  v_mfma_f32_16x16x32_bf16 v[152:155], v[64:67], v[88:91], v[152:155]
  s_add_u32 m0, s47, 28672
  s_mov_b32 s49, 258048
  buffer_load_dwordx4 v16, s[20:23], s49 offen lds
  v_mfma_f32_16x16x32_bf16 v[156:159], v[64:67], v[92:95], v[156:159]
  ds_read_b64_tr_b16 v[76:77], v4 offset:18496
  ds_read_b64_tr_b16 v[78:79], v4 offset:20800
  s_waitcnt lgkmcnt(4)
  v_mfma_f32_16x16x32_bf16 v[160:163], v[68:71], v[80:83], v[160:163]
  v_mfma_f32_16x16x32_bf16 v[164:167], v[68:71], v[84:87], v[164:167]
  ds_read_b64_tr_b16 v[56:57], v5 offset:64
  ds_read_b64_tr_b16 v[58:59], v5 offset:2368
  v_mfma_f32_16x16x32_bf16 v[168:171], v[68:71], v[88:91], v[168:171]
  s_add_u32 m0, s47, 32768
  s_mov_b32 s49, 294912
  buffer_load_dwordx4 v16, s[20:23], s49 offen lds
  v_mfma_f32_16x16x32_bf16 v[172:175], v[68:71], v[92:95], v[172:175]
  ds_read_b64_tr_b16 v[60:61], v5 offset:18496
  ds_read_b64_tr_b16 v[62:63], v5 offset:20800
  s_waitcnt lgkmcnt(6)
  v_mfma_f32_16x16x32_bf16 v[176:179], v[72:75], v[80:83], v[176:179]
  v_mfma_f32_16x16x32_bf16 v[180:183], v[72:75], v[84:87], v[180:183]
  v_mfma_f32_16x16x32_bf16 v[184:187], v[72:75], v[88:91], v[184:187]
  v_mfma_f32_16x16x32_bf16 v[188:191], v[72:75], v[92:95], v[188:191]
  s_waitcnt lgkmcnt(4)
  v_mfma_f32_16x16x32_bf16 v[192:195], v[76:79], v[80:83], v[192:195]
  v_mfma_f32_16x16x32_bf16 v[196:199], v[76:79], v[84:87], v[196:199]
  v_mfma_f32_16x16x32_bf16 v[200:203], v[76:79], v[88:91], v[200:203]
  v_mfma_f32_16x16x32_bf16 v[204:207], v[76:79], v[92:95], v[204:207]
  s_waitcnt lgkmcnt(0)
  s_waitcnt vmcnt(9)
  s_barrier
  v_add_u32 v6, 36864, v6
  v_add_u32 v4, 36864, v4
  v_add_u32 v5, 36864, v5
  v_mfma_f32_16x16x32_bf16 v[208:211], v[56:59], v[80:83], v[208:211]
  ds_read_b128 v[96:99], v7 offset:16384
  ds_read_b128 v[100:103], v7 offset:17408
  v_mfma_f32_16x16x32_bf16 v[212:215], v[56:59], v[84:87], v[212:215]
  ds_read_b128 v[104:107], v8 offset:18432
  ds_read_b128 v[108:111], v8 offset:19456
  ds_read_b64_tr_b16 v[64:65], v6 offset:0
  ds_read_b64_tr_b16 v[66:67], v6 offset:2304
  s_add_u32 m0, s47, 36864
  s_mov_b32 s49, 128
  buffer_load_dwordx4 v16, s[20:23], s49 offen lds
  v_mfma_f32_16x16x32_bf16 v[216:219], v[56:59], v[88:91], v[216:219]
  v_mfma_f32_16x16x32_bf16 v[220:223], v[56:59], v[92:95], v[220:223]
  ds_read_b64_tr_b16 v[68:69], v6 offset:18432
  ds_read_b64_tr_b16 v[70:71], v6 offset:20736
  s_add_u32 m0, s47, 40960
  s_mov_b32 s49, 36992
  buffer_load_dwordx4 v16, s[20:23], s49 offen lds
  v_mfma_f32_16x16x32_bf16 v[224:227], v[60:63], v[80:83], v[224:227]
  v_mfma_f32_16x16x32_bf16 v[228:231], v[60:63], v[84:87], v[228:231]
  ds_read_b64_tr_b16 v[72:73], v4 offset:0
  ds_read_b64_tr_b16 v[74:75], v4 offset:2304
  s_add_u32 m0, s47, 45056
  s_mov_b32 s49, 73856
  buffer_load_dwordx4 v16, s[20:23], s49 offen lds
  v_mfma_f32_16x16x32_bf16 v[232:235], v[60:63], v[88:91], v[232:235]
  v_mfma_f32_16x16x32_bf16 v[236:239], v[60:63], v[92:95], v[236:239]
  s_waitcnt lgkmcnt(4)
  v_mfma_f32_16x16x32_bf16 v[240:243], v[64:67], v[96:99], v[240:243]
  s_add_u32 m0, s47, 49152
  s_mov_b32 s49, 110720
  buffer_load_dwordx4 v16, s[20:23], s49 offen lds
  v_mfma_f32_16x16x32_bf16 v[244:247], v[64:67], v[100:103], v[244:247]
  ds_read_b64_tr_b16 v[76:77], v4 offset:18432
  ds_read_b64_tr_b16 v[78:79], v4 offset:20736
  s_waitcnt lgkmcnt(4)
  v_mfma_f32_16x16x32_bf16 v[248:251], v[68:71], v[96:99], v[248:251]
  v_mfma_f32_16x16x32_bf16 v[252:255], v[68:71], v[100:103], v[252:255]
  s_add_u32 m0, s47, 53248
  s_mov_b32 s49, 147584
  buffer_load_dwordx4 v16, s[20:23], s49 offen lds
  s_waitcnt lgkmcnt(2)
  v_mfma_f32_16x16x32_bf16 v[112:115], v[72:75], v[96:99], v[112:115]
  v_mfma_f32_16x16x32_bf16 v[116:119], v[72:75], v[100:103], v[116:119]
  ds_read_b64_tr_b16 v[56:57], v5 offset:0
  ds_read_b64_tr_b16 v[58:59], v5 offset:2304
  v_mfma_f32_16x16x32_bf16 v[120:123], v[72:75], v[104:107], v[120:123]
  v_mfma_f32_16x16x32_bf16 v[124:127], v[72:75], v[108:111], v[124:127]
  s_add_u32 m0, s47, 57344
  s_mov_b32 s49, 184448
  buffer_load_dwordx4 v16, s[20:23], s49 offen lds
  s_waitcnt lgkmcnt(2)
  v_mfma_f32_16x16x32_bf16 v[128:131], v[76:79], v[96:99], v[128:131]
  v_mfma_f32_16x16x32_bf16 v[132:135], v[76:79], v[100:103], v[132:135]
  ds_read_b64_tr_b16 v[60:61], v5 offset:18432
  ds_read_b64_tr_b16 v[62:63], v5 offset:20736
  v_mfma_f32_16x16x32_bf16 v[136:139], v[76:79], v[104:107], v[136:139]
  v_mfma_f32_16x16x32_bf16 v[140:143], v[76:79], v[108:111], v[140:143]
  s_add_u32 m0, s47, 61440
  s_mov_b32 s49, 221312
  buffer_load_dwordx4 v16, s[20:23], s49 offen lds
  s_waitcnt lgkmcnt(2)
  v_mfma_f32_16x16x32_bf16 v[144:147], v[56:59], v[96:99], v[144:147]
  ds_read_b64_tr_b16 v[64:65], v4 offset:64
  ds_read_b64_tr_b16 v[66:67], v4 offset:2368
  v_mfma_f32_16x16x32_bf16 v[148:151], v[56:59], v[100:103], v[148:151]
  v_mfma_f32_16x16x32_bf16 v[152:155], v[56:59], v[104:107], v[152:155]
  s_add_u32 m0, s47, 65536
  s_mov_b32 s49, 258176
  buffer_load_dwordx4 v16, s[20:23], s49 offen lds
  v_mfma_f32_16x16x32_bf16 v[156:159], v[56:59], v[108:111], v[156:159]
  ds_read_b64_tr_b16 v[68:69], v4 offset:18496
  ds_read_b64_tr_b16 v[70:71], v4 offset:20800
  s_waitcnt lgkmcnt(4)
  v_mfma_f32_16x16x32_bf16 v[160:163], v[60:63], v[96:99], v[160:163]
  v_mfma_f32_16x16x32_bf16 v[164:167], v[60:63], v[100:103], v[164:167]
  ds_read_b64_tr_b16 v[72:73], v5 offset:64
  ds_read_b64_tr_b16 v[74:75], v5 offset:2368
  v_mfma_f32_16x16x32_bf16 v[168:171], v[60:63], v[104:107], v[168:171]
  s_add_u32 m0, s47, 69632
  s_mov_b32 s49, 295040
  buffer_load_dwordx4 v16, s[20:23], s49 offen lds
  v_mfma_f32_16x16x32_bf16 v[172:175], v[60:63], v[108:111], v[172:175]
  ds_read_b64_tr_b16 v[76:77], v5 offset:18496
  ds_read_b64_tr_b16 v[78:79], v5 offset:20800
  s_waitcnt lgkmcnt(6)
  v_mfma_f32_16x16x32_bf16 v[176:179], v[64:67], v[96:99], v[176:179]
  v_mfma_f32_16x16x32_bf16 v[180:183], v[64:67], v[100:103], v[180:183]
  v_mfma_f32_16x16x32_bf16 v[184:187], v[64:67], v[104:107], v[184:187]
  v_mfma_f32_16x16x32_bf16 v[188:191], v[64:67], v[108:111], v[188:191]
  s_waitcnt lgkmcnt(4)
  v_mfma_f32_16x16x32_bf16 v[192:195], v[68:71], v[96:99], v[192:195]
  v_mfma_f32_16x16x32_bf16 v[196:199], v[68:71], v[100:103], v[196:199]
  v_mfma_f32_16x16x32_bf16 v[200:203], v[68:71], v[104:107], v[200:203]
  v_mfma_f32_16x16x32_bf16 v[204:207], v[68:71], v[108:111], v[204:207]
  s_waitcnt lgkmcnt(0)
  s_barrier
  v_mfma_f32_16x16x32_bf16 v[208:211], v[72:75], v[96:99], v[208:211]
  v_mfma_f32_16x16x32_bf16 v[212:215], v[72:75], v[100:103], v[212:215]
  v_mfma_f32_16x16x32_bf16 v[216:219], v[72:75], v[104:107], v[216:219]
  v_mfma_f32_16x16x32_bf16 v[220:223], v[72:75], v[108:111], v[220:223]
  v_mfma_f32_16x16x32_bf16 v[224:227], v[76:79], v[96:99], v[224:227]
  v_mfma_f32_16x16x32_bf16 v[228:231], v[76:79], v[100:103], v[228:231]
  v_mfma_f32_16x16x32_bf16 v[232:235], v[76:79], v[104:107], v[232:235]
  v_mfma_f32_16x16x32_bf16 v[236:239], v[76:79], v[108:111], v[236:239]
  s_branch L_g1end
L_g1B:
  s_waitcnt lgkmcnt(4)
  v_mfma_f32_16x16x32_bf16 v[240:243], v[56:59], v[80:83], 0
  s_mov_b32 s3, 128
  buffer_load_dword v15, v21, s[8:11], s3 offen
  v_mfma_f32_16x16x32_bf16 v[244:247], v[56:59], v[84:87], 0
  ds_read_b64_tr_b16 v[68:69], v4 offset:18432
  ds_read_b64_tr_b16 v[70:71], v4 offset:20736
  s_waitcnt lgkmcnt(4)
  v_mfma_f32_16x16x32_bf16 v[248:251], v[60:63], v[80:83], 0
  v_mfma_f32_16x16x32_bf16 v[252:255], v[60:63], v[84:87], 0
  s_waitcnt lgkmcnt(2)
  v_mfma_f32_16x16x32_bf16 v[112:115], v[64:67], v[80:83], 0
  v_mfma_f32_16x16x32_bf16 v[116:119], v[64:67], v[84:87], 0
  ds_read_b64_tr_b16 v[72:73], v5 offset:0
  ds_read_b64_tr_b16 v[74:75], v5 offset:2304
  s_mov_b32 s3, 256
  buffer_load_dword v15, v21, s[8:11], s3 offen
  v_mfma_f32_16x16x32_bf16 v[120:123], v[64:67], v[88:91], 0
  v_mfma_f32_16x16x32_bf16 v[124:127], v[64:67], v[92:95], 0
  s_waitcnt lgkmcnt(2)
  v_mfma_f32_16x16x32_bf16 v[128:131], v[68:71], v[80:83], 0
  v_mfma_f32_16x16x32_bf16 v[132:135], v[68:71], v[84:87], 0
  ds_read_b64_tr_b16 v[76:77], v5 offset:18432
  ds_read_b64_tr_b16 v[78:79], v5 offset:20736
  v_mfma_f32_16x16x32_bf16 v[136:139], v[68:71], v[88:91], 0
  s_mov_b32 s3, 884736
  buffer_load_dword v15, v13, s[12:15], s3 offen
  buffer_load_dword v15, v13, s[16:19], s3 offen
  v_mfma_f32_16x16x32_bf16 v[140:143], v[68:71], v[92:95], 0
  s_waitcnt lgkmcnt(2)
  v_mfma_f32_16x16x32_bf16 v[144:147], v[72:75], v[80:83], 0
  ds_read_b64_tr_b16 v[56:57], v4 offset:64
  ds_read_b64_tr_b16 v[58:59], v4 offset:2368
  v_mfma_f32_16x16x32_bf16 v[148:151], v[72:75], v[84:87], 0
  v_mfma_f32_16x16x32_bf16 v[152:155], v[72:75], v[88:91], 0
  v_mfma_f32_16x16x32_bf16 v[156:159], v[72:75], v[92:95], 0
  ds_read_b64_tr_b16 v[60:61], v4 offset:18496
  ds_read_b64_tr_b16 v[62:63], v4 offset:20800
  s_mov_b32 s3, 1179648
  buffer_load_dword v15, v13, s[12:15], s3 offen
  buffer_load_dword v15, v13, s[16:19], s3 offen
  s_waitcnt lgkmcnt(4)
  v_mfma_f32_16x16x32_bf16 v[160:163], v[76:79], v[80:83], 0
  v_mfma_f32_16x16x32_bf16 v[164:167], v[76:79], v[84:87], 0
  ds_read_b64_tr_b16 v[64:65], v5 offset:64
  ds_read_b64_tr_b16 v[66:67], v5 offset:2368
  v_mfma_f32_16x16x32_bf16 v[168:171], v[76:79], v[88:91], 0
  v_mfma_f32_16x16x32_bf16 v[172:175], v[76:79], v[92:95], 0
  ds_read_b64_tr_b16 v[68:69], v5 offset:18496
  ds_read_b64_tr_b16 v[70:71], v5 offset:20800
  s_waitcnt lgkmcnt(6)
  v_mfma_f32_16x16x32_bf16 v[176:179], v[56:59], v[80:83], 0
  s_mov_b32 s3, 1474560
  buffer_load_dword v15, v13, s[12:15], s3 offen
  buffer_load_dword v15, v13, s[16:19], s3 offen
  v_mfma_f32_16x16x32_bf16 v[180:183], v[56:59], v[84:87], 0
  v_mfma_f32_16x16x32_bf16 v[184:187], v[56:59], v[88:91], 0
  v_mfma_f32_16x16x32_bf16 v[188:191], v[56:59], v[92:95], 0
  s_waitcnt lgkmcnt(4)
  v_mfma_f32_16x16x32_bf16 v[192:195], v[60:63], v[80:83], 0
  v_mfma_f32_16x16x32_bf16 v[196:199], v[60:63], v[84:87], 0
  v_mfma_f32_16x16x32_bf16 v[200:203], v[60:63], v[88:91], 0
  v_mfma_f32_16x16x32_bf16 v[204:207], v[60:63], v[92:95], 0
  s_waitcnt lgkmcnt(0)
  s_barrier
  v_add_u32 v6, 36864, v6
  v_add_u32 v4, 36864, v4
  v_add_u32 v5, 36864, v5
  v_mfma_f32_16x16x32_bf16 v[208:211], v[64:67], v[80:83], 0
  ds_read_b128 v[96:99], v7 offset:8192
  ds_read_b128 v[100:103], v7 offset:9216
  v_mfma_f32_16x16x32_bf16 v[212:215], v[64:67], v[84:87], 0
  ds_read_b128 v[104:107], v8 offset:10240
  ds_read_b128 v[108:111], v8 offset:11264
  ds_read_b64_tr_b16 v[72:73], v6 offset:0
  ds_read_b64_tr_b16 v[74:75], v6 offset:2304
  s_mov_b32 s3, 1769472
  buffer_load_dword v15, v13, s[12:15], s3 offen
  buffer_load_dword v15, v13, s[16:19], s3 offen
  v_mfma_f32_16x16x32_bf16 v[216:219], v[64:67], v[88:91], 0
  v_mfma_f32_16x16x32_bf16 v[220:223], v[64:67], v[92:95], 0
  ds_read_b64_tr_b16 v[76:77], v6 offset:18432
  ds_read_b64_tr_b16 v[78:79], v6 offset:20736
  v_mfma_f32_16x16x32_bf16 v[224:227], v[68:71], v[80:83], 0
  s_mov_b32 s3, 384
  buffer_load_dword v15, v21, s[8:11], s3 offen
  v_mfma_f32_16x16x32_bf16 v[228:231], v[68:71], v[84:87], 0
  ds_read_b64_tr_b16 v[56:57], v4 offset:0
  ds_read_b64_tr_b16 v[58:59], v4 offset:2304
  v_mfma_f32_16x16x32_bf16 v[232:235], v[68:71], v[88:91], 0
  v_mfma_f32_16x16x32_bf16 v[236:239], v[68:71], v[92:95], 0
  s_waitcnt lgkmcnt(4)
  v_mfma_f32_16x16x32_bf16 v[240:243], v[72:75], v[96:99], v[240:243]
  s_and_b32 s53, s45, 7
  v_mfma_f32_16x16x32_bf16 v[244:247], v[72:75], v[100:103], v[244:247]
  ds_read_b64_tr_b16 v[60:61], v4 offset:18432
  ds_read_b64_tr_b16 v[62:63], v4 offset:20736
  s_waitcnt lgkmcnt(4)
  v_mfma_f32_16x16x32_bf16 v[248:251], v[76:79], v[96:99], v[248:251]
  s_lshl_b32 s54, s53, 2
  v_mfma_f32_16x16x32_bf16 v[252:255], v[76:79], v[100:103], v[252:255]
  s_waitcnt lgkmcnt(2)
  v_mfma_f32_16x16x32_bf16 v[112:115], v[56:59], v[96:99], v[112:115]
  s_add_u32 s54, s54, s51
  v_mfma_f32_16x16x32_bf16 v[116:119], v[56:59], v[100:103], v[116:119]
  ds_read_b64_tr_b16 v[64:65], v5 offset:0
  ds_read_b64_tr_b16 v[66:67], v5 offset:2304
  v_mfma_f32_16x16x32_bf16 v[120:123], v[56:59], v[104:107], v[120:123]
  s_mul_i32 s54, s54, 9
  v_mfma_f32_16x16x32_bf16 v[124:127], v[56:59], v[108:111], v[124:127]
  s_waitcnt lgkmcnt(2)
  v_mfma_f32_16x16x32_bf16 v[128:131], v[60:63], v[96:99], v[128:131]
  v_add_u32 v52, s54, v1
  v_mfma_f32_16x16x32_bf16 v[132:135], v[60:63], v[100:103], v[132:135]
  ds_read_b64_tr_b16 v[68:69], v5 offset:18432
  ds_read_b64_tr_b16 v[70:71], v5 offset:20736
  v_mfma_f32_16x16x32_bf16 v[136:139], v[60:63], v[104:107], v[136:139]
  s_mul_i32 s55, s46, 288
  v_mfma_f32_16x16x32_bf16 v[140:143], v[60:63], v[108:111], v[140:143]
  s_waitcnt lgkmcnt(2)
  v_mfma_f32_16x16x32_bf16 v[144:147], v[64:67], v[96:99], v[144:147]
  ds_read_b64_tr_b16 v[72:73], v4 offset:64
  ds_read_b64_tr_b16 v[74:75], v4 offset:2368
  v_mfma_f32_16x16x32_bf16 v[148:151], v[64:67], v[100:103], v[148:151]
  v_add_u32 v53, s55, v52
  v_mfma_f32_16x16x32_bf16 v[152:155], v[64:67], v[104:107], v[152:155]
  v_mfma_f32_16x16x32_bf16 v[156:159], v[64:67], v[108:111], v[156:159]
  ds_read_b64_tr_b16 v[76:77], v4 offset:18496
  ds_read_b64_tr_b16 v[78:79], v4 offset:20800
  v_mul_u32_u24 v53, 1152, v53
  s_waitcnt lgkmcnt(4)
  v_mfma_f32_16x16x32_bf16 v[160:163], v[68:71], v[96:99], v[160:163]
  v_mfma_f32_16x16x32_bf16 v[164:167], v[68:71], v[100:103], v[164:167]
  ds_read_b64_tr_b16 v[56:57], v5 offset:64
  ds_read_b64_tr_b16 v[58:59], v5 offset:2368
  v_cmp_gt_u32 vcc, 9, v1
  v_mfma_f32_16x16x32_bf16 v[168:171], v[68:71], v[104:107], v[168:171]
  v_mfma_f32_16x16x32_bf16 v[172:175], v[68:71], v[108:111], v[172:175]
  ds_read_b64_tr_b16 v[60:61], v5 offset:18496
  ds_read_b64_tr_b16 v[62:63], v5 offset:20800
  v_cndmask_b32 v53, v20, v53, vcc
  s_waitcnt lgkmcnt(6)
  v_mfma_f32_16x16x32_bf16 v[176:179], v[72:75], v[96:99], v[176:179]
  v_mfma_f32_16x16x32_bf16 v[180:183], v[72:75], v[100:103], v[180:183]
  v_cmp_gt_u32 vcc, 288, v52
  v_mfma_f32_16x16x32_bf16 v[184:187], v[72:75], v[104:107], v[184:187]
  v_mfma_f32_16x16x32_bf16 v[188:191], v[72:75], v[108:111], v[188:191]
  v_cndmask_b32 v14, v20, v53, vcc
  s_waitcnt lgkmcnt(4)
  v_mfma_f32_16x16x32_bf16 v[192:195], v[76:79], v[96:99], v[192:195]
  v_mfma_f32_16x16x32_bf16 v[196:199], v[76:79], v[100:103], v[196:199]
  v_mfma_f32_16x16x32_bf16 v[200:203], v[76:79], v[104:107], v[200:203]
  v_mfma_f32_16x16x32_bf16 v[204:207], v[76:79], v[108:111], v[204:207]
  s_waitcnt lgkmcnt(0)
  s_barrier
  v_add_u32 v6, 36864, v6
  v_add_u32 v4, 36864, v4
  v_add_u32 v5, 36864, v5
  v_mfma_f32_16x16x32_bf16 v[208:211], v[56:59], v[96:99], v[208:211]
  ds_read_b128 v[80:83], v7 offset:16384
  ds_read_b128 v[84:87], v7 offset:17408
  v_mfma_f32_16x16x32_bf16 v[212:215], v[56:59], v[100:103], v[212:215]
  ds_read_b128 v[88:91], v8 offset:18432
  ds_read_b128 v[92:95], v8 offset:19456
  ds_read_b64_tr_b16 v[64:65], v6 offset:0
  ds_read_b64_tr_b16 v[66:67], v6 offset:2304
  s_mov_b32 s3, 2064384
  buffer_load_dword v15, v13, s[12:15], s3 offen
  buffer_load_dword v15, v13, s[16:19], s3 offen
  v_mfma_f32_16x16x32_bf16 v[216:219], v[56:59], v[104:107], v[216:219]
  v_mfma_f32_16x16x32_bf16 v[220:223], v[56:59], v[108:111], v[220:223]
  ds_read_b64_tr_b16 v[68:69], v6 offset:18432
  ds_read_b64_tr_b16 v[70:71], v6 offset:20736
  v_mfma_f32_16x16x32_bf16 v[224:227], v[60:63], v[96:99], v[224:227]
  v_mfma_f32_16x16x32_bf16 v[228:231], v[60:63], v[100:103], v[228:231]
  ds_read_b64_tr_b16 v[72:73], v4 offset:0
  ds_read_b64_tr_b16 v[74:75], v4 offset:2304
  v_mfma_f32_16x16x32_bf16 v[232:235], v[60:63], v[104:107], v[232:235]
  v_mfma_f32_16x16x32_bf16 v[236:239], v[60:63], v[108:111], v[236:239]
  s_waitcnt lgkmcnt(4)
  v_mfma_f32_16x16x32_bf16 v[240:243], v[64:67], v[80:83], v[240:243]
  s_mul_i32 s53, s46, 288
  s_lshl_b32 s54, s44, 3
  v_mfma_f32_16x16x32_bf16 v[244:247], v[64:67], v[84:87], v[244:247]
  ds_read_b64_tr_b16 v[76:77], v4 offset:18432
  ds_read_b64_tr_b16 v[78:79], v4 offset:20736
  s_add_u32 s53, s53, s54
  s_waitcnt lgkmcnt(4)
  v_mfma_f32_16x16x32_bf16 v[248:251], v[68:71], v[80:83], v[248:251]
  v_lshrrev_b32 v52, 3, v1
  v_add_u32 v53, s53, v52
  v_mfma_f32_16x16x32_bf16 v[252:255], v[68:71], v[84:87], v[252:255]
  v_mul_u32_u24 v53, 1152, v53
  s_waitcnt lgkmcnt(2)
  v_mfma_f32_16x16x32_bf16 v[112:115], v[72:75], v[80:83], v[112:115]
  v_bfe_u32 v54, v1, 1, 2
  v_bfe_u32 v55, v1, 4, 1
  v_mfma_f32_16x16x32_bf16 v[116:119], v[72:75], v[84:87], v[116:119]
  ds_read_b64_tr_b16 v[56:57], v5 offset:0
  ds_read_b64_tr_b16 v[58:59], v5 offset:2304
  s_and_b32 s54, s44, 1
  v_mfma_f32_16x16x32_bf16 v[120:123], v[72:75], v[88:91], v[120:123]
  s_lshl_b32 s54, s54, 1
  v_mfma_f32_16x16x32_bf16 v[124:127], v[72:75], v[92:95], v[124:127]
  v_or_b32 v16, s54, v55
  v_xor_b32 v16, v54, v16
  s_waitcnt lgkmcnt(2)
  v_mfma_f32_16x16x32_bf16 v[128:131], v[76:79], v[80:83], v[128:131]
  v_lshlrev_b32 v16, 5, v16
  v_mfma_f32_16x16x32_bf16 v[132:135], v[76:79], v[84:87], v[132:135]
  ds_read_b64_tr_b16 v[60:61], v5 offset:18432
  ds_read_b64_tr_b16 v[62:63], v5 offset:20736
  v_and_b32 v17, 1, v1
  v_lshlrev_b32 v17, 4, v17
  v_mfma_f32_16x16x32_bf16 v[136:139], v[76:79], v[88:91], v[136:139]
  v_add_u32 v16, v16, v17
  v_mfma_f32_16x16x32_bf16 v[140:143], v[76:79], v[92:95], v[140:143]
  v_add_u32 v16, v53, v16
  s_lshr_b32 s53, s44, 1
  s_waitcnt lgkmcnt(2)
  v_mfma_f32_16x16x32_bf16 v[144:147], v[56:59], v[80:83], v[144:147]
  ds_read_b64_tr_b16 v[64:65], v4 offset:64
  ds_read_b64_tr_b16 v[66:67], v4 offset:2368
  s_add_u32 s53, s53, 32
  v_mfma_f32_16x16x32_bf16 v[148:151], v[56:59], v[84:87], v[148:151]
  s_and_b32 s54, s44, 1
  v_mfma_f32_16x16x32_bf16 v[152:155], v[56:59], v[88:91], v[152:155]
  s_lshl_b32 s52, s53, 10
  s_lshl_b32 s55, s54, 9
  v_mfma_f32_16x16x32_bf16 v[156:159], v[56:59], v[92:95], v[156:159]
  ds_read_b64_tr_b16 v[68:69], v4 offset:18496
  ds_read_b64_tr_b16 v[70:71], v4 offset:20800
  s_add_u32 s52, s52, s55
  s_waitcnt lgkmcnt(4)
  v_mfma_f32_16x16x32_bf16 v[160:163], v[60:63], v[80:83], v[160:163]
  s_lshl_b32 s55, s53, 3
  s_lshl_b32 s54, s54, 2
  v_mfma_f32_16x16x32_bf16 v[164:167], v[60:63], v[84:87], v[164:167]
  ds_read_b64_tr_b16 v[72:73], v5 offset:64
  ds_read_b64_tr_b16 v[74:75], v5 offset:2368
  s_add_u32 s55, s55, s54
  v_mfma_f32_16x16x32_bf16 v[168:171], v[60:63], v[88:91], v[168:171]
  s_mul_i32 s54, s46, 288
  s_add_u32 s55, s55, s54
  v_mfma_f32_16x16x32_bf16 v[172:175], v[60:63], v[92:95], v[172:175]
  ds_read_b64_tr_b16 v[76:77], v5 offset:18496
  ds_read_b64_tr_b16 v[78:79], v5 offset:20800
  v_add_u32 v53, s55, v52
  s_waitcnt lgkmcnt(6)
  v_mfma_f32_16x16x32_bf16 v[176:179], v[64:67], v[80:83], v[176:179]
  v_mul_u32_u24 v53, 1152, v53
  v_mfma_f32_16x16x32_bf16 v[180:183], v[64:67], v[84:87], v[180:183]
  s_and_b32 s53, s53, 1
  s_lshl_b32 s53, s53, 1
  v_mfma_f32_16x16x32_bf16 v[184:187], v[64:67], v[88:91], v[184:187]
  v_or_b32 v52, s53, v55
  v_mfma_f32_16x16x32_bf16 v[188:191], v[64:67], v[92:95], v[188:191]
  v_xor_b32 v52, v54, v52
  v_lshlrev_b32 v52, 5, v52
  s_waitcnt lgkmcnt(4)
  v_mfma_f32_16x16x32_bf16 v[192:195], v[68:71], v[80:83], v[192:195]
  v_add_u32 v52, v52, v17
  v_mfma_f32_16x16x32_bf16 v[196:199], v[68:71], v[84:87], v[196:199]
  v_add_u32 v17, v53, v52
  v_mfma_f32_16x16x32_bf16 v[200:203], v[68:71], v[88:91], v[200:203]
  v_mfma_f32_16x16x32_bf16 v[204:207], v[68:71], v[92:95], v[204:207]
  s_waitcnt lgkmcnt(0)
  s_barrier
  v_subrev_u32 v6, 73728, v6
  v_subrev_u32 v4, 73728, v4
  v_subrev_u32 v5, 73728, v5
  v_mfma_f32_16x16x32_bf16 v[208:211], v[72:75], v[80:83], v[208:211]
  ds_read_b128 v[96:99], v7 offset:0
  ds_read_b128 v[100:103], v7 offset:1024
  v_mfma_f32_16x16x32_bf16 v[212:215], v[72:75], v[84:87], v[212:215]
  ds_read_b128 v[104:107], v8 offset:2048
  ds_read_b128 v[108:111], v8 offset:3072
  ds_read_b64_tr_b16 v[56:57], v6 offset:0
  ds_read_b64_tr_b16 v[58:59], v6 offset:2304
  s_mov_b32 s3, 2359296
  buffer_load_dword v15, v13, s[12:15], s3 offen
  buffer_load_dword v15, v13, s[16:19], s3 offen
  v_mfma_f32_16x16x32_bf16 v[216:219], v[72:75], v[88:91], v[216:219]
  v_mfma_f32_16x16x32_bf16 v[220:223], v[72:75], v[92:95], v[220:223]
  ds_read_b64_tr_b16 v[60:61], v6 offset:18432
  ds_read_b64_tr_b16 v[62:63], v6 offset:20736
  v_mfma_f32_16x16x32_bf16 v[224:227], v[76:79], v[80:83], v[224:227]
  s_mov_b32 s3, 512
  buffer_load_dword v15, v21, s[8:11], s3 offen
  v_mfma_f32_16x16x32_bf16 v[228:231], v[76:79], v[84:87], v[228:231]
  ds_read_b64_tr_b16 v[64:65], v4 offset:0
  ds_read_b64_tr_b16 v[66:67], v4 offset:2304
  v_mfma_f32_16x16x32_bf16 v[232:235], v[76:79], v[88:91], v[232:235]
  v_mfma_f32_16x16x32_bf16 v[236:239], v[76:79], v[92:95], v[236:239]
  s_waitcnt lgkmcnt(4)
  v_mfma_f32_16x16x32_bf16 v[240:243], v[56:59], v[96:99], v[240:243]
  v_bfe_u32 v52, v1, 2, 2
  v_lshlrev_b32 v53, 3, v3
  v_mfma_f32_16x16x32_bf16 v[244:247], v[56:59], v[100:103], v[244:247]
  ds_read_b64_tr_b16 v[68:69], v4 offset:18432
  ds_read_b64_tr_b16 v[70:71], v4 offset:20736
  v_add_u32 v53, v53, v52
  s_waitcnt lgkmcnt(4)
  v_mfma_f32_16x16x32_bf16 v[248:251], v[60:63], v[96:99], v[248:251]
  v_lshlrev_b32 v53, 7, v53
  v_mfma_f32_16x16x32_bf16 v[252:255], v[60:63], v[100:103], v[252:255]
  v_lshrrev_b32 v54, 1, v52
  v_and_b32 v55, 1, v3
  s_waitcnt lgkmcnt(2)
  v_mfma_f32_16x16x32_bf16 v[112:115], v[64:67], v[96:99], v[112:115]
  v_lshlrev_b32 v55, 1, v55
  v_mfma_f32_16x16x32_bf16 v[116:119], v[64:67], v[100:103], v[116:119]
  ds_read_b64_tr_b16 v[72:73], v5 offset:0
  ds_read_b64_tr_b16 v[74:75], v5 offset:2304
  v_or_b32 v54, v54, v55
  v_mfma_f32_16x16x32_bf16 v[120:123], v[64:67], v[104:107], v[120:123]
  v_xor_b32 v54, s51, v54
  v_lshlrev_b32 v54, 5, v54
  v_mfma_f32_16x16x32_bf16 v[124:127], v[64:67], v[108:111], v[124:127]
  v_add_u32 v53, v53, v54
  s_waitcnt lgkmcnt(2)
  v_mfma_f32_16x16x32_bf16 v[128:131], v[68:71], v[96:99], v[128:131]
  v_and_b32 v54, 3, v1
  v_mfma_f32_16x16x32_bf16 v[132:135], v[68:71], v[100:103], v[132:135]
  ds_read_b64_tr_b16 v[76:77], v5 offset:18432
  ds_read_b64_tr_b16 v[78:79], v5 offset:20736
  v_lshlrev_b32 v54, 3, v54
  v_add_u32 v18, v53, v54
  v_mfma_f32_16x16x32_bf16 v[136:139], v[68:71], v[104:107], v[136:139]
  v_and_b32 v52, 1, v3
  v_mfma_f32_16x16x32_bf16 v[140:143], v[68:71], v[108:111], v[140:143]
  v_lshlrev_b32 v52, 1, v52
  s_waitcnt lgkmcnt(2)
  v_mfma_f32_16x16x32_bf16 v[144:147], v[72:75], v[96:99], v[144:147]
  ds_read_b64_tr_b16 v[56:57], v4 offset:64
  ds_read_b64_tr_b16 v[58:59], v4 offset:2368
  v_lshrrev_b32 v53, 3, v2
  v_mfma_f32_16x16x32_bf16 v[148:151], v[72:75], v[100:103], v[148:151]
  v_add_u32 v52, v52, v53
  s_lshl_b32 s53, s50, 3
  v_mfma_f32_16x16x32_bf16 v[152:155], v[72:75], v[104:107], v[152:155]
  v_add_u32 v52, s53, v52
  v_mfma_f32_16x16x32_bf16 v[156:159], v[72:75], v[108:111], v[156:159]
  ds_read_b64_tr_b16 v[60:61], v4 offset:18496
  ds_read_b64_tr_b16 v[62:63], v4 offset:20800
  s_mov_b32 s53, 147456
  s_waitcnt lgkmcnt(4)
  v_mfma_f32_16x16x32_bf16 v[160:163], v[76:79], v[96:99], v[160:163]
  v_mul_lo_u32 v52, v52, s53
  v_lshrrev_b32 v53, 1, v3
  v_mfma_f32_16x16x32_bf16 v[164:167], v[76:79], v[100:103], v[164:167]
  ds_read_b64_tr_b16 v[64:65], v5 offset:64
  ds_read_b64_tr_b16 v[66:67], v5 offset:2368
  v_lshlrev_b32 v53, 7, v53
  v_mfma_f32_16x16x32_bf16 v[168:171], v[76:79], v[104:107], v[168:171]
  v_and_b32 v54, 7, v2
  v_mfma_f32_16x16x32_bf16 v[172:175], v[76:79], v[108:111], v[172:175]
  ds_read_b64_tr_b16 v[68:69], v5 offset:18496
  ds_read_b64_tr_b16 v[70:71], v5 offset:20800
  v_lshlrev_b32 v54, 4, v54
  v_add_u32 v53, v53, v54
  s_waitcnt lgkmcnt(6)
  v_mfma_f32_16x16x32_bf16 v[176:179], v[56:59], v[96:99], v[176:179]
  s_lshl_b32 s53, s51, 8
  v_mfma_f32_16x16x32_bf16 v[180:183], v[56:59], v[100:103], v[180:183]
  v_add_u32 v53, s53, v53
  v_mfma_f32_16x16x32_bf16 v[184:187], v[56:59], v[104:107], v[184:187]
  v_add_u32 v19, v52, v53
  s_mul_i32 s56, s45, 2359296
  v_mfma_f32_16x16x32_bf16 v[188:191], v[56:59], v[108:111], v[188:191]
  s_lshl_b32 s53, s46, 10
  s_waitcnt lgkmcnt(4)
  v_mfma_f32_16x16x32_bf16 v[192:195], v[60:63], v[96:99], v[192:195]
  s_add_u32 s56, s56, s53
  v_mfma_f32_16x16x32_bf16 v[196:199], v[60:63], v[100:103], v[196:199]
  s_add_u32 s56, s56, 201326592
  v_mfma_f32_16x16x32_bf16 v[200:203], v[60:63], v[104:107], v[200:203]
  v_mfma_f32_16x16x32_bf16 v[204:207], v[60:63], v[108:111], v[204:207]
  s_waitcnt lgkmcnt(0)
  s_barrier
  v_add_u32 v6, 36864, v6
  v_add_u32 v4, 36864, v4
  v_add_u32 v5, 36864, v5
  v_mfma_f32_16x16x32_bf16 v[208:211], v[64:67], v[96:99], v[208:211]
  ds_read_b128 v[80:83], v7 offset:8192
  ds_read_b128 v[84:87], v7 offset:9216
  v_mfma_f32_16x16x32_bf16 v[212:215], v[64:67], v[100:103], v[212:215]
  ds_read_b128 v[88:91], v8 offset:10240
  ds_read_b128 v[92:95], v8 offset:11264
  ds_read_b64_tr_b16 v[72:73], v6 offset:0
  ds_read_b64_tr_b16 v[74:75], v6 offset:2304
  s_mov_b32 s3, 2654208
  buffer_load_dword v15, v13, s[12:15], s3 offen
  buffer_load_dword v15, v13, s[16:19], s3 offen
  v_mfma_f32_16x16x32_bf16 v[216:219], v[64:67], v[104:107], v[216:219]
  v_mfma_f32_16x16x32_bf16 v[220:223], v[64:67], v[108:111], v[220:223]
  ds_read_b64_tr_b16 v[76:77], v6 offset:18432
  ds_read_b64_tr_b16 v[78:79], v6 offset:20736
  v_mfma_f32_16x16x32_bf16 v[224:227], v[68:71], v[96:99], v[224:227]
  v_mfma_f32_16x16x32_bf16 v[228:231], v[68:71], v[100:103], v[228:231]
  ds_read_b64_tr_b16 v[56:57], v4 offset:0
  ds_read_b64_tr_b16 v[58:59], v4 offset:2304
  v_mfma_f32_16x16x32_bf16 v[232:235], v[68:71], v[104:107], v[232:235]
  v_mfma_f32_16x16x32_bf16 v[236:239], v[68:71], v[108:111], v[236:239]
  s_waitcnt lgkmcnt(4)
  v_mfma_f32_16x16x32_bf16 v[240:243], v[72:75], v[80:83], v[240:243]
  v_mfma_f32_16x16x32_bf16 v[244:247], v[72:75], v[84:87], v[244:247]
  ds_read_b64_tr_b16 v[60:61], v4 offset:18432
  ds_read_b64_tr_b16 v[62:63], v4 offset:20736
  s_waitcnt lgkmcnt(4)
  v_mfma_f32_16x16x32_bf16 v[248:251], v[76:79], v[80:83], v[248:251]
  v_mfma_f32_16x16x32_bf16 v[252:255], v[76:79], v[84:87], v[252:255]
  s_waitcnt lgkmcnt(2)
  v_mfma_f32_16x16x32_bf16 v[112:115], v[56:59], v[80:83], v[112:115]
  v_mfma_f32_16x16x32_bf16 v[116:119], v[56:59], v[84:87], v[116:119]
  ds_read_b64_tr_b16 v[64:65], v5 offset:0
  ds_read_b64_tr_b16 v[66:67], v5 offset:2304
  v_mfma_f32_16x16x32_bf16 v[120:123], v[56:59], v[88:91], v[120:123]
  v_mfma_f32_16x16x32_bf16 v[124:127], v[56:59], v[92:95], v[124:127]
  s_waitcnt lgkmcnt(2)
  v_mfma_f32_16x16x32_bf16 v[128:131], v[60:63], v[80:83], v[128:131]
  v_mfma_f32_16x16x32_bf16 v[132:135], v[60:63], v[84:87], v[132:135]
  ds_read_b64_tr_b16 v[68:69], v5 offset:18432
  ds_read_b64_tr_b16 v[70:71], v5 offset:20736
  v_mfma_f32_16x16x32_bf16 v[136:139], v[60:63], v[88:91], v[136:139]
  v_mfma_f32_16x16x32_bf16 v[140:143], v[60:63], v[92:95], v[140:143]
  s_waitcnt lgkmcnt(2)
  v_mfma_f32_16x16x32_bf16 v[144:147], v[64:67], v[80:83], v[144:147]
  ds_read_b64_tr_b16 v[72:73], v4 offset:64
  ds_read_b64_tr_b16 v[74:75], v4 offset:2368
  v_mfma_f32_16x16x32_bf16 v[148:151], v[64:67], v[84:87], v[148:151]
  v_mfma_f32_16x16x32_bf16 v[152:155], v[64:67], v[88:91], v[152:155]
  v_mfma_f32_16x16x32_bf16 v[156:159], v[64:67], v[92:95], v[156:159]
  ds_read_b64_tr_b16 v[76:77], v4 offset:18496
  ds_read_b64_tr_b16 v[78:79], v4 offset:20800
  s_waitcnt lgkmcnt(4)
  v_mfma_f32_16x16x32_bf16 v[160:163], v[68:71], v[80:83], v[160:163]
  v_mfma_f32_16x16x32_bf16 v[164:167], v[68:71], v[84:87], v[164:167]
  ds_read_b64_tr_b16 v[56:57], v5 offset:64
  ds_read_b64_tr_b16 v[58:59], v5 offset:2368
  v_mfma_f32_16x16x32_bf16 v[168:171], v[68:71], v[88:91], v[168:171]
  v_mfma_f32_16x16x32_bf16 v[172:175], v[68:71], v[92:95], v[172:175]
  ds_read_b64_tr_b16 v[60:61], v5 offset:18496
  ds_read_b64_tr_b16 v[62:63], v5 offset:20800
  s_waitcnt lgkmcnt(6)
  v_mfma_f32_16x16x32_bf16 v[176:179], v[72:75], v[80:83], v[176:179]
  v_mfma_f32_16x16x32_bf16 v[180:183], v[72:75], v[84:87], v[180:183]
  v_mfma_f32_16x16x32_bf16 v[184:187], v[72:75], v[88:91], v[184:187]
  v_mfma_f32_16x16x32_bf16 v[188:191], v[72:75], v[92:95], v[188:191]
  s_waitcnt lgkmcnt(4)
  v_mfma_f32_16x16x32_bf16 v[192:195], v[76:79], v[80:83], v[192:195]
  v_mfma_f32_16x16x32_bf16 v[196:199], v[76:79], v[84:87], v[196:199]
  v_mfma_f32_16x16x32_bf16 v[200:203], v[76:79], v[88:91], v[200:203]
  v_mfma_f32_16x16x32_bf16 v[204:207], v[76:79], v[92:95], v[204:207]
  s_waitcnt lgkmcnt(0)
  s_barrier
  v_add_u32 v6, 36864, v6
  v_add_u32 v4, 36864, v4
  v_add_u32 v5, 36864, v5
  v_mfma_f32_16x16x32_bf16 v[208:211], v[56:59], v[80:83], v[208:211]
  ds_read_b128 v[96:99], v7 offset:16384
  ds_read_b128 v[100:103], v7 offset:17408
  v_mfma_f32_16x16x32_bf16 v[212:215], v[56:59], v[84:87], v[212:215]
  ds_read_b128 v[104:107], v8 offset:18432
  ds_read_b128 v[108:111], v8 offset:19456
  ds_read_b64_tr_b16 v[64:65], v6 offset:0
  ds_read_b64_tr_b16 v[66:67], v6 offset:2304
  s_mov_b32 s3, 2949120
  buffer_load_dword v15, v13, s[12:15], s3 offen
  buffer_load_dword v15, v13, s[16:19], s3 offen
  v_mfma_f32_16x16x32_bf16 v[216:219], v[56:59], v[88:91], v[216:219]
  v_mfma_f32_16x16x32_bf16 v[220:223], v[56:59], v[92:95], v[220:223]
  ds_read_b64_tr_b16 v[68:69], v6 offset:18432
  ds_read_b64_tr_b16 v[70:71], v6 offset:20736
  v_mfma_f32_16x16x32_bf16 v[224:227], v[60:63], v[80:83], v[224:227]
  s_mov_b32 s3, 640
  buffer_load_dword v15, v21, s[8:11], s3 offen
  v_mfma_f32_16x16x32_bf16 v[228:231], v[60:63], v[84:87], v[228:231]
  ds_read_b64_tr_b16 v[72:73], v4 offset:0
  ds_read_b64_tr_b16 v[74:75], v4 offset:2304
  v_mfma_f32_16x16x32_bf16 v[232:235], v[60:63], v[88:91], v[232:235]
  v_mfma_f32_16x16x32_bf16 v[236:239], v[60:63], v[92:95], v[236:239]
  s_waitcnt lgkmcnt(4)
  v_mfma_f32_16x16x32_bf16 v[240:243], v[64:67], v[96:99], v[240:243]
  v_mfma_f32_16x16x32_bf16 v[244:247], v[64:67], v[100:103], v[244:247]
  ds_read_b64_tr_b16 v[76:77], v4 offset:18432
  ds_read_b64_tr_b16 v[78:79], v4 offset:20736
  s_waitcnt lgkmcnt(4)
  v_mfma_f32_16x16x32_bf16 v[248:251], v[68:71], v[96:99], v[248:251]
  v_mfma_f32_16x16x32_bf16 v[252:255], v[68:71], v[100:103], v[252:255]
  s_waitcnt lgkmcnt(2)
  v_mfma_f32_16x16x32_bf16 v[112:115], v[72:75], v[96:99], v[112:115]
  v_mfma_f32_16x16x32_bf16 v[116:119], v[72:75], v[100:103], v[116:119]
  ds_read_b64_tr_b16 v[56:57], v5 offset:0
  ds_read_b64_tr_b16 v[58:59], v5 offset:2304
  v_mfma_f32_16x16x32_bf16 v[120:123], v[72:75], v[104:107], v[120:123]
  v_mfma_f32_16x16x32_bf16 v[124:127], v[72:75], v[108:111], v[124:127]
  s_waitcnt lgkmcnt(2)
  v_mfma_f32_16x16x32_bf16 v[128:131], v[76:79], v[96:99], v[128:131]
  v_mfma_f32_16x16x32_bf16 v[132:135], v[76:79], v[100:103], v[132:135]
  ds_read_b64_tr_b16 v[60:61], v5 offset:18432
  ds_read_b64_tr_b16 v[62:63], v5 offset:20736
  v_mfma_f32_16x16x32_bf16 v[136:139], v[76:79], v[104:107], v[136:139]
  v_mfma_f32_16x16x32_bf16 v[140:143], v[76:79], v[108:111], v[140:143]
  s_waitcnt lgkmcnt(2)
  v_mfma_f32_16x16x32_bf16 v[144:147], v[56:59], v[96:99], v[144:147]
  ds_read_b64_tr_b16 v[64:65], v4 offset:64
  ds_read_b64_tr_b16 v[66:67], v4 offset:2368
  v_mfma_f32_16x16x32_bf16 v[148:151], v[56:59], v[100:103], v[148:151]
  v_mfma_f32_16x16x32_bf16 v[152:155], v[56:59], v[104:107], v[152:155]
  v_mfma_f32_16x16x32_bf16 v[156:159], v[56:59], v[108:111], v[156:159]
  ds_read_b64_tr_b16 v[68:69], v4 offset:18496
  ds_read_b64_tr_b16 v[70:71], v4 offset:20800
  s_waitcnt lgkmcnt(4)
  v_mfma_f32_16x16x32_bf16 v[160:163], v[60:63], v[96:99], v[160:163]
  v_mfma_f32_16x16x32_bf16 v[164:167], v[60:63], v[100:103], v[164:167]
  ds_read_b64_tr_b16 v[72:73], v5 offset:64
  ds_read_b64_tr_b16 v[74:75], v5 offset:2368
  v_mfma_f32_16x16x32_bf16 v[168:171], v[60:63], v[104:107], v[168:171]
  v_mfma_f32_16x16x32_bf16 v[172:175], v[60:63], v[108:111], v[172:175]
  ds_read_b64_tr_b16 v[76:77], v5 offset:18496
  ds_read_b64_tr_b16 v[78:79], v5 offset:20800
  s_waitcnt lgkmcnt(6)
  v_mfma_f32_16x16x32_bf16 v[176:179], v[64:67], v[96:99], v[176:179]
  v_mfma_f32_16x16x32_bf16 v[180:183], v[64:67], v[100:103], v[180:183]
  v_mfma_f32_16x16x32_bf16 v[184:187], v[64:67], v[104:107], v[184:187]
  v_mfma_f32_16x16x32_bf16 v[188:191], v[64:67], v[108:111], v[188:191]
  s_waitcnt lgkmcnt(4)
  v_mfma_f32_16x16x32_bf16 v[192:195], v[68:71], v[96:99], v[192:195]
  v_mfma_f32_16x16x32_bf16 v[196:199], v[68:71], v[100:103], v[196:199]
  v_mfma_f32_16x16x32_bf16 v[200:203], v[68:71], v[104:107], v[200:203]
  v_mfma_f32_16x16x32_bf16 v[204:207], v[68:71], v[108:111], v[204:207]
  s_waitcnt lgkmcnt(0)
  s_barrier
  v_subrev_u32 v6, 73728, v6
  v_subrev_u32 v4, 73728, v4
  v_subrev_u32 v5, 73728, v5
  v_mfma_f32_16x16x32_bf16 v[208:211], v[72:75], v[96:99], v[208:211]
  ds_read_b128 v[80:83], v7 offset:0
  ds_read_b128 v[84:87], v7 offset:1024
  v_mfma_f32_16x16x32_bf16 v[212:215], v[72:75], v[100:103], v[212:215]
  ds_read_b128 v[88:91], v8 offset:2048
  ds_read_b128 v[92:95], v8 offset:3072
  ds_read_b64_tr_b16 v[56:57], v6 offset:0
  ds_read_b64_tr_b16 v[58:59], v6 offset:2304
  s_mov_b32 s3, 3244032
  buffer_load_dword v15, v13, s[12:15], s3 offen
  buffer_load_dword v15, v13, s[16:19], s3 offen
  v_mfma_f32_16x16x32_bf16 v[216:219], v[72:75], v[104:107], v[216:219]
  v_mfma_f32_16x16x32_bf16 v[220:223], v[72:75], v[108:111], v[220:223]
  ds_read_b64_tr_b16 v[60:61], v6 offset:18432
  ds_read_b64_tr_b16 v[62:63], v6 offset:20736
  v_mfma_f32_16x16x32_bf16 v[224:227], v[76:79], v[96:99], v[224:227]
  v_mfma_f32_16x16x32_bf16 v[228:231], v[76:79], v[100:103], v[228:231]
  ds_read_b64_tr_b16 v[64:65], v4 offset:0
  ds_read_b64_tr_b16 v[66:67], v4 offset:2304
  v_mfma_f32_16x16x32_bf16 v[232:235], v[76:79], v[104:107], v[232:235]
  v_mfma_f32_16x16x32_bf16 v[236:239], v[76:79], v[108:111], v[236:239]
  s_waitcnt lgkmcnt(4)
  v_mfma_f32_16x16x32_bf16 v[240:243], v[56:59], v[80:83], v[240:243]
  v_mfma_f32_16x16x32_bf16 v[244:247], v[56:59], v[84:87], v[244:247]
  ds_read_b64_tr_b16 v[68:69], v4 offset:18432
  ds_read_b64_tr_b16 v[70:71], v4 offset:20736
  s_waitcnt lgkmcnt(4)
  v_mfma_f32_16x16x32_bf16 v[248:251], v[60:63], v[80:83], v[248:251]
  v_mfma_f32_16x16x32_bf16 v[252:255], v[60:63], v[84:87], v[252:255]
  s_waitcnt lgkmcnt(2)
  v_mfma_f32_16x16x32_bf16 v[112:115], v[64:67], v[80:83], v[112:115]
  v_mfma_f32_16x16x32_bf16 v[116:119], v[64:67], v[84:87], v[116:119]
  ds_read_b64_tr_b16 v[72:73], v5 offset:0
  ds_read_b64_tr_b16 v[74:75], v5 offset:2304
  v_mfma_f32_16x16x32_bf16 v[120:123], v[64:67], v[88:91], v[120:123]
  v_mfma_f32_16x16x32_bf16 v[124:127], v[64:67], v[92:95], v[124:127]
  s_waitcnt lgkmcnt(2)
  v_mfma_f32_16x16x32_bf16 v[128:131], v[68:71], v[80:83], v[128:131]
  v_mfma_f32_16x16x32_bf16 v[132:135], v[68:71], v[84:87], v[132:135]
  ds_read_b64_tr_b16 v[76:77], v5 offset:18432
  ds_read_b64_tr_b16 v[78:79], v5 offset:20736
  v_mfma_f32_16x16x32_bf16 v[136:139], v[68:71], v[88:91], v[136:139]
  v_mfma_f32_16x16x32_bf16 v[140:143], v[68:71], v[92:95], v[140:143]
  s_waitcnt lgkmcnt(2)
  v_mfma_f32_16x16x32_bf16 v[144:147], v[72:75], v[80:83], v[144:147]
  ds_read_b64_tr_b16 v[56:57], v4 offset:64
  ds_read_b64_tr_b16 v[58:59], v4 offset:2368
  v_mfma_f32_16x16x32_bf16 v[148:151], v[72:75], v[84:87], v[148:151]
  v_mfma_f32_16x16x32_bf16 v[152:155], v[72:75], v[88:91], v[152:155]
  v_mfma_f32_16x16x32_bf16 v[156:159], v[72:75], v[92:95], v[156:159]
  ds_read_b64_tr_b16 v[60:61], v4 offset:18496
  ds_read_b64_tr_b16 v[62:63], v4 offset:20800
  s_waitcnt lgkmcnt(4)
  v_mfma_f32_16x16x32_bf16 v[160:163], v[76:79], v[80:83], v[160:163]
  v_mfma_f32_16x16x32_bf16 v[164:167], v[76:79], v[84:87], v[164:167]
  ds_read_b64_tr_b16 v[64:65], v5 offset:64
  ds_read_b64_tr_b16 v[66:67], v5 offset:2368
  v_mfma_f32_16x16x32_bf16 v[168:171], v[76:79], v[88:91], v[168:171]
  v_mfma_f32_16x16x32_bf16 v[172:175], v[76:79], v[92:95], v[172:175]
  ds_read_b64_tr_b16 v[68:69], v5 offset:18496
  ds_read_b64_tr_b16 v[70:71], v5 offset:20800
  s_waitcnt lgkmcnt(6)
  v_mfma_f32_16x16x32_bf16 v[176:179], v[56:59], v[80:83], v[176:179]
  v_mfma_f32_16x16x32_bf16 v[180:183], v[56:59], v[84:87], v[180:183]
  v_mfma_f32_16x16x32_bf16 v[184:187], v[56:59], v[88:91], v[184:187]
  v_mfma_f32_16x16x32_bf16 v[188:191], v[56:59], v[92:95], v[188:191]
  s_waitcnt lgkmcnt(4)
  v_mfma_f32_16x16x32_bf16 v[192:195], v[60:63], v[80:83], v[192:195]
  v_mfma_f32_16x16x32_bf16 v[196:199], v[60:63], v[84:87], v[196:199]
  v_mfma_f32_16x16x32_bf16 v[200:203], v[60:63], v[88:91], v[200:203]
  v_mfma_f32_16x16x32_bf16 v[204:207], v[60:63], v[92:95], v[204:207]
  s_waitcnt lgkmcnt(0)
  s_barrier
  v_add_u32 v6, 36864, v6
  v_add_u32 v4, 36864, v4
  v_add_u32 v5, 36864, v5
  v_mfma_f32_16x16x32_bf16 v[208:211], v[64:67], v[80:83], v[208:211]
  ds_read_b128 v[96:99], v7 offset:8192
  ds_read_b128 v[100:103], v7 offset:9216
  v_mfma_f32_16x16x32_bf16 v[212:215], v[64:67], v[84:87], v[212:215]
  ds_read_b128 v[104:107], v8 offset:10240
  ds_read_b128 v[108:111], v8 offset:11264
  ds_read_b64_tr_b16 v[72:73], v6 offset:0
  ds_read_b64_tr_b16 v[74:75], v6 offset:2304
  s_mov_b32 s3, 3538944
  buffer_load_dword v15, v13, s[12:15], s3 offen
  buffer_load_dword v15, v13, s[16:19], s3 offen
  v_mfma_f32_16x16x32_bf16 v[216:219], v[64:67], v[88:91], v[216:219]
  v_mfma_f32_16x16x32_bf16 v[220:223], v[64:67], v[92:95], v[220:223]
  ds_read_b64_tr_b16 v[76:77], v6 offset:18432
  ds_read_b64_tr_b16 v[78:79], v6 offset:20736
  v_mfma_f32_16x16x32_bf16 v[224:227], v[68:71], v[80:83], v[224:227]
  s_mov_b32 s3, 768
  buffer_load_dword v15, v21, s[8:11], s3 offen
  v_mfma_f32_16x16x32_bf16 v[228:231], v[68:71], v[84:87], v[228:231]
  ds_read_b64_tr_b16 v[56:57], v4 offset:0
  ds_read_b64_tr_b16 v[58:59], v4 offset:2304
  v_mfma_f32_16x16x32_bf16 v[232:235], v[68:71], v[88:91], v[232:235]
  v_mfma_f32_16x16x32_bf16 v[236:239], v[68:71], v[92:95], v[236:239]
  s_waitcnt lgkmcnt(4)
  v_mfma_f32_16x16x32_bf16 v[240:243], v[72:75], v[96:99], v[240:243]
  v_mfma_f32_16x16x32_bf16 v[244:247], v[72:75], v[100:103], v[244:247]
  ds_read_b64_tr_b16 v[60:61], v4 offset:18432
  ds_read_b64_tr_b16 v[62:63], v4 offset:20736
  s_waitcnt lgkmcnt(4)
  v_mfma_f32_16x16x32_bf16 v[248:251], v[76:79], v[96:99], v[248:251]
  v_mfma_f32_16x16x32_bf16 v[252:255], v[76:79], v[100:103], v[252:255]
  s_waitcnt lgkmcnt(2)
  v_mfma_f32_16x16x32_bf16 v[112:115], v[56:59], v[96:99], v[112:115]
  v_mfma_f32_16x16x32_bf16 v[116:119], v[56:59], v[100:103], v[116:119]
  ds_read_b64_tr_b16 v[64:65], v5 offset:0
  ds_read_b64_tr_b16 v[66:67], v5 offset:2304
  v_mfma_f32_16x16x32_bf16 v[120:123], v[56:59], v[104:107], v[120:123]
  v_mfma_f32_16x16x32_bf16 v[124:127], v[56:59], v[108:111], v[124:127]
  s_waitcnt lgkmcnt(2)
  v_mfma_f32_16x16x32_bf16 v[128:131], v[60:63], v[96:99], v[128:131]
  v_mfma_f32_16x16x32_bf16 v[132:135], v[60:63], v[100:103], v[132:135]
  ds_read_b64_tr_b16 v[68:69], v5 offset:18432
  ds_read_b64_tr_b16 v[70:71], v5 offset:20736
  v_mfma_f32_16x16x32_bf16 v[136:139], v[60:63], v[104:107], v[136:139]
  v_mfma_f32_16x16x32_bf16 v[140:143], v[60:63], v[108:111], v[140:143]
  s_waitcnt lgkmcnt(2)
  v_mfma_f32_16x16x32_bf16 v[144:147], v[64:67], v[96:99], v[144:147]
  ds_read_b64_tr_b16 v[72:73], v4 offset:64
  ds_read_b64_tr_b16 v[74:75], v4 offset:2368
  v_mfma_f32_16x16x32_bf16 v[148:151], v[64:67], v[100:103], v[148:151]
  v_mfma_f32_16x16x32_bf16 v[152:155], v[64:67], v[104:107], v[152:155]
  v_mfma_f32_16x16x32_bf16 v[156:159], v[64:67], v[108:111], v[156:159]
  ds_read_b64_tr_b16 v[76:77], v4 offset:18496
  ds_read_b64_tr_b16 v[78:79], v4 offset:20800
  s_waitcnt lgkmcnt(4)
  v_mfma_f32_16x16x32_bf16 v[160:163], v[68:71], v[96:99], v[160:163]
  v_mfma_f32_16x16x32_bf16 v[164:167], v[68:71], v[100:103], v[164:167]
  ds_read_b64_tr_b16 v[56:57], v5 offset:64
  ds_read_b64_tr_b16 v[58:59], v5 offset:2368
  v_mfma_f32_16x16x32_bf16 v[168:171], v[68:71], v[104:107], v[168:171]
  v_mfma_f32_16x16x32_bf16 v[172:175], v[68:71], v[108:111], v[172:175]
  ds_read_b64_tr_b16 v[60:61], v5 offset:18496
  ds_read_b64_tr_b16 v[62:63], v5 offset:20800
  s_waitcnt lgkmcnt(6)
  v_mfma_f32_16x16x32_bf16 v[176:179], v[72:75], v[96:99], v[176:179]
  v_mfma_f32_16x16x32_bf16 v[180:183], v[72:75], v[100:103], v[180:183]
  v_mfma_f32_16x16x32_bf16 v[184:187], v[72:75], v[104:107], v[184:187]
  v_mfma_f32_16x16x32_bf16 v[188:191], v[72:75], v[108:111], v[188:191]
  s_waitcnt lgkmcnt(4)
  v_mfma_f32_16x16x32_bf16 v[192:195], v[76:79], v[96:99], v[192:195]
  v_mfma_f32_16x16x32_bf16 v[196:199], v[76:79], v[100:103], v[196:199]
  v_mfma_f32_16x16x32_bf16 v[200:203], v[76:79], v[104:107], v[200:203]
  v_mfma_f32_16x16x32_bf16 v[204:207], v[76:79], v[108:111], v[204:207]
  s_waitcnt lgkmcnt(0)
  s_barrier
  v_add_u32 v6, 36864, v6
  v_add_u32 v4, 36864, v4
  v_add_u32 v5, 36864, v5
  v_mfma_f32_16x16x32_bf16 v[208:211], v[56:59], v[96:99], v[208:211]
  ds_read_b128 v[80:83], v7 offset:16384
  ds_read_b128 v[84:87], v7 offset:17408
  v_mfma_f32_16x16x32_bf16 v[212:215], v[56:59], v[100:103], v[212:215]
  ds_read_b128 v[88:91], v8 offset:18432
  ds_read_b128 v[92:95], v8 offset:19456
  ds_read_b64_tr_b16 v[64:65], v6 offset:0
  ds_read_b64_tr_b16 v[66:67], v6 offset:2304
  s_mov_b32 s3, 3833856
  buffer_load_dword v15, v13, s[12:15], s3 offen
  buffer_load_dword v15, v13, s[16:19], s3 offen
  v_mfma_f32_16x16x32_bf16 v[216:219], v[56:59], v[104:107], v[216:219]
  v_mfma_f32_16x16x32_bf16 v[220:223], v[56:59], v[108:111], v[220:223]
  ds_read_b64_tr_b16 v[68:69], v6 offset:18432
  ds_read_b64_tr_b16 v[70:71], v6 offset:20736
  v_mfma_f32_16x16x32_bf16 v[224:227], v[60:63], v[96:99], v[224:227]
  v_mfma_f32_16x16x32_bf16 v[228:231], v[60:63], v[100:103], v[228:231]
  ds_read_b64_tr_b16 v[72:73], v4 offset:0
  ds_read_b64_tr_b16 v[74:75], v4 offset:2304
  v_mfma_f32_16x16x32_bf16 v[232:235], v[60:63], v[104:107], v[232:235]
  v_mfma_f32_16x16x32_bf16 v[236:239], v[60:63], v[108:111], v[236:239]
  s_waitcnt lgkmcnt(4)
  v_mfma_f32_16x16x32_bf16 v[240:243], v[64:67], v[80:83], v[240:243]
  v_mfma_f32_16x16x32_bf16 v[244:247], v[64:67], v[84:87], v[244:247]
  ds_read_b64_tr_b16 v[76:77], v4 offset:18432
  ds_read_b64_tr_b16 v[78:79], v4 offset:20736
  s_waitcnt lgkmcnt(4)
  v_mfma_f32_16x16x32_bf16 v[248:251], v[68:71], v[80:83], v[248:251]
  v_mfma_f32_16x16x32_bf16 v[252:255], v[68:71], v[84:87], v[252:255]
  s_waitcnt lgkmcnt(2)
  v_mfma_f32_16x16x32_bf16 v[112:115], v[72:75], v[80:83], v[112:115]
  v_mfma_f32_16x16x32_bf16 v[116:119], v[72:75], v[84:87], v[116:119]
  ds_read_b64_tr_b16 v[56:57], v5 offset:0
  ds_read_b64_tr_b16 v[58:59], v5 offset:2304
  v_mfma_f32_16x16x32_bf16 v[120:123], v[72:75], v[88:91], v[120:123]
  v_mfma_f32_16x16x32_bf16 v[124:127], v[72:75], v[92:95], v[124:127]
  s_waitcnt lgkmcnt(2)
  v_mfma_f32_16x16x32_bf16 v[128:131], v[76:79], v[80:83], v[128:131]
  v_mfma_f32_16x16x32_bf16 v[132:135], v[76:79], v[84:87], v[132:135]
  ds_read_b64_tr_b16 v[60:61], v5 offset:18432
  ds_read_b64_tr_b16 v[62:63], v5 offset:20736
  v_mfma_f32_16x16x32_bf16 v[136:139], v[76:79], v[88:91], v[136:139]
  v_mfma_f32_16x16x32_bf16 v[140:143], v[76:79], v[92:95], v[140:143]
  s_waitcnt lgkmcnt(2)
  v_mfma_f32_16x16x32_bf16 v[144:147], v[56:59], v[80:83], v[144:147]
  ds_read_b64_tr_b16 v[64:65], v4 offset:64
  ds_read_b64_tr_b16 v[66:67], v4 offset:2368
  v_mfma_f32_16x16x32_bf16 v[148:151], v[56:59], v[84:87], v[148:151]
  v_mfma_f32_16x16x32_bf16 v[152:155], v[56:59], v[88:91], v[152:155]
  v_mfma_f32_16x16x32_bf16 v[156:159], v[56:59], v[92:95], v[156:159]
  ds_read_b64_tr_b16 v[68:69], v4 offset:18496
  ds_read_b64_tr_b16 v[70:71], v4 offset:20800
  s_waitcnt lgkmcnt(4)
  v_mfma_f32_16x16x32_bf16 v[160:163], v[60:63], v[80:83], v[160:163]
  v_mfma_f32_16x16x32_bf16 v[164:167], v[60:63], v[84:87], v[164:167]
  ds_read_b64_tr_b16 v[72:73], v5 offset:64
  ds_read_b64_tr_b16 v[74:75], v5 offset:2368
  v_mfma_f32_16x16x32_bf16 v[168:171], v[60:63], v[88:91], v[168:171]
  v_mfma_f32_16x16x32_bf16 v[172:175], v[60:63], v[92:95], v[172:175]
  ds_read_b64_tr_b16 v[76:77], v5 offset:18496
  ds_read_b64_tr_b16 v[78:79], v5 offset:20800
  s_waitcnt lgkmcnt(6)
  v_mfma_f32_16x16x32_bf16 v[176:179], v[64:67], v[80:83], v[176:179]
  v_mfma_f32_16x16x32_bf16 v[180:183], v[64:67], v[84:87], v[180:183]
  v_mfma_f32_16x16x32_bf16 v[184:187], v[64:67], v[88:91], v[184:187]
  v_mfma_f32_16x16x32_bf16 v[188:191], v[64:67], v[92:95], v[188:191]
  s_waitcnt lgkmcnt(4)
  v_mfma_f32_16x16x32_bf16 v[192:195], v[68:71], v[80:83], v[192:195]
  v_mfma_f32_16x16x32_bf16 v[196:199], v[68:71], v[84:87], v[196:199]
  v_mfma_f32_16x16x32_bf16 v[200:203], v[68:71], v[88:91], v[200:203]
  v_mfma_f32_16x16x32_bf16 v[204:207], v[68:71], v[92:95], v[204:207]
  s_waitcnt lgkmcnt(0)
  s_barrier
  v_subrev_u32 v6, 73728, v6
  v_subrev_u32 v4, 73728, v4
  v_subrev_u32 v5, 73728, v5
  v_mfma_f32_16x16x32_bf16 v[208:211], v[72:75], v[80:83], v[208:211]
  ds_read_b128 v[96:99], v7 offset:0
  ds_read_b128 v[100:103], v7 offset:1024
  v_mfma_f32_16x16x32_bf16 v[212:215], v[72:75], v[84:87], v[212:215]
  ds_read_b128 v[104:107], v8 offset:2048
  ds_read_b128 v[108:111], v8 offset:3072
  ds_read_b64_tr_b16 v[56:57], v6 offset:0
  ds_read_b64_tr_b16 v[58:59], v6 offset:2304
  s_mov_b32 s3, 4128768
  buffer_load_dword v15, v13, s[12:15], s3 offen
  buffer_load_dword v15, v13, s[16:19], s3 offen
  v_mfma_f32_16x16x32_bf16 v[216:219], v[72:75], v[88:91], v[216:219]
  v_mfma_f32_16x16x32_bf16 v[220:223], v[72:75], v[92:95], v[220:223]
  ds_read_b64_tr_b16 v[60:61], v6 offset:18432
  ds_read_b64_tr_b16 v[62:63], v6 offset:20736
  v_mfma_f32_16x16x32_bf16 v[224:227], v[76:79], v[80:83], v[224:227]
  s_mov_b32 s3, 896
  buffer_load_dword v15, v21, s[8:11], s3 offen
  v_mfma_f32_16x16x32_bf16 v[228:231], v[76:79], v[84:87], v[228:231]
  ds_read_b64_tr_b16 v[64:65], v4 offset:0
  ds_read_b64_tr_b16 v[66:67], v4 offset:2304
  v_mfma_f32_16x16x32_bf16 v[232:235], v[76:79], v[88:91], v[232:235]
  v_mfma_f32_16x16x32_bf16 v[236:239], v[76:79], v[92:95], v[236:239]
  s_waitcnt lgkmcnt(4)
  v_mfma_f32_16x16x32_bf16 v[240:243], v[56:59], v[96:99], v[240:243]
  v_mfma_f32_16x16x32_bf16 v[244:247], v[56:59], v[100:103], v[244:247]
  ds_read_b64_tr_b16 v[68:69], v4 offset:18432
  ds_read_b64_tr_b16 v[70:71], v4 offset:20736
  s_waitcnt lgkmcnt(4)
  v_mfma_f32_16x16x32_bf16 v[248:251], v[60:63], v[96:99], v[248:251]
  v_mfma_f32_16x16x32_bf16 v[252:255], v[60:63], v[100:103], v[252:255]
  s_waitcnt lgkmcnt(2)
  v_mfma_f32_16x16x32_bf16 v[112:115], v[64:67], v[96:99], v[112:115]
  v_mfma_f32_16x16x32_bf16 v[116:119], v[64:67], v[100:103], v[116:119]
  ds_read_b64_tr_b16 v[72:73], v5 offset:0
  ds_read_b64_tr_b16 v[74:75], v5 offset:2304
  v_mfma_f32_16x16x32_bf16 v[120:123], v[64:67], v[104:107], v[120:123]
  v_mfma_f32_16x16x32_bf16 v[124:127], v[64:67], v[108:111], v[124:127]
  s_waitcnt lgkmcnt(2)
  v_mfma_f32_16x16x32_bf16 v[128:131], v[68:71], v[96:99], v[128:131]
  v_mfma_f32_16x16x32_bf16 v[132:135], v[68:71], v[100:103], v[132:135]
  ds_read_b64_tr_b16 v[76:77], v5 offset:18432
  ds_read_b64_tr_b16 v[78:79], v5 offset:20736
  v_mfma_f32_16x16x32_bf16 v[136:139], v[68:71], v[104:107], v[136:139]
  v_mfma_f32_16x16x32_bf16 v[140:143], v[68:71], v[108:111], v[140:143]
  s_waitcnt lgkmcnt(2)
  v_mfma_f32_16x16x32_bf16 v[144:147], v[72:75], v[96:99], v[144:147]
  ds_read_b64_tr_b16 v[56:57], v4 offset:64
  ds_read_b64_tr_b16 v[58:59], v4 offset:2368
  v_mfma_f32_16x16x32_bf16 v[148:151], v[72:75], v[100:103], v[148:151]
  v_mfma_f32_16x16x32_bf16 v[152:155], v[72:75], v[104:107], v[152:155]
  v_mfma_f32_16x16x32_bf16 v[156:159], v[72:75], v[108:111], v[156:159]
  ds_read_b64_tr_b16 v[60:61], v4 offset:18496
  ds_read_b64_tr_b16 v[62:63], v4 offset:20800
  s_waitcnt lgkmcnt(4)
  v_mfma_f32_16x16x32_bf16 v[160:163], v[76:79], v[96:99], v[160:163]
  v_mfma_f32_16x16x32_bf16 v[164:167], v[76:79], v[100:103], v[164:167]
  ds_read_b64_tr_b16 v[64:65], v5 offset:64
  ds_read_b64_tr_b16 v[66:67], v5 offset:2368
  v_mfma_f32_16x16x32_bf16 v[168:171], v[76:79], v[104:107], v[168:171]
  v_mfma_f32_16x16x32_bf16 v[172:175], v[76:79], v[108:111], v[172:175]
  ds_read_b64_tr_b16 v[68:69], v5 offset:18496
  ds_read_b64_tr_b16 v[70:71], v5 offset:20800
  s_waitcnt lgkmcnt(6)
  v_mfma_f32_16x16x32_bf16 v[176:179], v[56:59], v[96:99], v[176:179]
  v_mfma_f32_16x16x32_bf16 v[180:183], v[56:59], v[100:103], v[180:183]
  v_mfma_f32_16x16x32_bf16 v[184:187], v[56:59], v[104:107], v[184:187]
  v_mfma_f32_16x16x32_bf16 v[188:191], v[56:59], v[108:111], v[188:191]
  s_waitcnt lgkmcnt(4)
  v_mfma_f32_16x16x32_bf16 v[192:195], v[60:63], v[96:99], v[192:195]
  v_mfma_f32_16x16x32_bf16 v[196:199], v[60:63], v[100:103], v[196:199]
  v_mfma_f32_16x16x32_bf16 v[200:203], v[60:63], v[104:107], v[200:203]
  v_mfma_f32_16x16x32_bf16 v[204:207], v[60:63], v[108:111], v[204:207]
  s_waitcnt lgkmcnt(0)
  s_barrier
  v_add_u32 v6, 36864, v6
  v_add_u32 v4, 36864, v4
  v_add_u32 v5, 36864, v5
  v_mfma_f32_16x16x32_bf16 v[208:211], v[64:67], v[96:99], v[208:211]
  ds_read_b128 v[80:83], v7 offset:8192
  ds_read_b128 v[84:87], v7 offset:9216
  v_mfma_f32_16x16x32_bf16 v[212:215], v[64:67], v[100:103], v[212:215]
  ds_read_b128 v[88:91], v8 offset:10240
  ds_read_b128 v[92:95], v8 offset:11264
  ds_read_b64_tr_b16 v[72:73], v6 offset:0
  ds_read_b64_tr_b16 v[74:75], v6 offset:2304
  s_mov_b32 s3, 4423680
  buffer_load_dword v15, v13, s[12:15], s3 offen
  buffer_load_dword v15, v13, s[16:19], s3 offen
  v_mfma_f32_16x16x32_bf16 v[216:219], v[64:67], v[104:107], v[216:219]
  v_mfma_f32_16x16x32_bf16 v[220:223], v[64:67], v[108:111], v[220:223]
  ds_read_b64_tr_b16 v[76:77], v6 offset:18432
  ds_read_b64_tr_b16 v[78:79], v6 offset:20736
  v_mfma_f32_16x16x32_bf16 v[224:227], v[68:71], v[96:99], v[224:227]
  s_mov_b32 s3, 0
  buffer_load_dword v15, v14, s[20:23], s3 offen
  v_mfma_f32_16x16x32_bf16 v[228:231], v[68:71], v[100:103], v[228:231]
  ds_read_b64_tr_b16 v[56:57], v4 offset:0
  ds_read_b64_tr_b16 v[58:59], v4 offset:2304
  v_mfma_f32_16x16x32_bf16 v[232:235], v[68:71], v[104:107], v[232:235]
  v_mfma_f32_16x16x32_bf16 v[236:239], v[68:71], v[108:111], v[236:239]
  s_waitcnt lgkmcnt(4)
  v_mfma_f32_16x16x32_bf16 v[240:243], v[72:75], v[80:83], v[240:243]
  v_mfma_f32_16x16x32_bf16 v[244:247], v[72:75], v[84:87], v[244:247]
  ds_read_b64_tr_b16 v[60:61], v4 offset:18432
  ds_read_b64_tr_b16 v[62:63], v4 offset:20736
  s_waitcnt lgkmcnt(4)
  v_mfma_f32_16x16x32_bf16 v[248:251], v[76:79], v[80:83], v[248:251]
  v_mfma_f32_16x16x32_bf16 v[252:255], v[76:79], v[84:87], v[252:255]
  s_waitcnt lgkmcnt(2)
  v_mfma_f32_16x16x32_bf16 v[112:115], v[56:59], v[80:83], v[112:115]
  v_mfma_f32_16x16x32_bf16 v[116:119], v[56:59], v[84:87], v[116:119]
  ds_read_b64_tr_b16 v[64:65], v5 offset:0
  ds_read_b64_tr_b16 v[66:67], v5 offset:2304
  v_mfma_f32_16x16x32_bf16 v[120:123], v[56:59], v[88:91], v[120:123]
  v_mfma_f32_16x16x32_bf16 v[124:127], v[56:59], v[92:95], v[124:127]
  s_waitcnt lgkmcnt(2)
  v_mfma_f32_16x16x32_bf16 v[128:131], v[60:63], v[80:83], v[128:131]
  v_mfma_f32_16x16x32_bf16 v[132:135], v[60:63], v[84:87], v[132:135]
  ds_read_b64_tr_b16 v[68:69], v5 offset:18432
  ds_read_b64_tr_b16 v[70:71], v5 offset:20736
  v_mfma_f32_16x16x32_bf16 v[136:139], v[60:63], v[88:91], v[136:139]
  v_mfma_f32_16x16x32_bf16 v[140:143], v[60:63], v[92:95], v[140:143]
  s_waitcnt lgkmcnt(2)
  v_mfma_f32_16x16x32_bf16 v[144:147], v[64:67], v[80:83], v[144:147]
  ds_read_b64_tr_b16 v[72:73], v4 offset:64
  ds_read_b64_tr_b16 v[74:75], v4 offset:2368
  v_mfma_f32_16x16x32_bf16 v[148:151], v[64:67], v[84:87], v[148:151]
  v_mfma_f32_16x16x32_bf16 v[152:155], v[64:67], v[88:91], v[152:155]
  v_mfma_f32_16x16x32_bf16 v[156:159], v[64:67], v[92:95], v[156:159]
  ds_read_b64_tr_b16 v[76:77], v4 offset:18496
  ds_read_b64_tr_b16 v[78:79], v4 offset:20800
  s_waitcnt lgkmcnt(4)
  v_mfma_f32_16x16x32_bf16 v[160:163], v[68:71], v[80:83], v[160:163]
  v_mfma_f32_16x16x32_bf16 v[164:167], v[68:71], v[84:87], v[164:167]
  ds_read_b64_tr_b16 v[56:57], v5 offset:64
  ds_read_b64_tr_b16 v[58:59], v5 offset:2368
  v_mfma_f32_16x16x32_bf16 v[168:171], v[68:71], v[88:91], v[168:171]
  v_mfma_f32_16x16x32_bf16 v[172:175], v[68:71], v[92:95], v[172:175]
  ds_read_b64_tr_b16 v[60:61], v5 offset:18496
  ds_read_b64_tr_b16 v[62:63], v5 offset:20800
  s_waitcnt lgkmcnt(6)
  v_mfma_f32_16x16x32_bf16 v[176:179], v[72:75], v[80:83], v[176:179]
  v_mfma_f32_16x16x32_bf16 v[180:183], v[72:75], v[84:87], v[180:183]
  v_mfma_f32_16x16x32_bf16 v[184:187], v[72:75], v[88:91], v[184:187]
  v_mfma_f32_16x16x32_bf16 v[188:191], v[72:75], v[92:95], v[188:191]
  s_waitcnt lgkmcnt(4)
  v_mfma_f32_16x16x32_bf16 v[192:195], v[76:79], v[80:83], v[192:195]
  v_mfma_f32_16x16x32_bf16 v[196:199], v[76:79], v[84:87], v[196:199]
  v_mfma_f32_16x16x32_bf16 v[200:203], v[76:79], v[88:91], v[200:203]
  v_mfma_f32_16x16x32_bf16 v[204:207], v[76:79], v[92:95], v[204:207]
  s_waitcnt lgkmcnt(0)
  s_barrier
  v_add_u32 v6, 36864, v6
  v_add_u32 v4, 36864, v4
  v_add_u32 v5, 36864, v5
  v_mfma_f32_16x16x32_bf16 v[208:211], v[56:59], v[80:83], v[208:211]
  ds_read_b128 v[96:99], v7 offset:16384
  ds_read_b128 v[100:103], v7 offset:17408
  v_mfma_f32_16x16x32_bf16 v[212:215], v[56:59], v[84:87], v[212:215]
  ds_read_b128 v[104:107], v8 offset:18432
  ds_read_b128 v[108:111], v8 offset:19456
  ds_read_b64_tr_b16 v[64:65], v6 offset:0
  ds_read_b64_tr_b16 v[66:67], v6 offset:2304
  s_mov_b32 s3, 4718592
  buffer_load_dword v15, v13, s[12:15], s3 offen
  buffer_load_dword v15, v13, s[16:19], s3 offen
  v_mfma_f32_16x16x32_bf16 v[216:219], v[56:59], v[88:91], v[216:219]
  v_mfma_f32_16x16x32_bf16 v[220:223], v[56:59], v[92:95], v[220:223]
  ds_read_b64_tr_b16 v[68:69], v6 offset:18432
  ds_read_b64_tr_b16 v[70:71], v6 offset:20736
  s_mov_b32 s3, 128
  buffer_load_dword v15, v14, s[20:23], s3 offen
  v_mfma_f32_16x16x32_bf16 v[224:227], v[60:63], v[80:83], v[224:227]
  v_mfma_f32_16x16x32_bf16 v[228:231], v[60:63], v[84:87], v[228:231]
  ds_read_b64_tr_b16 v[72:73], v4 offset:0
  ds_read_b64_tr_b16 v[74:75], v4 offset:2304
  s_mov_b32 s3, 1024
  buffer_load_dword v15, v21, s[8:11], s3 offen
  v_mfma_f32_16x16x32_bf16 v[232:235], v[60:63], v[88:91], v[232:235]
  v_mfma_f32_16x16x32_bf16 v[236:239], v[60:63], v[92:95], v[236:239]
  s_waitcnt lgkmcnt(4)
  v_mfma_f32_16x16x32_bf16 v[240:243], v[64:67], v[96:99], v[240:243]
  v_mfma_f32_16x16x32_bf16 v[244:247], v[64:67], v[100:103], v[244:247]
  ds_read_b64_tr_b16 v[76:77], v4 offset:18432
  ds_read_b64_tr_b16 v[78:79], v4 offset:20736
  s_waitcnt lgkmcnt(4)
  v_mfma_f32_16x16x32_bf16 v[248:251], v[68:71], v[96:99], v[248:251]
  v_mfma_f32_16x16x32_bf16 v[252:255], v[68:71], v[100:103], v[252:255]
  s_waitcnt lgkmcnt(2)
  v_mfma_f32_16x16x32_bf16 v[112:115], v[72:75], v[96:99], v[112:115]
  v_mfma_f32_16x16x32_bf16 v[116:119], v[72:75], v[100:103], v[116:119]
  ds_read_b64_tr_b16 v[56:57], v5 offset:0
  ds_read_b64_tr_b16 v[58:59], v5 offset:2304
  v_mfma_f32_16x16x32_bf16 v[120:123], v[72:75], v[104:107], v[120:123]
  v_mfma_f32_16x16x32_bf16 v[124:127], v[72:75], v[108:111], v[124:127]
  s_waitcnt lgkmcnt(2)
  v_mfma_f32_16x16x32_bf16 v[128:131], v[76:79], v[96:99], v[128:131]
  v_mfma_f32_16x16x32_bf16 v[132:135], v[76:79], v[100:103], v[132:135]
  ds_read_b64_tr_b16 v[60:61], v5 offset:18432
  ds_read_b64_tr_b16 v[62:63], v5 offset:20736
  v_mfma_f32_16x16x32_bf16 v[136:139], v[76:79], v[104:107], v[136:139]
  v_mfma_f32_16x16x32_bf16 v[140:143], v[76:79], v[108:111], v[140:143]
  s_waitcnt lgkmcnt(2)
  v_mfma_f32_16x16x32_bf16 v[144:147], v[56:59], v[96:99], v[144:147]
  ds_read_b64_tr_b16 v[64:65], v4 offset:64
  ds_read_b64_tr_b16 v[66:67], v4 offset:2368
  v_mfma_f32_16x16x32_bf16 v[148:151], v[56:59], v[100:103], v[148:151]
  v_mfma_f32_16x16x32_bf16 v[152:155], v[56:59], v[104:107], v[152:155]
  v_mfma_f32_16x16x32_bf16 v[156:159], v[56:59], v[108:111], v[156:159]
  ds_read_b64_tr_b16 v[68:69], v4 offset:18496
  ds_read_b64_tr_b16 v[70:71], v4 offset:20800
  s_waitcnt lgkmcnt(4)
  v_mfma_f32_16x16x32_bf16 v[160:163], v[60:63], v[96:99], v[160:163]
  v_mfma_f32_16x16x32_bf16 v[164:167], v[60:63], v[100:103], v[164:167]
  ds_read_b64_tr_b16 v[72:73], v5 offset:64
  ds_read_b64_tr_b16 v[74:75], v5 offset:2368
  v_mfma_f32_16x16x32_bf16 v[168:171], v[60:63], v[104:107], v[168:171]
  v_mfma_f32_16x16x32_bf16 v[172:175], v[60:63], v[108:111], v[172:175]
  ds_read_b64_tr_b16 v[76:77], v5 offset:18496
  ds_read_b64_tr_b16 v[78:79], v5 offset:20800
  s_waitcnt lgkmcnt(6)
  v_mfma_f32_16x16x32_bf16 v[176:179], v[64:67], v[96:99], v[176:179]
  v_mfma_f32_16x16x32_bf16 v[180:183], v[64:67], v[100:103], v[180:183]
  v_mfma_f32_16x16x32_bf16 v[184:187], v[64:67], v[104:107], v[184:187]
  v_mfma_f32_16x16x32_bf16 v[188:191], v[64:67], v[108:111], v[188:191]
  s_waitcnt lgkmcnt(4)
  v_mfma_f32_16x16x32_bf16 v[192:195], v[68:71], v[96:99], v[192:195]
  v_mfma_f32_16x16x32_bf16 v[196:199], v[68:71], v[100:103], v[196:199]
  v_mfma_f32_16x16x32_bf16 v[200:203], v[68:71], v[104:107], v[200:203]
  v_mfma_f32_16x16x32_bf16 v[204:207], v[68:71], v[108:111], v[204:207]
  s_waitcnt lgkmcnt(0)
  s_barrier
  v_subrev_u32 v6, 73728, v6
  v_subrev_u32 v4, 73728, v4
  v_subrev_u32 v5, 73728, v5
  v_mfma_f32_16x16x32_bf16 v[208:211], v[72:75], v[96:99], v[208:211]
  ds_read_b128 v[80:83], v7 offset:0
  ds_read_b128 v[84:87], v7 offset:1024
  v_mfma_f32_16x16x32_bf16 v[212:215], v[72:75], v[100:103], v[212:215]
  ds_read_b128 v[88:91], v8 offset:2048
  ds_read_b128 v[92:95], v8 offset:3072
  ds_read_b64_tr_b16 v[56:57], v6 offset:0
  ds_read_b64_tr_b16 v[58:59], v6 offset:2304
  s_mov_b32 s3, 5013504
  buffer_load_dword v15, v13, s[12:15], s3 offen
  buffer_load_dword v15, v13, s[16:19], s3 offen
  v_mfma_f32_16x16x32_bf16 v[216:219], v[72:75], v[104:107], v[216:219]
  v_mfma_f32_16x16x32_bf16 v[220:223], v[72:75], v[108:111], v[220:223]
  ds_read_b64_tr_b16 v[60:61], v6 offset:18432
  ds_read_b64_tr_b16 v[62:63], v6 offset:20736
  v_mfma_f32_16x16x32_bf16 v[224:227], v[76:79], v[96:99], v[224:227]
  v_mfma_f32_16x16x32_bf16 v[228:231], v[76:79], v[100:103], v[228:231]
  ds_read_b64_tr_b16 v[64:65], v4 offset:0
  ds_read_b64_tr_b16 v[66:67], v4 offset:2304
  v_mfma_f32_16x16x32_bf16 v[232:235], v[76:79], v[104:107], v[232:235]
  v_mfma_f32_16x16x32_bf16 v[236:239], v[76:79], v[108:111], v[236:239]
  s_waitcnt lgkmcnt(4)
  v_mfma_f32_16x16x32_bf16 v[240:243], v[56:59], v[80:83], v[240:243]
  v_mfma_f32_16x16x32_bf16 v[244:247], v[56:59], v[84:87], v[244:247]
  ds_read_b64_tr_b16 v[68:69], v4 offset:18432
  ds_read_b64_tr_b16 v[70:71], v4 offset:20736
  s_waitcnt lgkmcnt(4)
  v_mfma_f32_16x16x32_bf16 v[248:251], v[60:63], v[80:83], v[248:251]
  v_mfma_f32_16x16x32_bf16 v[252:255], v[60:63], v[84:87], v[252:255]
  s_waitcnt lgkmcnt(2)
  v_mfma_f32_16x16x32_bf16 v[112:115], v[64:67], v[80:83], v[112:115]
  v_mfma_f32_16x16x32_bf16 v[116:119], v[64:67], v[84:87], v[116:119]
  ds_read_b64_tr_b16 v[72:73], v5 offset:0
  ds_read_b64_tr_b16 v[74:75], v5 offset:2304
  v_mfma_f32_16x16x32_bf16 v[120:123], v[64:67], v[88:91], v[120:123]
  v_mfma_f32_16x16x32_bf16 v[124:127], v[64:67], v[92:95], v[124:127]
  s_waitcnt lgkmcnt(2)
  v_mfma_f32_16x16x32_bf16 v[128:131], v[68:71], v[80:83], v[128:131]
  v_mfma_f32_16x16x32_bf16 v[132:135], v[68:71], v[84:87], v[132:135]
  ds_read_b64_tr_b16 v[76:77], v5 offset:18432
  ds_read_b64_tr_b16 v[78:79], v5 offset:20736
  v_mfma_f32_16x16x32_bf16 v[136:139], v[68:71], v[88:91], v[136:139]
  v_mfma_f32_16x16x32_bf16 v[140:143], v[68:71], v[92:95], v[140:143]
  s_waitcnt lgkmcnt(2)
  v_mfma_f32_16x16x32_bf16 v[144:147], v[72:75], v[80:83], v[144:147]
  ds_read_b64_tr_b16 v[56:57], v4 offset:64
  ds_read_b64_tr_b16 v[58:59], v4 offset:2368
  v_mfma_f32_16x16x32_bf16 v[148:151], v[72:75], v[84:87], v[148:151]
  v_mfma_f32_16x16x32_bf16 v[152:155], v[72:75], v[88:91], v[152:155]
  v_mfma_f32_16x16x32_bf16 v[156:159], v[72:75], v[92:95], v[156:159]
  ds_read_b64_tr_b16 v[60:61], v4 offset:18496
  ds_read_b64_tr_b16 v[62:63], v4 offset:20800
  s_waitcnt lgkmcnt(4)
  v_mfma_f32_16x16x32_bf16 v[160:163], v[76:79], v[80:83], v[160:163]
  v_mfma_f32_16x16x32_bf16 v[164:167], v[76:79], v[84:87], v[164:167]
  ds_read_b64_tr_b16 v[64:65], v5 offset:64
  ds_read_b64_tr_b16 v[66:67], v5 offset:2368
  v_mfma_f32_16x16x32_bf16 v[168:171], v[76:79], v[88:91], v[168:171]
  v_mfma_f32_16x16x32_bf16 v[172:175], v[76:79], v[92:95], v[172:175]
  ds_read_b64_tr_b16 v[68:69], v5 offset:18496
  ds_read_b64_tr_b16 v[70:71], v5 offset:20800
  s_waitcnt lgkmcnt(6)
  v_mfma_f32_16x16x32_bf16 v[176:179], v[56:59], v[80:83], v[176:179]
  v_mfma_f32_16x16x32_bf16 v[180:183], v[56:59], v[84:87], v[180:183]
  v_mfma_f32_16x16x32_bf16 v[184:187], v[56:59], v[88:91], v[184:187]
  v_mfma_f32_16x16x32_bf16 v[188:191], v[56:59], v[92:95], v[188:191]
  s_waitcnt lgkmcnt(4)
  v_mfma_f32_16x16x32_bf16 v[192:195], v[60:63], v[80:83], v[192:195]
  v_mfma_f32_16x16x32_bf16 v[196:199], v[60:63], v[84:87], v[196:199]
  v_mfma_f32_16x16x32_bf16 v[200:203], v[60:63], v[88:91], v[200:203]
  v_mfma_f32_16x16x32_bf16 v[204:207], v[60:63], v[92:95], v[204:207]
  s_waitcnt lgkmcnt(0)
  s_barrier
  v_add_u32 v6, 36864, v6
  v_add_u32 v4, 36864, v4
  v_add_u32 v5, 36864, v5
  v_mfma_f32_16x16x32_bf16 v[208:211], v[64:67], v[80:83], v[208:211]
  ds_read_b128 v[96:99], v7 offset:8192
  ds_read_b128 v[100:103], v7 offset:9216
  v_mfma_f32_16x16x32_bf16 v[212:215], v[64:67], v[84:87], v[212:215]
  ds_read_b128 v[104:107], v8 offset:10240
  ds_read_b128 v[108:111], v8 offset:11264
  ds_read_b64_tr_b16 v[72:73], v6 offset:0
  ds_read_b64_tr_b16 v[74:75], v6 offset:2304
  v_mfma_f32_16x16x32_bf16 v[216:219], v[64:67], v[88:91], v[216:219]
  v_mfma_f32_16x16x32_bf16 v[220:223], v[64:67], v[92:95], v[220:223]
  ds_read_b64_tr_b16 v[76:77], v6 offset:18432
  ds_read_b64_tr_b16 v[78:79], v6 offset:20736
  v_mfma_f32_16x16x32_bf16 v[224:227], v[68:71], v[80:83], v[224:227]
  v_mfma_f32_16x16x32_bf16 v[228:231], v[68:71], v[84:87], v[228:231]
  ds_read_b64_tr_b16 v[56:57], v4 offset:0
  ds_read_b64_tr_b16 v[58:59], v4 offset:2304
  v_mfma_f32_16x16x32_bf16 v[232:235], v[68:71], v[88:91], v[232:235]
  v_mfma_f32_16x16x32_bf16 v[236:239], v[68:71], v[92:95], v[236:239]
  s_waitcnt lgkmcnt(4)
  v_mfma_f32_16x16x32_bf16 v[240:243], v[72:75], v[96:99], v[240:243]
  v_mfma_f32_16x16x32_bf16 v[244:247], v[72:75], v[100:103], v[244:247]
  ds_read_b64_tr_b16 v[60:61], v4 offset:18432
  ds_read_b64_tr_b16 v[62:63], v4 offset:20736
  s_waitcnt lgkmcnt(4)
  v_mfma_f32_16x16x32_bf16 v[248:251], v[76:79], v[96:99], v[248:251]
  v_mfma_f32_16x16x32_bf16 v[252:255], v[76:79], v[100:103], v[252:255]
  s_waitcnt lgkmcnt(2)
  v_mfma_f32_16x16x32_bf16 v[112:115], v[56:59], v[96:99], v[112:115]
  v_mfma_f32_16x16x32_bf16 v[116:119], v[56:59], v[100:103], v[116:119]
  ds_read_b64_tr_b16 v[64:65], v5 offset:0
  ds_read_b64_tr_b16 v[66:67], v5 offset:2304
  v_mfma_f32_16x16x32_bf16 v[120:123], v[56:59], v[104:107], v[120:123]
  v_mfma_f32_16x16x32_bf16 v[124:127], v[56:59], v[108:111], v[124:127]
  s_waitcnt lgkmcnt(2)
  v_mfma_f32_16x16x32_bf16 v[128:131], v[60:63], v[96:99], v[128:131]
  v_mfma_f32_16x16x32_bf16 v[132:135], v[60:63], v[100:103], v[132:135]
  ds_read_b64_tr_b16 v[68:69], v5 offset:18432
  ds_read_b64_tr_b16 v[70:71], v5 offset:20736
  v_mfma_f32_16x16x32_bf16 v[136:139], v[60:63], v[104:107], v[136:139]
  v_mfma_f32_16x16x32_bf16 v[140:143], v[60:63], v[108:111], v[140:143]
  s_waitcnt lgkmcnt(2)
  v_mfma_f32_16x16x32_bf16 v[144:147], v[64:67], v[96:99], v[144:147]
  ds_read_b64_tr_b16 v[72:73], v4 offset:64
  ds_read_b64_tr_b16 v[74:75], v4 offset:2368
  v_mfma_f32_16x16x32_bf16 v[148:151], v[64:67], v[100:103], v[148:151]
  v_mfma_f32_16x16x32_bf16 v[152:155], v[64:67], v[104:107], v[152:155]
  v_mfma_f32_16x16x32_bf16 v[156:159], v[64:67], v[108:111], v[156:159]
  ds_read_b64_tr_b16 v[76:77], v4 offset:18496
  ds_read_b64_tr_b16 v[78:79], v4 offset:20800
  s_waitcnt lgkmcnt(4)
  v_mfma_f32_16x16x32_bf16 v[160:163], v[68:71], v[96:99], v[160:163]
  v_mfma_f32_16x16x32_bf16 v[164:167], v[68:71], v[100:103], v[164:167]
  ds_read_b64_tr_b16 v[56:57], v5 offset:64
  ds_read_b64_tr_b16 v[58:59], v5 offset:2368
  v_mfma_f32_16x16x32_bf16 v[168:171], v[68:71], v[104:107], v[168:171]
  v_mfma_f32_16x16x32_bf16 v[172:175], v[68:71], v[108:111], v[172:175]
  ds_read_b64_tr_b16 v[60:61], v5 offset:18496
  ds_read_b64_tr_b16 v[62:63], v5 offset:20800
  s_waitcnt lgkmcnt(6)
  v_mfma_f32_16x16x32_bf16 v[176:179], v[72:75], v[96:99], v[176:179]
  v_mfma_f32_16x16x32_bf16 v[180:183], v[72:75], v[100:103], v[180:183]
  v_mfma_f32_16x16x32_bf16 v[184:187], v[72:75], v[104:107], v[184:187]
  v_mfma_f32_16x16x32_bf16 v[188:191], v[72:75], v[108:111], v[188:191]
  s_waitcnt lgkmcnt(4)
  v_mfma_f32_16x16x32_bf16 v[192:195], v[76:79], v[96:99], v[192:195]
  v_mfma_f32_16x16x32_bf16 v[196:199], v[76:79], v[100:103], v[196:199]
  v_mfma_f32_16x16x32_bf16 v[200:203], v[76:79], v[104:107], v[200:203]
  v_mfma_f32_16x16x32_bf16 v[204:207], v[76:79], v[108:111], v[204:207]
  s_waitcnt lgkmcnt(0)
  s_barrier
  v_add_u32 v6, 36864, v6
  v_add_u32 v4, 36864, v4
  v_add_u32 v5, 36864, v5
  v_mfma_f32_16x16x32_bf16 v[208:211], v[56:59], v[96:99], v[208:211]
  ds_read_b128 v[80:83], v7 offset:16384
  ds_read_b128 v[84:87], v7 offset:17408
  v_mfma_f32_16x16x32_bf16 v[212:215], v[56:59], v[100:103], v[212:215]
  ds_read_b128 v[88:91], v8 offset:18432
  ds_read_b128 v[92:95], v8 offset:19456
  ds_read_b64_tr_b16 v[64:65], v6 offset:0
  ds_read_b64_tr_b16 v[66:67], v6 offset:2304
  v_mfma_f32_16x16x32_bf16 v[216:219], v[56:59], v[104:107], v[216:219]
  v_mfma_f32_16x16x32_bf16 v[220:223], v[56:59], v[108:111], v[220:223]
  ds_read_b64_tr_b16 v[68:69], v6 offset:18432
  ds_read_b64_tr_b16 v[70:71], v6 offset:20736
  v_mfma_f32_16x16x32_bf16 v[224:227], v[60:63], v[96:99], v[224:227]
  v_mfma_f32_16x16x32_bf16 v[228:231], v[60:63], v[100:103], v[228:231]
  ds_read_b64_tr_b16 v[72:73], v4 offset:0
  ds_read_b64_tr_b16 v[74:75], v4 offset:2304
  v_mfma_f32_16x16x32_bf16 v[232:235], v[60:63], v[104:107], v[232:235]
  v_mfma_f32_16x16x32_bf16 v[236:239], v[60:63], v[108:111], v[236:239]
  s_waitcnt lgkmcnt(4)
  v_mfma_f32_16x16x32_bf16 v[240:243], v[64:67], v[80:83], v[240:243]
  v_mfma_f32_16x16x32_bf16 v[244:247], v[64:67], v[84:87], v[244:247]
  ds_read_b64_tr_b16 v[76:77], v4 offset:18432
  ds_read_b64_tr_b16 v[78:79], v4 offset:20736
  s_waitcnt lgkmcnt(4)
  v_mfma_f32_16x16x32_bf16 v[248:251], v[68:71], v[80:83], v[248:251]
  v_mfma_f32_16x16x32_bf16 v[252:255], v[68:71], v[84:87], v[252:255]
  s_waitcnt lgkmcnt(2)
  v_mfma_f32_16x16x32_bf16 v[112:115], v[72:75], v[80:83], v[112:115]
  v_mfma_f32_16x16x32_bf16 v[116:119], v[72:75], v[84:87], v[116:119]
  ds_read_b64_tr_b16 v[56:57], v5 offset:0
  ds_read_b64_tr_b16 v[58:59], v5 offset:2304
  v_mfma_f32_16x16x32_bf16 v[120:123], v[72:75], v[88:91], v[120:123]
  v_mfma_f32_16x16x32_bf16 v[124:127], v[72:75], v[92:95], v[124:127]
  s_waitcnt lgkmcnt(2)
  v_mfma_f32_16x16x32_bf16 v[128:131], v[76:79], v[80:83], v[128:131]
  v_mfma_f32_16x16x32_bf16 v[132:135], v[76:79], v[84:87], v[132:135]
  ds_read_b64_tr_b16 v[60:61], v5 offset:18432
  ds_read_b64_tr_b16 v[62:63], v5 offset:20736
  v_mfma_f32_16x16x32_bf16 v[136:139], v[76:79], v[88:91], v[136:139]
  v_mfma_f32_16x16x32_bf16 v[140:143], v[76:79], v[92:95], v[140:143]
  s_waitcnt lgkmcnt(2)
  v_mfma_f32_16x16x32_bf16 v[144:147], v[56:59], v[80:83], v[144:147]
  ds_read_b64_tr_b16 v[64:65], v4 offset:64
  ds_read_b64_tr_b16 v[66:67], v4 offset:2368
  v_mfma_f32_16x16x32_bf16 v[148:151], v[56:59], v[84:87], v[148:151]
  v_mfma_f32_16x16x32_bf16 v[152:155], v[56:59], v[88:91], v[152:155]
  v_mfma_f32_16x16x32_bf16 v[156:159], v[56:59], v[92:95], v[156:159]
  ds_read_b64_tr_b16 v[68:69], v4 offset:18496
  ds_read_b64_tr_b16 v[70:71], v4 offset:20800
  s_waitcnt lgkmcnt(4)
  v_mfma_f32_16x16x32_bf16 v[160:163], v[60:63], v[80:83], v[160:163]
  v_mfma_f32_16x16x32_bf16 v[164:167], v[60:63], v[84:87], v[164:167]
  ds_read_b64_tr_b16 v[72:73], v5 offset:64
  ds_read_b64_tr_b16 v[74:75], v5 offset:2368
  v_mfma_f32_16x16x32_bf16 v[168:171], v[60:63], v[88:91], v[168:171]
  v_mfma_f32_16x16x32_bf16 v[172:175], v[60:63], v[92:95], v[172:175]
  ds_read_b64_tr_b16 v[76:77], v5 offset:18496
  ds_read_b64_tr_b16 v[78:79], v5 offset:20800
  s_waitcnt lgkmcnt(6)
  v_mfma_f32_16x16x32_bf16 v[176:179], v[64:67], v[80:83], v[176:179]
  v_mfma_f32_16x16x32_bf16 v[180:183], v[64:67], v[84:87], v[180:183]
  v_mfma_f32_16x16x32_bf16 v[184:187], v[64:67], v[88:91], v[184:187]
  v_mfma_f32_16x16x32_bf16 v[188:191], v[64:67], v[92:95], v[188:191]
  s_waitcnt lgkmcnt(4)
  v_mfma_f32_16x16x32_bf16 v[192:195], v[68:71], v[80:83], v[192:195]
  v_mfma_f32_16x16x32_bf16 v[196:199], v[68:71], v[84:87], v[196:199]
  v_mfma_f32_16x16x32_bf16 v[200:203], v[68:71], v[88:91], v[200:203]
  v_mfma_f32_16x16x32_bf16 v[204:207], v[68:71], v[92:95], v[204:207]
  s_waitcnt lgkmcnt(0)
  s_barrier
  v_subrev_u32 v6, 73728, v6
  v_subrev_u32 v4, 73728, v4
  v_subrev_u32 v5, 73728, v5
  v_mfma_f32_16x16x32_bf16 v[208:211], v[72:75], v[80:83], v[208:211]
  ds_read_b128 v[96:99], v7 offset:0
  ds_read_b128 v[100:103], v7 offset:1024
  v_mfma_f32_16x16x32_bf16 v[212:215], v[72:75], v[84:87], v[212:215]
  ds_read_b128 v[104:107], v8 offset:2048
  ds_read_b128 v[108:111], v8 offset:3072
  ds_read_b64_tr_b16 v[56:57], v6 offset:0
  ds_read_b64_tr_b16 v[58:59], v6 offset:2304
  v_mfma_f32_16x16x32_bf16 v[216:219], v[72:75], v[88:91], v[216:219]
  v_mfma_f32_16x16x32_bf16 v[220:223], v[72:75], v[92:95], v[220:223]
  ds_read_b64_tr_b16 v[60:61], v6 offset:18432
  ds_read_b64_tr_b16 v[62:63], v6 offset:20736
  v_mfma_f32_16x16x32_bf16 v[224:227], v[76:79], v[80:83], v[224:227]
  v_mfma_f32_16x16x32_bf16 v[228:231], v[76:79], v[84:87], v[228:231]
  ds_read_b64_tr_b16 v[64:65], v4 offset:0
  ds_read_b64_tr_b16 v[66:67], v4 offset:2304
  v_mfma_f32_16x16x32_bf16 v[232:235], v[76:79], v[88:91], v[232:235]
  v_mfma_f32_16x16x32_bf16 v[236:239], v[76:79], v[92:95], v[236:239]
  s_waitcnt lgkmcnt(4)
  v_mfma_f32_16x16x32_bf16 v[240:243], v[56:59], v[96:99], v[240:243]
  v_mfma_f32_16x16x32_bf16 v[244:247], v[56:59], v[100:103], v[244:247]
  ds_read_b64_tr_b16 v[68:69], v4 offset:18432
  ds_read_b64_tr_b16 v[70:71], v4 offset:20736
  s_waitcnt lgkmcnt(4)
  v_mfma_f32_16x16x32_bf16 v[248:251], v[60:63], v[96:99], v[248:251]
  v_mfma_f32_16x16x32_bf16 v[252:255], v[60:63], v[100:103], v[252:255]
  s_waitcnt lgkmcnt(2)
  v_mfma_f32_16x16x32_bf16 v[112:115], v[64:67], v[96:99], v[112:115]
  v_mfma_f32_16x16x32_bf16 v[116:119], v[64:67], v[100:103], v[116:119]
  ds_read_b64_tr_b16 v[72:73], v5 offset:0
  ds_read_b64_tr_b16 v[74:75], v5 offset:2304
  v_mfma_f32_16x16x32_bf16 v[120:123], v[64:67], v[104:107], v[120:123]
  v_mfma_f32_16x16x32_bf16 v[124:127], v[64:67], v[108:111], v[124:127]
  s_waitcnt lgkmcnt(2)
  v_mfma_f32_16x16x32_bf16 v[128:131], v[68:71], v[96:99], v[128:131]
  v_mfma_f32_16x16x32_bf16 v[132:135], v[68:71], v[100:103], v[132:135]
  ds_read_b64_tr_b16 v[76:77], v5 offset:18432
  ds_read_b64_tr_b16 v[78:79], v5 offset:20736
  v_mfma_f32_16x16x32_bf16 v[136:139], v[68:71], v[104:107], v[136:139]
  v_mfma_f32_16x16x32_bf16 v[140:143], v[68:71], v[108:111], v[140:143]
  s_waitcnt lgkmcnt(2)
  v_mfma_f32_16x16x32_bf16 v[144:147], v[72:75], v[96:99], v[144:147]
  ds_read_b64_tr_b16 v[56:57], v4 offset:64
  ds_read_b64_tr_b16 v[58:59], v4 offset:2368
  v_mfma_f32_16x16x32_bf16 v[148:151], v[72:75], v[100:103], v[148:151]
  v_mfma_f32_16x16x32_bf16 v[152:155], v[72:75], v[104:107], v[152:155]
  v_mfma_f32_16x16x32_bf16 v[156:159], v[72:75], v[108:111], v[156:159]
  ds_read_b64_tr_b16 v[60:61], v4 offset:18496
  ds_read_b64_tr_b16 v[62:63], v4 offset:20800
  s_waitcnt lgkmcnt(4)
  v_mfma_f32_16x16x32_bf16 v[160:163], v[76:79], v[96:99], v[160:163]
  v_mfma_f32_16x16x32_bf16 v[164:167], v[76:79], v[100:103], v[164:167]
  ds_read_b64_tr_b16 v[64:65], v5 offset:64
  ds_read_b64_tr_b16 v[66:67], v5 offset:2368
  v_mfma_f32_16x16x32_bf16 v[168:171], v[76:79], v[104:107], v[168:171]
  v_mfma_f32_16x16x32_bf16 v[172:175], v[76:79], v[108:111], v[172:175]
  ds_read_b64_tr_b16 v[68:69], v5 offset:18496
  ds_read_b64_tr_b16 v[70:71], v5 offset:20800
  s_waitcnt lgkmcnt(6)
  v_mfma_f32_16x16x32_bf16 v[176:179], v[56:59], v[96:99], v[176:179]
  v_mfma_f32_16x16x32_bf16 v[180:183], v[56:59], v[100:103], v[180:183]
  v_mfma_f32_16x16x32_bf16 v[184:187], v[56:59], v[104:107], v[184:187]
  v_mfma_f32_16x16x32_bf16 v[188:191], v[56:59], v[108:111], v[188:191]
  s_waitcnt lgkmcnt(4)
  v_mfma_f32_16x16x32_bf16 v[192:195], v[60:63], v[96:99], v[192:195]
  v_mfma_f32_16x16x32_bf16 v[196:199], v[60:63], v[100:103], v[196:199]
  v_mfma_f32_16x16x32_bf16 v[200:203], v[60:63], v[104:107], v[200:203]
  v_mfma_f32_16x16x32_bf16 v[204:207], v[60:63], v[108:111], v[204:207]
  s_waitcnt lgkmcnt(0)
  s_barrier
  v_add_u32 v6, 36864, v6
  v_add_u32 v4, 36864, v4
  v_add_u32 v5, 36864, v5
  v_mfma_f32_16x16x32_bf16 v[208:211], v[64:67], v[96:99], v[208:211]
  ds_read_b128 v[80:83], v7 offset:8192
  ds_read_b128 v[84:87], v7 offset:9216
  v_mfma_f32_16x16x32_bf16 v[212:215], v[64:67], v[100:103], v[212:215]
  ds_read_b128 v[88:91], v8 offset:10240
  ds_read_b128 v[92:95], v8 offset:11264
  ds_read_b64_tr_b16 v[72:73], v6 offset:0
  ds_read_b64_tr_b16 v[74:75], v6 offset:2304
  v_mfma_f32_16x16x32_bf16 v[216:219], v[64:67], v[104:107], v[216:219]
  v_mfma_f32_16x16x32_bf16 v[220:223], v[64:67], v[108:111], v[220:223]
  ds_read_b64_tr_b16 v[76:77], v6 offset:18432
  ds_read_b64_tr_b16 v[78:79], v6 offset:20736
  v_mfma_f32_16x16x32_bf16 v[224:227], v[68:71], v[96:99], v[224:227]
  v_mfma_f32_16x16x32_bf16 v[228:231], v[68:71], v[100:103], v[228:231]
  ds_read_b64_tr_b16 v[56:57], v4 offset:0
  ds_read_b64_tr_b16 v[58:59], v4 offset:2304
  v_mfma_f32_16x16x32_bf16 v[232:235], v[68:71], v[104:107], v[232:235]
  v_mfma_f32_16x16x32_bf16 v[236:239], v[68:71], v[108:111], v[236:239]
  s_waitcnt lgkmcnt(4)
  v_mfma_f32_16x16x32_bf16 v[240:243], v[72:75], v[80:83], v[240:243]
  v_mfma_f32_16x16x32_bf16 v[244:247], v[72:75], v[84:87], v[244:247]
  ds_read_b64_tr_b16 v[60:61], v4 offset:18432
  ds_read_b64_tr_b16 v[62:63], v4 offset:20736
  s_waitcnt lgkmcnt(4)
  v_mfma_f32_16x16x32_bf16 v[248:251], v[76:79], v[80:83], v[248:251]
  v_mfma_f32_16x16x32_bf16 v[252:255], v[76:79], v[84:87], v[252:255]
  s_waitcnt lgkmcnt(2)
  v_mfma_f32_16x16x32_bf16 v[112:115], v[56:59], v[80:83], v[112:115]
  v_mfma_f32_16x16x32_bf16 v[116:119], v[56:59], v[84:87], v[116:119]
  ds_read_b64_tr_b16 v[64:65], v5 offset:0
  ds_read_b64_tr_b16 v[66:67], v5 offset:2304
  v_mfma_f32_16x16x32_bf16 v[120:123], v[56:59], v[88:91], v[120:123]
  v_mfma_f32_16x16x32_bf16 v[124:127], v[56:59], v[92:95], v[124:127]
  s_waitcnt lgkmcnt(2)
  v_mfma_f32_16x16x32_bf16 v[128:131], v[60:63], v[80:83], v[128:131]
  v_mfma_f32_16x16x32_bf16 v[132:135], v[60:63], v[84:87], v[132:135]
  ds_read_b64_tr_b16 v[68:69], v5 offset:18432
  ds_read_b64_tr_b16 v[70:71], v5 offset:20736
  v_mfma_f32_16x16x32_bf16 v[136:139], v[60:63], v[88:91], v[136:139]
  v_mfma_f32_16x16x32_bf16 v[140:143], v[60:63], v[92:95], v[140:143]
  s_waitcnt lgkmcnt(2)
  v_mfma_f32_16x16x32_bf16 v[144:147], v[64:67], v[80:83], v[144:147]
  ds_read_b64_tr_b16 v[72:73], v4 offset:64
  ds_read_b64_tr_b16 v[74:75], v4 offset:2368
  v_mfma_f32_16x16x32_bf16 v[148:151], v[64:67], v[84:87], v[148:151]
  v_mfma_f32_16x16x32_bf16 v[152:155], v[64:67], v[88:91], v[152:155]
  v_mfma_f32_16x16x32_bf16 v[156:159], v[64:67], v[92:95], v[156:159]
  ds_read_b64_tr_b16 v[76:77], v4 offset:18496
  ds_read_b64_tr_b16 v[78:79], v4 offset:20800
  s_waitcnt lgkmcnt(4)
  v_mfma_f32_16x16x32_bf16 v[160:163], v[68:71], v[80:83], v[160:163]
  v_mfma_f32_16x16x32_bf16 v[164:167], v[68:71], v[84:87], v[164:167]
  ds_read_b64_tr_b16 v[56:57], v5 offset:64
  ds_read_b64_tr_b16 v[58:59], v5 offset:2368
  v_mfma_f32_16x16x32_bf16 v[168:171], v[68:71], v[88:91], v[168:171]
  v_mfma_f32_16x16x32_bf16 v[172:175], v[68:71], v[92:95], v[172:175]
  ds_read_b64_tr_b16 v[60:61], v5 offset:18496
  ds_read_b64_tr_b16 v[62:63], v5 offset:20800
  s_waitcnt lgkmcnt(6)
  v_mfma_f32_16x16x32_bf16 v[176:179], v[72:75], v[80:83], v[176:179]
  v_mfma_f32_16x16x32_bf16 v[180:183], v[72:75], v[84:87], v[180:183]
  v_mfma_f32_16x16x32_bf16 v[184:187], v[72:75], v[88:91], v[184:187]
  v_mfma_f32_16x16x32_bf16 v[188:191], v[72:75], v[92:95], v[188:191]
  s_waitcnt lgkmcnt(4)
  v_mfma_f32_16x16x32_bf16 v[192:195], v[76:79], v[80:83], v[192:195]
  v_mfma_f32_16x16x32_bf16 v[196:199], v[76:79], v[84:87], v[196:199]
  v_mfma_f32_16x16x32_bf16 v[200:203], v[76:79], v[88:91], v[200:203]
  v_mfma_f32_16x16x32_bf16 v[204:207], v[76:79], v[92:95], v[204:207]
  s_waitcnt lgkmcnt(0)
  s_barrier
  v_add_u32 v6, 36864, v6
  v_add_u32 v4, 36864, v4
  v_add_u32 v5, 36864, v5
  v_mfma_f32_16x16x32_bf16 v[208:211], v[56:59], v[80:83], v[208:211]
  ds_read_b128 v[96:99], v7 offset:16384
  ds_read_b128 v[100:103], v7 offset:17408
  v_mfma_f32_16x16x32_bf16 v[212:215], v[56:59], v[84:87], v[212:215]
  ds_read_b128 v[104:107], v8 offset:18432
  ds_read_b128 v[108:111], v8 offset:19456
  ds_read_b64_tr_b16 v[64:65], v6 offset:0
  ds_read_b64_tr_b16 v[66:67], v6 offset:2304
  v_mfma_f32_16x16x32_bf16 v[216:219], v[56:59], v[88:91], v[216:219]
  v_mfma_f32_16x16x32_bf16 v[220:223], v[56:59], v[92:95], v[220:223]
  ds_read_b64_tr_b16 v[68:69], v6 offset:18432
  ds_read_b64_tr_b16 v[70:71], v6 offset:20736
  v_mfma_f32_16x16x32_bf16 v[224:227], v[60:63], v[80:83], v[224:227]
  v_mfma_f32_16x16x32_bf16 v[228:231], v[60:63], v[84:87], v[228:231]
  ds_read_b64_tr_b16 v[72:73], v4 offset:0
  ds_read_b64_tr_b16 v[74:75], v4 offset:2304
  v_mfma_f32_16x16x32_bf16 v[232:235], v[60:63], v[88:91], v[232:235]
  v_mfma_f32_16x16x32_bf16 v[236:239], v[60:63], v[92:95], v[236:239]
  s_waitcnt lgkmcnt(4)
  v_mfma_f32_16x16x32_bf16 v[240:243], v[64:67], v[96:99], v[240:243]
  v_mfma_f32_16x16x32_bf16 v[244:247], v[64:67], v[100:103], v[244:247]
  ds_read_b64_tr_b16 v[76:77], v4 offset:18432
  ds_read_b64_tr_b16 v[78:79], v4 offset:20736
  s_waitcnt lgkmcnt(4)
  v_mfma_f32_16x16x32_bf16 v[248:251], v[68:71], v[96:99], v[248:251]
  v_mfma_f32_16x16x32_bf16 v[252:255], v[68:71], v[100:103], v[252:255]
  s_waitcnt lgkmcnt(2)
  v_mfma_f32_16x16x32_bf16 v[112:115], v[72:75], v[96:99], v[112:115]
  v_mfma_f32_16x16x32_bf16 v[116:119], v[72:75], v[100:103], v[116:119]
  ds_read_b64_tr_b16 v[56:57], v5 offset:0
  ds_read_b64_tr_b16 v[58:59], v5 offset:2304
  v_mfma_f32_16x16x32_bf16 v[120:123], v[72:75], v[104:107], v[120:123]
  v_mfma_f32_16x16x32_bf16 v[124:127], v[72:75], v[108:111], v[124:127]
  s_waitcnt lgkmcnt(2)
  v_mfma_f32_16x16x32_bf16 v[128:131], v[76:79], v[96:99], v[128:131]
  v_mfma_f32_16x16x32_bf16 v[132:135], v[76:79], v[100:103], v[132:135]
  ds_read_b64_tr_b16 v[60:61], v5 offset:18432
  ds_read_b64_tr_b16 v[62:63], v5 offset:20736
  v_mfma_f32_16x16x32_bf16 v[136:139], v[76:79], v[104:107], v[136:139]
  v_mfma_f32_16x16x32_bf16 v[140:143], v[76:79], v[108:111], v[140:143]
  s_waitcnt lgkmcnt(2)
  v_mfma_f32_16x16x32_bf16 v[144:147], v[56:59], v[96:99], v[144:147]
  ds_read_b64_tr_b16 v[64:65], v4 offset:64
  ds_read_b64_tr_b16 v[66:67], v4 offset:2368
  v_mfma_f32_16x16x32_bf16 v[148:151], v[56:59], v[100:103], v[148:151]
  v_mfma_f32_16x16x32_bf16 v[152:155], v[56:59], v[104:107], v[152:155]
  v_mfma_f32_16x16x32_bf16 v[156:159], v[56:59], v[108:111], v[156:159]
  ds_read_b64_tr_b16 v[68:69], v4 offset:18496
  ds_read_b64_tr_b16 v[70:71], v4 offset:20800
  s_waitcnt lgkmcnt(4)
  v_mfma_f32_16x16x32_bf16 v[160:163], v[60:63], v[96:99], v[160:163]
  v_mfma_f32_16x16x32_bf16 v[164:167], v[60:63], v[100:103], v[164:167]
  ds_read_b64_tr_b16 v[72:73], v5 offset:64
  ds_read_b64_tr_b16 v[74:75], v5 offset:2368
  v_mfma_f32_16x16x32_bf16 v[168:171], v[60:63], v[104:107], v[168:171]
  v_mfma_f32_16x16x32_bf16 v[172:175], v[60:63], v[108:111], v[172:175]
  ds_read_b64_tr_b16 v[76:77], v5 offset:18496
  ds_read_b64_tr_b16 v[78:79], v5 offset:20800
  s_waitcnt lgkmcnt(6)
  v_mfma_f32_16x16x32_bf16 v[176:179], v[64:67], v[96:99], v[176:179]
  v_mfma_f32_16x16x32_bf16 v[180:183], v[64:67], v[100:103], v[180:183]
  v_mfma_f32_16x16x32_bf16 v[184:187], v[64:67], v[104:107], v[184:187]
  v_mfma_f32_16x16x32_bf16 v[188:191], v[64:67], v[108:111], v[188:191]
  s_waitcnt lgkmcnt(4)
  v_mfma_f32_16x16x32_bf16 v[192:195], v[68:71], v[96:99], v[192:195]
  v_mfma_f32_16x16x32_bf16 v[196:199], v[68:71], v[100:103], v[196:199]
  v_mfma_f32_16x16x32_bf16 v[200:203], v[68:71], v[104:107], v[200:203]
  v_mfma_f32_16x16x32_bf16 v[204:207], v[68:71], v[108:111], v[204:207]
  s_waitcnt lgkmcnt(0)
  s_barrier
  v_mfma_f32_16x16x32_bf16 v[208:211], v[72:75], v[96:99], v[208:211]
  v_mfma_f32_16x16x32_bf16 v[212:215], v[72:75], v[100:103], v[212:215]
  v_mfma_f32_16x16x32_bf16 v[216:219], v[72:75], v[104:107], v[216:219]
  v_mfma_f32_16x16x32_bf16 v[220:223], v[72:75], v[108:111], v[220:223]
  v_mfma_f32_16x16x32_bf16 v[224:227], v[76:79], v[96:99], v[224:227]
  v_mfma_f32_16x16x32_bf16 v[228:231], v[76:79], v[100:103], v[228:231]
  v_mfma_f32_16x16x32_bf16 v[232:235], v[76:79], v[104:107], v[232:235]
  v_mfma_f32_16x16x32_bf16 v[236:239], v[76:79], v[108:111], v[236:239]
L_g1end:
  s_and_b32 s53, s2, 15
  s_lshl_b32 s53, s53, 7
  s_lshr_b32 s54, s2, 4
  s_lshl_b32 s54, s54, 7
  v_lshrrev_b32 v52, 4, v0
  v_lshlrev_b32 v52, 2, v52
  v_add_u32 v52, s53, v52
  v_mul_u32_u24 v52, 1152, v52
  v_and_b32 v53, 15, v0
  v_lshlrev_b32 v53, 3, v53
  v_add_u32 v53, s54, v53
  v_add_u32 v52, v52, v53
  s_cmp_lt_u32 s2, 144
  s_cselect_b32 s53, 0, 0x80000000
  v_add_u32 v52, s53, v52
  s_mov_b32 s36, s62
  s_and_b32 s37, s63, 0xffff
  s_mov_b32 s38, 2359296
  s_mov_b32 s39, 0x20000
  v_subrev_u32 v54, 3456, v52
  buffer_load_dwordx2 v[80:81], v54, s[36:39], 0 offen
  v_subrev_u32 v54, 2304, v52
  buffer_load_dwordx2 v[82:83], v54, s[36:39], 0 offen
  v_subrev_u32 v54, 1152, v52
  buffer_load_dwordx2 v[84:85], v54, s[36:39], 0 offen
  buffer_load_dwordx2 v[86:87], v52, s[36:39], 0 offen offset:0
  buffer_load_dwordx2 v[88:89], v52, s[36:39], 0 offen offset:1152
  buffer_load_dwordx2 v[90:91], v52, s[36:39], 0 offen offset:2304
  buffer_load_dwordx2 v[92:93], v52, s[36:39], 0 offen offset:3456
  s_mov_b32 s36, s64
  s_and_b32 s37, s65, 0xffff
  s_mov_b32 s38, 2359296
  s_mov_b32 s39, 0x20000
  buffer_load_dwordx2 v[94:95], v52, s[36:39], 0 offen offset:0
  buffer_load_dwordx2 v[96:97], v52, s[36:39], 0 offen offset:1152
  buffer_load_dwordx2 v[98:99], v52, s[36:39], 0 offen offset:2304
  buffer_load_dwordx2 v[100:101], v52, s[36:39], 0 offen offset:3456
  s_mov_b32 s36, s66
  s_and_b32 s37, s67, 0xffff
  s_mov_b32 s38, 4608
  s_mov_b32 s39, 0x20000
  s_lshr_b32 s54, s2, 4
  s_lshl_b32 s54, s54, 9
  v_and_b32 v54, 15, v0
  v_lshlrev_b32 v54, 5, v54
  v_add_u32 v54, s54, v54
  buffer_load_dwordx4 v[102:105], v54, s[36:39], 0 offen
  buffer_load_dwordx4 v[106:109], v54, s[36:39], 0 offen offset:16
  s_min_u32 s7, s2, 191
  v_and_b32 v21, 255, v0
  v_lshlrev_b32 v21, 4, v21
  v_subrev_u32 v22, 16, v21
  s_mul_i32 s53, s7, 3
  s_add_u32 s53, s53, s50
  s_lshl_b32 s53, s53, 12
  s_add_u32 s36, s68, s53
  s_addc_u32 s37, s69, 0
  s_and_b32 s37, s37, 0xffff
  s_mov_b32 s38, 4096
  s_mov_b32 s39, 0x20000
  buffer_load_dwordx4 v[24:27], v22, s[36:39], 0 offen
  buffer_load_dwordx4 v[28:31], v21, s[36:39], 0 offen
  s_mul_i32 s53, s7, 3
  s_add_u32 s53, s53, 2
  s_lshl_b32 s53, s53, 12
  s_add_u32 s36, s68, s53
  s_addc_u32 s37, s69, 0
  s_and_b32 s37, s37, 0xffff
  s_mov_b32 s38, 4096
  s_mov_b32 s39, 0x20000
  buffer_load_dwordx4 v[32:35], v22, s[36:39], 0 offen
  buffer_load_dwordx4 v[36:39], v21, s[36:39], 0 offen
  s_mov_b32 s36, s70
  s_and_b32 s37, s71, 0xffff
  s_mov_b32 s38, 1152
  s_mov_b32 s39, 0x20000
  s_mul_i32 s53, s7, 6
  v_mov_b32 v21, 0
  buffer_load_ushort v22, v21, s[36:39], s53 offen offset:2
  buffer_load_ushort v23, v21, s[36:39], s53 offen offset:4
  buffer_load_ushort v21, v21, s[36:39], s53 offen
  s_cmp_lt_u32 s44, 4
  s_cbranch_scc1 L_sk_57
  s_mov_b32 s3, 256
  buffer_load_dword v15, v14, s[20:23], s3 offen
  s_mov_b32 s3, 384
  buffer_load_dword v15, v14, s[20:23], s3 offen
  s_mov_b32 s3, 512
  buffer_load_dword v15, v14, s[20:23], s3 offen
  s_mov_b32 s3, 640
  buffer_load_dword v15, v14, s[20:23], s3 offen
  s_mov_b32 s3, 768
  buffer_load_dword v15, v14, s[20:23], s3 offen
  s_mov_b32 s3, 896
  buffer_load_dword v15, v14, s[20:23], s3 offen
  s_mov_b32 s3, 1024
  buffer_load_dword v15, v14, s[20:23], s3 offen
L_sk_57:
  s_cmp_lg_u32 s44, 5
  s_cbranch_scc1 L_cpf1
  s_getpc_b64 s[4:5]
L_pc_58:
  s_lshr_b32 s53, s2, 3
  s_mul_i32 s53, s53, 1536
  v_lshlrev_b32 v40, 7, v1
  v_add_u32 v40, s53, v40
  v_min_u32 v40, L_end-L_pc_58-4, v40
  v_and_b32 v40, 0xfffffffc, v40
  v_mov_b32 v41, s5
  v_add_co_u32 v40, vcc, s4, v40
  s_nop 1
  v_addc_co_u32 v41, vcc, 0, v41, vcc
  s_mov_b64 exec, 4095
  global_load_dword v15, v[40:41], off
  s_mov_b64 exec, -1
L_cpf1:
  v_bfe_u32 v40, v2, 1, 2
  s_lshl_b32 s53, s50, 6
  v_add_u32 v41, s53, v2
  v_mul_u32_u24 v41, 576, v41
  v_xor_b32 v42, v3, v40
  v_lshlrev_b32 v42, 4, v42
  v_add_u32 v54, v41, v42
  v_add_u32 v54, 73728, v54
  v_and_b32 v42, 1, v3
  v_lshlrev_b32 v42, 3, v42
  v_add_u32 v41, v41, v42
  v_add_u32 v41, 73728, v41
  v_lshrrev_b32 v42, 1, v3
  s_lshl_b32 s53, s51, 7
  s_mul_i32 s54, s72, 18432
  v_xor_b32 v43, v42, v40
  v_lshlrev_b32 v43, 4, v43
  v_add_u32 v43, v41, v43
  v_add_u32 v43, s53, v43
  v_add_u32 v56, s54, v43
  v_subrev_u32 v57, s54, v43
  v_add_u32 v43, 2, v42
  v_xor_b32 v43, v43, v40
  v_lshlrev_b32 v43, 4, v43
  v_add_u32 v43, v41, v43
  v_add_u32 v43, s53, v43
  v_add_u32 v58, s54, v43
  v_subrev_u32 v59, s54, v43
  s_lshr_b32 s53, s51, 1
  s_lshl_b32 s53, s53, 1
  v_add_u32 v43, s53, v42
  v_xor_b32 v43, v43, v40
  v_lshlrev_b32 v43, 4, v43
  v_add_u32 v43, v41, v43
  s_add_u32 s54, s54, 512
  v_add_u32 v60, s54, v43
  v_mov_b32 v40, 0xc0135761
  v_mov_b32 v41, 0xc0135761
  v_mov_b32 v42, 0xbdd2d3e8
  v_mov_b32 v43, 0xbdd2d3e8
  v_mov_b32 v62, 1.0
  v_mov_b32 v63, 1.0
  v_pk_mul_f32 v[44:45], v[240:241], v[240:241]
  v_pk_mul_f32 v[46:47], v[242:243], v[242:243]
  v_pk_mul_f32 v[48:49], v[244:245], v[244:245]
  v_pk_mul_f32 v[50:51], v[246:247], v[246:247]
  v_pk_fma_f32 v[44:45], v[44:45], v[42:43], v[40:41]
  v_pk_fma_f32 v[46:47], v[46:47], v[42:43], v[40:41]
  v_pk_fma_f32 v[48:49], v[48:49], v[42:43], v[40:41]
  v_pk_fma_f32 v[50:51], v[50:51], v[42:43], v[40:41]
  v_pk_mul_f32 v[44:45], v[44:45], v[240:241]
  v_pk_mul_f32 v[46:47], v[46:47], v[242:243]
  v_pk_mul_f32 v[48:49], v[48:49], v[244:245]
  v_pk_mul_f32 v[50:51], v[50:51], v[246:247]
  v_exp_f32 v44, v44
  v_exp_f32 v45, v45
  v_exp_f32 v46, v46
  v_exp_f32 v47, v47
  v_exp_f32 v48, v48
  v_exp_f32 v49, v49
  v_exp_f32 v50, v50
  v_exp_f32 v51, v51
  v_pk_mul_f32 v[248:249], v[240:241], v[248:249]
  v_pk_mul_f32 v[250:251], v[242:243], v[250:251]
  v_pk_mul_f32 v[252:253], v[244:245], v[252:253]
  v_pk_mul_f32 v[254:255], v[246:247], v[254:255]
  v_pk_add_f32 v[44:45], v[44:45], v[62:63]
  v_pk_add_f32 v[46:47], v[46:47], v[62:63]
  v_pk_add_f32 v[48:49], v[48:49], v[62:63]
  v_pk_add_f32 v[50:51], v[50:51], v[62:63]
  v_rcp_f32 v44, v44
  v_rcp_f32 v45, v45
  v_rcp_f32 v46, v46
  v_rcp_f32 v47, v47
  v_rcp_f32 v48, v48
  v_rcp_f32 v49, v49
  v_rcp_f32 v50, v50
  v_rcp_f32 v51, v51
  v_pk_mul_f32 v[248:249], v[248:249], v[44:45]
  v_pk_mul_f32 v[250:251], v[250:251], v[46:47]
  v_pk_mul_f32 v[252:253], v[252:253], v[48:49]
  v_pk_mul_f32 v[254:255], v[254:255], v[50:51]
  v_cvt_pk_bf16_f32 v240, v248, v249
  v_cvt_pk_bf16_f32 v241, v250, v251
  v_cvt_pk_bf16_f32 v244, v252, v253
  v_cvt_pk_bf16_f32 v245, v254, v255
  ds_write_b64 v60, v[240:241] offset:0
  ds_write_b64 v60, v[244:245] offset:9216
  v_pk_mul_f32 v[64:65], v[112:113], v[112:113]
  v_pk_mul_f32 v[66:67], v[114:115], v[114:115]
  v_pk_mul_f32 v[68:69], v[116:117], v[116:117]
  v_pk_mul_f32 v[70:71], v[118:119], v[118:119]
  v_pk_fma_f32 v[64:65], v[64:65], v[42:43], v[40:41]
  v_pk_fma_f32 v[66:67], v[66:67], v[42:43], v[40:41]
  v_pk_fma_f32 v[68:69], v[68:69], v[42:43], v[40:41]
  v_pk_fma_f32 v[70:71], v[70:71], v[42:43], v[40:41]
  v_pk_mul_f32 v[64:65], v[64:65], v[112:113]
  v_pk_mul_f32 v[66:67], v[66:67], v[114:115]
  v_pk_mul_f32 v[68:69], v[68:69], v[116:117]
  v_pk_mul_f32 v[70:71], v[70:71], v[118:119]
  v_exp_f32 v64, v64
  v_exp_f32 v65, v65
  v_exp_f32 v66, v66
  v_exp_f32 v67, v67
  v_exp_f32 v68, v68
  v_exp_f32 v69, v69
  v_exp_f32 v70, v70
  v_exp_f32 v71, v71
  v_pk_mul_f32 v[128:129], v[112:113], v[128:129]
  v_pk_mul_f32 v[130:131], v[114:115], v[130:131]
  v_pk_mul_f32 v[132:133], v[116:117], v[132:133]
  v_pk_mul_f32 v[134:135], v[118:119], v[134:135]
  v_pk_add_f32 v[64:65], v[64:65], v[62:63]
  v_pk_add_f32 v[66:67], v[66:67], v[62:63]
  v_pk_add_f32 v[68:69], v[68:69], v[62:63]
  v_pk_add_f32 v[70:71], v[70:71], v[62:63]
  v_rcp_f32 v64, v64
  v_rcp_f32 v65, v65
  v_rcp_f32 v66, v66
  v_rcp_f32 v67, v67
  v_rcp_f32 v68, v68
  v_rcp_f32 v69, v69
  v_rcp_f32 v70, v70
  v_rcp_f32 v71, v71
  v_pk_mul_f32 v[128:129], v[128:129], v[64:65]
  v_pk_mul_f32 v[130:131], v[130:131], v[66:67]
  v_pk_mul_f32 v[132:133], v[132:133], v[68:69]
  v_pk_mul_f32 v[134:135], v[134:135], v[70:71]
  v_cvt_pk_bf16_f32 v112, v128, v129
  v_cvt_pk_bf16_f32 v113, v130, v131
  v_cvt_pk_bf16_f32 v116, v132, v133
  v_cvt_pk_bf16_f32 v117, v134, v135
  ds_write_b64 v56, v[112:113] offset:0
  ds_write_b64 v56, v[116:117] offset:9216
  v_pk_mul_f32 v[44:45], v[120:121], v[120:121]
  v_pk_mul_f32 v[46:47], v[122:123], v[122:123]
  v_pk_mul_f32 v[48:49], v[124:125], v[124:125]
  v_pk_mul_f32 v[50:51], v[126:127], v[126:127]
  v_pk_fma_f32 v[44:45], v[44:45], v[42:43], v[40:41]
  v_pk_fma_f32 v[46:47], v[46:47], v[42:43], v[40:41]
  v_pk_fma_f32 v[48:49], v[48:49], v[42:43], v[40:41]
  v_pk_fma_f32 v[50:51], v[50:51], v[42:43], v[40:41]
  v_pk_mul_f32 v[44:45], v[44:45], v[120:121]
  v_pk_mul_f32 v[46:47], v[46:47], v[122:123]
  v_pk_mul_f32 v[48:49], v[48:49], v[124:125]
  v_pk_mul_f32 v[50:51], v[50:51], v[126:127]
  v_exp_f32 v44, v44
  v_exp_f32 v45, v45
  v_exp_f32 v46, v46
  v_exp_f32 v47, v47
  v_exp_f32 v48, v48
  v_exp_f32 v49, v49
  v_exp_f32 v50, v50
  v_exp_f32 v51, v51
  v_pk_mul_f32 v[136:137], v[120:121], v[136:137]
  v_pk_mul_f32 v[138:139], v[122:123], v[138:139]
  v_pk_mul_f32 v[140:141], v[124:125], v[140:141]
  v_pk_mul_f32 v[142:143], v[126:127], v[142:143]
  v_pk_add_f32 v[44:45], v[44:45], v[62:63]
  v_pk_add_f32 v[46:47], v[46:47], v[62:63]
  v_pk_add_f32 v[48:49], v[48:49], v[62:63]
  v_pk_add_f32 v[50:51], v[50:51], v[62:63]
  v_rcp_f32 v44, v44
  v_rcp_f32 v45, v45
  v_rcp_f32 v46, v46
  v_rcp_f32 v47, v47
  v_rcp_f32 v48, v48
  v_rcp_f32 v49, v49
  v_rcp_f32 v50, v50
  v_rcp_f32 v51, v51
  v_pk_mul_f32 v[136:137], v[136:137], v[44:45]
  v_pk_mul_f32 v[138:139], v[138:139], v[46:47]
  v_pk_mul_f32 v[140:141], v[140:141], v[48:49]
  v_pk_mul_f32 v[142:143], v[142:143], v[50:51]
  v_cvt_pk_bf16_f32 v120, v136, v137
  v_cvt_pk_bf16_f32 v121, v138, v139
  v_cvt_pk_bf16_f32 v124, v140, v141
  v_cvt_pk_bf16_f32 v125, v142, v143
  ds_write_b64 v57, v[120:121] offset:18432
  ds_write_b64 v57, v[124:125] offset:27648
  v_pk_mul_f32 v[64:65], v[144:145], v[144:145]
  v_pk_mul_f32 v[66:67], v[146:147], v[146:147]
  v_pk_mul_f32 v[68:69], v[148:149], v[148:149]
  v_pk_mul_f32 v[70:71], v[150:151], v[150:151]
  v_pk_fma_f32 v[64:65], v[64:65], v[42:43], v[40:41]
  v_pk_fma_f32 v[66:67], v[66:67], v[42:43], v[40:41]
  v_pk_fma_f32 v[68:69], v[68:69], v[42:43], v[40:41]
  v_pk_fma_f32 v[70:71], v[70:71], v[42:43], v[40:41]
  v_pk_mul_f32 v[64:65], v[64:65], v[144:145]
  v_pk_mul_f32 v[66:67], v[66:67], v[146:147]
  v_pk_mul_f32 v[68:69], v[68:69], v[148:149]
  v_pk_mul_f32 v[70:71], v[70:71], v[150:151]
  v_exp_f32 v64, v64
  v_exp_f32 v65, v65
  v_exp_f32 v66, v66
  v_exp_f32 v67, v67
  v_exp_f32 v68, v68
  v_exp_f32 v69, v69
  v_exp_f32 v70, v70
  v_exp_f32 v71, v71
  v_pk_mul_f32 v[160:161], v[144:145], v[160:161]
  v_pk_mul_f32 v[162:163], v[146:147], v[162:163]
  v_pk_mul_f32 v[164:165], v[148:149], v[164:165]
  v_pk_mul_f32 v[166:167], v[150:151], v[166:167]
  v_pk_add_f32 v[64:65], v[64:65], v[62:63]
  v_pk_add_f32 v[66:67], v[66:67], v[62:63]
  v_pk_add_f32 v[68:69], v[68:69], v[62:63]
  v_pk_add_f32 v[70:71], v[70:71], v[62:63]
  v_rcp_f32 v64, v64
  v_rcp_f32 v65, v65
  v_rcp_f32 v66, v66
  v_rcp_f32 v67, v67
  v_rcp_f32 v68, v68
  v_rcp_f32 v69, v69
  v_rcp_f32 v70, v70
  v_rcp_f32 v71, v71
  v_pk_mul_f32 v[160:161], v[160:161], v[64:65]
  v_pk_mul_f32 v[162:163], v[162:163], v[66:67]
  v_pk_mul_f32 v[164:165], v[164:165], v[68:69]
  v_pk_mul_f32 v[166:167], v[166:167], v[70:71]
  v_cvt_pk_bf16_f32 v144, v160, v161
  v_cvt_pk_bf16_f32 v145, v162, v163
  v_cvt_pk_bf16_f32 v148, v164, v165
  v_cvt_pk_bf16_f32 v149, v166, v167
  ds_write_b64 v58, v[144:145] offset:0
  ds_write_b64 v58, v[148:149] offset:9216
  v_pk_mul_f32 v[44:45], v[152:153], v[152:153]
  v_pk_mul_f32 v[46:47], v[154:155], v[154:155]
  v_pk_mul_f32 v[48:49], v[156:157], v[156:157]
  v_pk_mul_f32 v[50:51], v[158:159], v[158:159]
  v_pk_fma_f32 v[44:45], v[44:45], v[42:43], v[40:41]
  v_pk_fma_f32 v[46:47], v[46:47], v[42:43], v[40:41]
  v_pk_fma_f32 v[48:49], v[48:49], v[42:43], v[40:41]
  v_pk_fma_f32 v[50:51], v[50:51], v[42:43], v[40:41]
  v_pk_mul_f32 v[44:45], v[44:45], v[152:153]
  v_pk_mul_f32 v[46:47], v[46:47], v[154:155]
  v_pk_mul_f32 v[48:49], v[48:49], v[156:157]
  v_pk_mul_f32 v[50:51], v[50:51], v[158:159]
  v_exp_f32 v44, v44
  v_exp_f32 v45, v45
  v_exp_f32 v46, v46
  v_exp_f32 v47, v47
  v_exp_f32 v48, v48
  v_exp_f32 v49, v49
  v_exp_f32 v50, v50
  v_exp_f32 v51, v51
  v_pk_mul_f32 v[168:169], v[152:153], v[168:169]
  v_pk_mul_f32 v[170:171], v[154:155], v[170:171]
  v_pk_mul_f32 v[172:173], v[156:157], v[172:173]
  v_pk_mul_f32 v[174:175], v[158:159], v[174:175]
  v_pk_add_f32 v[44:45], v[44:45], v[62:63]
  v_pk_add_f32 v[46:47], v[46:47], v[62:63]
  v_pk_add_f32 v[48:49], v[48:49], v[62:63]
  v_pk_add_f32 v[50:51], v[50:51], v[62:63]
  v_rcp_f32 v44, v44
  v_rcp_f32 v45, v45
  v_rcp_f32 v46, v46
  v_rcp_f32 v47, v47
  v_rcp_f32 v48, v48
  v_rcp_f32 v49, v49
  v_rcp_f32 v50, v50
  v_rcp_f32 v51, v51
  v_pk_mul_f32 v[168:169], v[168:169], v[44:45]
  v_pk_mul_f32 v[170:171], v[170:171], v[46:47]
  v_pk_mul_f32 v[172:173], v[172:173], v[48:49]
  v_pk_mul_f32 v[174:175], v[174:175], v[50:51]
  v_cvt_pk_bf16_f32 v152, v168, v169
  v_cvt_pk_bf16_f32 v153, v170, v171
  v_cvt_pk_bf16_f32 v156, v172, v173
  v_cvt_pk_bf16_f32 v157, v174, v175
  ds_write_b64 v59, v[152:153] offset:18432
  ds_write_b64 v59, v[156:157] offset:27648
  v_pk_mul_f32 v[64:65], v[176:177], v[176:177]
  v_pk_mul_f32 v[66:67], v[178:179], v[178:179]
  v_pk_mul_f32 v[68:69], v[180:181], v[180:181]
  v_pk_mul_f32 v[70:71], v[182:183], v[182:183]
  v_pk_fma_f32 v[64:65], v[64:65], v[42:43], v[40:41]
  v_pk_fma_f32 v[66:67], v[66:67], v[42:43], v[40:41]
  v_pk_fma_f32 v[68:69], v[68:69], v[42:43], v[40:41]
  v_pk_fma_f32 v[70:71], v[70:71], v[42:43], v[40:41]
  v_pk_mul_f32 v[64:65], v[64:65], v[176:177]
  v_pk_mul_f32 v[66:67], v[66:67], v[178:179]
  v_pk_mul_f32 v[68:69], v[68:69], v[180:181]
  v_pk_mul_f32 v[70:71], v[70:71], v[182:183]
  v_exp_f32 v64, v64
  v_exp_f32 v65, v65
  v_exp_f32 v66, v66
  v_exp_f32 v67, v67
  v_exp_f32 v68, v68
  v_exp_f32 v69, v69
  v_exp_f32 v70, v70
  v_exp_f32 v71, v71
  v_pk_mul_f32 v[192:193], v[176:177], v[192:193]
  v_pk_mul_f32 v[194:195], v[178:179], v[194:195]
  v_pk_mul_f32 v[196:197], v[180:181], v[196:197]
  v_pk_mul_f32 v[198:199], v[182:183], v[198:199]
  v_pk_add_f32 v[64:65], v[64:65], v[62:63]
  v_pk_add_f32 v[66:67], v[66:67], v[62:63]
  v_pk_add_f32 v[68:69], v[68:69], v[62:63]
  v_pk_add_f32 v[70:71], v[70:71], v[62:63]
  v_rcp_f32 v64, v64
  v_rcp_f32 v65, v65
  v_rcp_f32 v66, v66
  v_rcp_f32 v67, v67
  v_rcp_f32 v68, v68
  v_rcp_f32 v69, v69
  v_rcp_f32 v70, v70
  v_rcp_f32 v71, v71
  v_pk_mul_f32 v[192:193], v[192:193], v[64:65]
  v_pk_mul_f32 v[194:195], v[194:195], v[66:67]
  v_pk_mul_f32 v[196:197], v[196:197], v[68:69]
  v_pk_mul_f32 v[198:199], v[198:199], v[70:71]
  v_cvt_pk_bf16_f32 v176, v192, v193
  v_cvt_pk_bf16_f32 v177, v194, v195
  v_cvt_pk_bf16_f32 v180, v196, v197
  v_cvt_pk_bf16_f32 v181, v198, v199
  ds_write_b64 v56, v[176:177] offset:64
  ds_write_b64 v56, v[180:181] offset:9280
  v_pk_mul_f32 v[44:45], v[184:185], v[184:185]
  v_pk_mul_f32 v[46:47], v[186:187], v[186:187]
  v_pk_mul_f32 v[48:49], v[188:189], v[188:189]
  v_pk_mul_f32 v[50:51], v[190:191], v[190:191]
  v_pk_fma_f32 v[44:45], v[44:45], v[42:43], v[40:41]
  v_pk_fma_f32 v[46:47], v[46:47], v[42:43], v[40:41]
  v_pk_fma_f32 v[48:49], v[48:49], v[42:43], v[40:41]
  v_pk_fma_f32 v[50:51], v[50:51], v[42:43], v[40:41]
  v_pk_mul_f32 v[44:45], v[44:45], v[184:185]
  v_pk_mul_f32 v[46:47], v[46:47], v[186:187]
  v_pk_mul_f32 v[48:49], v[48:49], v[188:189]
  v_pk_mul_f32 v[50:51], v[50:51], v[190:191]
  v_exp_f32 v44, v44
  v_exp_f32 v45, v45
  v_exp_f32 v46, v46
  v_exp_f32 v47, v47
  v_exp_f32 v48, v48
  v_exp_f32 v49, v49
  v_exp_f32 v50, v50
  v_exp_f32 v51, v51
  v_pk_mul_f32 v[200:201], v[184:185], v[200:201]
  v_pk_mul_f32 v[202:203], v[186:187], v[202:203]
  v_pk_mul_f32 v[204:205], v[188:189], v[204:205]
  v_pk_mul_f32 v[206:207], v[190:191], v[206:207]
  v_pk_add_f32 v[44:45], v[44:45], v[62:63]
  v_pk_add_f32 v[46:47], v[46:47], v[62:63]
  v_pk_add_f32 v[48:49], v[48:49], v[62:63]
  v_pk_add_f32 v[50:51], v[50:51], v[62:63]
  v_rcp_f32 v44, v44
  v_rcp_f32 v45, v45
  v_rcp_f32 v46, v46
  v_rcp_f32 v47, v47
  v_rcp_f32 v48, v48
  v_rcp_f32 v49, v49
  v_rcp_f32 v50, v50
  v_rcp_f32 v51, v51
  v_pk_mul_f32 v[200:201], v[200:201], v[44:45]
  v_pk_mul_f32 v[202:203], v[202:203], v[46:47]
  v_pk_mul_f32 v[204:205], v[204:205], v[48:49]
  v_pk_mul_f32 v[206:207], v[206:207], v[50:51]
  v_cvt_pk_bf16_f32 v184, v200, v201
  v_cvt_pk_bf16_f32 v185, v202, v203
  v_cvt_pk_bf16_f32 v188, v204, v205
  v_cvt_pk_bf16_f32 v189, v206, v207
  ds_write_b64 v57, v[184:185] offset:18496
  ds_write_b64 v57, v[188:189] offset:27712
  v_pk_mul_f32 v[64:65], v[208:209], v[208:209]
  v_pk_mul_f32 v[66:67], v[210:211], v[210:211]
  v_pk_mul_f32 v[68:69], v[212:213], v[212:213]
  v_pk_mul_f32 v[70:71], v[214:215], v[214:215]
  v_pk_fma_f32 v[64:65], v[64:65], v[42:43], v[40:41]
  v_pk_fma_f32 v[66:67], v[66:67], v[42:43], v[40:41]
  v_pk_fma_f32 v[68:69], v[68:69], v[42:43], v[40:41]
  v_pk_fma_f32 v[70:71], v[70:71], v[42:43], v[40:41]
  v_pk_mul_f32 v[64:65], v[64:65], v[208:209]
  v_pk_mul_f32 v[66:67], v[66:67], v[210:211]
  v_pk_mul_f32 v[68:69], v[68:69], v[212:213]
  v_pk_mul_f32 v[70:71], v[70:71], v[214:215]
  v_exp_f32 v64, v64
  v_exp_f32 v65, v65
  v_exp_f32 v66, v66
  v_exp_f32 v67, v67
  v_exp_f32 v68, v68
  v_exp_f32 v69, v69
  v_exp_f32 v70, v70
  v_exp_f32 v71, v71
  v_pk_mul_f32 v[224:225], v[208:209], v[224:225]
  v_pk_mul_f32 v[226:227], v[210:211], v[226:227]
  v_pk_mul_f32 v[228:229], v[212:213], v[228:229]
  v_pk_mul_f32 v[230:231], v[214:215], v[230:231]
  v_pk_add_f32 v[64:65], v[64:65], v[62:63]
  v_pk_add_f32 v[66:67], v[66:67], v[62:63]
  v_pk_add_f32 v[68:69], v[68:69], v[62:63]
  v_pk_add_f32 v[70:71], v[70:71], v[62:63]
  v_rcp_f32 v64, v64
  v_rcp_f32 v65, v65
  v_rcp_f32 v66, v66
  v_rcp_f32 v67, v67
  v_rcp_f32 v68, v68
  v_rcp_f32 v69, v69
  v_rcp_f32 v70, v70
  v_rcp_f32 v71, v71
  v_pk_mul_f32 v[224:225], v[224:225], v[64:65]
  v_pk_mul_f32 v[226:227], v[226:227], v[66:67]
  v_pk_mul_f32 v[228:229], v[228:229], v[68:69]
  v_pk_mul_f32 v[230:231], v[230:231], v[70:71]
  v_cvt_pk_bf16_f32 v208, v224, v225
  v_cvt_pk_bf16_f32 v209, v226, v227
  v_cvt_pk_bf16_f32 v212, v228, v229
  v_cvt_pk_bf16_f32 v213, v230, v231
  ds_write_b64 v58, v[208:209] offset:64
  ds_write_b64 v58, v[212:213] offset:9280
  v_pk_mul_f32 v[44:45], v[216:217], v[216:217]
  v_pk_mul_f32 v[46:47], v[218:219], v[218:219]
  v_pk_mul_f32 v[48:49], v[220:221], v[220:221]
  v_pk_mul_f32 v[50:51], v[222:223], v[222:223]
  v_pk_fma_f32 v[44:45], v[44:45], v[42:43], v[40:41]
  v_pk_fma_f32 v[46:47], v[46:47], v[42:43], v[40:41]
  v_pk_fma_f32 v[48:49], v[48:49], v[42:43], v[40:41]
  v_pk_fma_f32 v[50:51], v[50:51], v[42:43], v[40:41]
  v_pk_mul_f32 v[44:45], v[44:45], v[216:217]
  v_pk_mul_f32 v[46:47], v[46:47], v[218:219]
  v_pk_mul_f32 v[48:49], v[48:49], v[220:221]
  v_pk_mul_f32 v[50:51], v[50:51], v[222:223]
  v_exp_f32 v44, v44
  v_exp_f32 v45, v45
  v_exp_f32 v46, v46
  v_exp_f32 v47, v47
  v_exp_f32 v48, v48
  v_exp_f32 v49, v49
  v_exp_f32 v50, v50
  v_exp_f32 v51, v51
  v_pk_mul_f32 v[232:233], v[216:217], v[232:233]
  v_pk_mul_f32 v[234:235], v[218:219], v[234:235]
  v_pk_mul_f32 v[236:237], v[220:221], v[236:237]
  v_pk_mul_f32 v[238:239], v[222:223], v[238:239]
  v_pk_add_f32 v[44:45], v[44:45], v[62:63]
  v_pk_add_f32 v[46:47], v[46:47], v[62:63]
  v_pk_add_f32 v[48:49], v[48:49], v[62:63]
  v_pk_add_f32 v[50:51], v[50:51], v[62:63]
  v_rcp_f32 v44, v44
  v_rcp_f32 v45, v45
  v_rcp_f32 v46, v46
  v_rcp_f32 v47, v47
  v_rcp_f32 v48, v48
  v_rcp_f32 v49, v49
  v_rcp_f32 v50, v50
  v_rcp_f32 v51, v51
  v_pk_mul_f32 v[232:233], v[232:233], v[44:45]
  v_pk_mul_f32 v[234:235], v[234:235], v[46:47]
  v_pk_mul_f32 v[236:237], v[236:237], v[48:49]
  v_pk_mul_f32 v[238:239], v[238:239], v[50:51]
  v_cvt_pk_bf16_f32 v216, v232, v233
  v_cvt_pk_bf16_f32 v217, v234, v235
  v_cvt_pk_bf16_f32 v220, v236, v237
  v_cvt_pk_bf16_f32 v221, v238, v239
  ds_write_b64 v59, v[216:217] offset:18496
  ds_write_b64 v59, v[220:221] offset:27712
  s_waitcnt vmcnt(8)
  v_lshlrev_b32 v136, 16, v102
  v_and_b32 v140, 0xffff0000, v102
  v_lshlrev_b32 v144, 16, v103
  v_and_b32 v148, 0xffff0000, v103
  v_lshlrev_b32 v137, 16, v104
  v_and_b32 v141, 0xffff0000, v104
  v_lshlrev_b32 v145, 16, v105
  v_and_b32 v149, 0xffff0000, v105
  s_waitcnt vmcnt(7)
  v_lshlrev_b32 v138, 16, v106
  v_and_b32 v142, 0xffff0000, v106
  v_lshlrev_b32 v146, 16, v107
  v_and_b32 v150, 0xffff0000, v107
  v_lshlrev_b32 v139, 16, v108
  v_and_b32 v143, 0xffff0000, v108
  v_lshlrev_b32 v147, 16, v109
  v_and_b32 v151, 0xffff0000, v109
  v_lshlrev_b32 v152, 16, v80
  v_and_b32 v153, 0xffff0000, v80
  v_lshlrev_b32 v154, 16, v81
  v_and_b32 v155, 0xffff0000, v81
  v_lshlrev_b32 v156, 16, v82
  v_and_b32 v157, 0xffff0000, v82
  v_lshlrev_b32 v158, 16, v83
  v_and_b32 v159, 0xffff0000, v83
  v_lshlrev_b32 v160, 16, v84
  v_and_b32 v161, 0xffff0000, v84
  v_lshlrev_b32 v162, 16, v85
  v_and_b32 v163, 0xffff0000, v85
  v_lshlrev_b32 v164, 16, v86
  v_and_b32 v165, 0xffff0000, v86
  v_lshlrev_b32 v166, 16, v87
  v_and_b32 v167, 0xffff0000, v87
  v_lshlrev_b32 v168, 16, v88
  v_and_b32 v169, 0xffff0000, v88
  v_lshlrev_b32 v170, 16, v89
  v_and_b32 v171, 0xffff0000, v89
  v_lshlrev_b32 v172, 16, v90
  v_and_b32 v173, 0xffff0000, v90
  v_lshlrev_b32 v174, 16, v91
  v_and_b32 v175, 0xffff0000, v91
  v_lshlrev_b32 v176, 16, v92
  v_and_b32 v177, 0xffff0000, v92
  v_lshlrev_b32 v178, 16, v93
  v_and_b32 v179, 0xffff0000, v93
  v_lshlrev_b32 v180, 16, v94
  v_and_b32 v181, 0xffff0000, v94
  v_lshlrev_b32 v182, 16, v95
  v_and_b32 v183, 0xffff0000, v95
  v_lshlrev_b32 v184, 16, v96
  v_and_b32 v185, 0xffff0000, v96
  v_lshlrev_b32 v186, 16, v97
  v_and_b32 v187, 0xffff0000, v97
  v_lshlrev_b32 v188, 16, v98
  v_and_b32 v189, 0xffff0000, v98
  v_lshlrev_b32 v190, 16, v99
  v_and_b32 v191, 0xffff0000, v99
  v_lshlrev_b32 v192, 16, v100
  v_and_b32 v193, 0xffff0000, v100
  v_lshlrev_b32 v194, 16, v101
  v_and_b32 v195, 0xffff0000, v101
  v_pk_mul_f32 v[200:201], v[164:165], v[136:137]
  v_pk_mul_f32 v[202:203], v[166:167], v[138:139]
  v_pk_mul_f32 v[204:205], v[168:169], v[136:137]
  v_pk_mul_f32 v[206:207], v[170:171], v[138:139]
  v_pk_mul_f32 v[208:209], v[172:173], v[136:137]
  v_pk_mul_f32 v[210:211], v[174:175], v[138:139]
  v_pk_mul_f32 v[212:213], v[176:177], v[136:137]
  v_pk_mul_f32 v[214:215], v[178:179], v[138:139]
  v_pk_fma_f32 v[200:201], v[160:161], v[140:141], v[200:201]
  v_pk_fma_f32 v[202:203], v[162:163], v[142:143], v[202:203]
  v_pk_fma_f32 v[204:205], v[164:165], v[140:141], v[204:205]
  v_pk_fma_f32 v[206:207], v[166:167], v[142:143], v[206:207]
  v_pk_fma_f32 v[208:209], v[168:169], v[140:141], v[208:209]
  v_pk_fma_f32 v[210:211], v[170:171], v[142:143], v[210:211]
  v_pk_fma_f32 v[212:213], v[172:173], v[140:141], v[212:213]
  v_pk_fma_f32 v[214:215], v[174:175], v[142:143], v[214:215]
  v_pk_fma_f32 v[200:201], v[156:157], v[144:145], v[200:201]
  v_pk_fma_f32 v[202:203], v[158:159], v[146:147], v[202:203]
  v_pk_fma_f32 v[204:205], v[160:161], v[144:145], v[204:205]
  v_pk_fma_f32 v[206:207], v[162:163], v[146:147], v[206:207]
  v_pk_fma_f32 v[208:209], v[164:165], v[144:145], v[208:209]
  v_pk_fma_f32 v[210:211], v[166:167], v[146:147], v[210:211]
  v_pk_fma_f32 v[212:213], v[168:169], v[144:145], v[212:213]
  v_pk_fma_f32 v[214:215], v[170:171], v[146:147], v[214:215]
  v_pk_fma_f32 v[200:201], v[152:153], v[148:149], v[200:201]
  v_pk_fma_f32 v[202:203], v[154:155], v[150:151], v[202:203]
  v_pk_fma_f32 v[204:205], v[156:157], v[148:149], v[204:205]
  v_pk_fma_f32 v[206:207], v[158:159], v[150:151], v[206:207]
  v_pk_fma_f32 v[208:209], v[160:161], v[148:149], v[208:209]
  v_pk_fma_f32 v[210:211], v[162:163], v[150:151], v[210:211]
  v_pk_fma_f32 v[212:213], v[164:165], v[148:149], v[212:213]
  v_pk_fma_f32 v[214:215], v[166:167], v[150:151], v[214:215]
  v_pk_mul_f32 v[200:201], v[200:201], v[180:181]
  v_pk_mul_f32 v[202:203], v[202:203], v[182:183]
  v_pk_mul_f32 v[204:205], v[204:205], v[184:185]
  v_pk_mul_f32 v[206:207], v[206:207], v[186:187]
  v_pk_mul_f32 v[208:209], v[208:209], v[188:189]
  v_pk_mul_f32 v[210:211], v[210:211], v[190:191]
  v_pk_mul_f32 v[212:213], v[212:213], v[192:193]
  v_pk_mul_f32 v[214:215], v[214:215], v[194:195]
  v_cvt_pk_bf16_f32 v216, v200, v204
  v_cvt_pk_bf16_f32 v217, v208, v212
  v_cvt_pk_bf16_f32 v218, v201, v205
  v_cvt_pk_bf16_f32 v219, v209, v213
  v_cvt_pk_bf16_f32 v220, v202, v206
  v_cvt_pk_bf16_f32 v221, v210, v214
  v_cvt_pk_bf16_f32 v222, v203, v207
  v_cvt_pk_bf16_f32 v223, v211, v215
  v_and_b32 v224, 15, v0
  v_lshrrev_b32 v225, 5, v0
  v_xor_b32 v225, v225, v224
  v_lshlrev_b32 v225, 4, v225
  v_lshlrev_b32 v224, 10, v224
  v_add_u32 v224, v224, v225
  v_bfe_u32 v225, v0, 4, 1
  v_lshlrev_b32 v225, 3, v225
  v_add_u32 v224, v224, v225
  v_add_u32 v224, 147456, v224
  ds_write_b64 v224, v[216:217] offset:0
  ds_write_b64 v224, v[218:219] offset:256
  ds_write_b64 v224, v[220:221] offset:512
  ds_write_b64 v224, v[222:223] offset:768
  s_waitcnt lgkmcnt(0)
  s_barrier
  ds_read_b128 v[112:115], v54 offset:0
  ds_read_b128 v[148:151], v54 offset:9216
  ds_read_b128 v[184:187], v54 offset:18432
  ds_read_b128 v[220:223], v54 offset:27648
  ds_read_b128 v[116:119], v54 offset:64
  ds_read_b128 v[152:155], v54 offset:9280
  ds_read_b128 v[188:191], v54 offset:18496
  ds_read_b128 v[224:227], v54 offset:27712
  ds_read_b64_tr_b16 v[56:57], v18 offset:0
  ds_read_b64_tr_b16 v[58:59], v18 offset:512
  ds_read_b64_tr_b16 v[60:61], v18 offset:4096
  ds_read_b64_tr_b16 v[62:63], v18 offset:4608
  s_waitcnt vmcnt(0) lgkmcnt(0)
  s_cmp_ge_u32 s44, 4
  s_cbranch_scc1 L_g2B
  v_lshlrev_b32 v4, 4, v1
  s_lshl_b32 s53, s51, 11
  s_add_u32 s53, s53, 147456
  v_add_u32 v4, s53, v4
  ds_read_b128 v[120:123], v54 offset:128
  ds_read_b128 v[156:159], v54 offset:9344
  ds_read_b128 v[192:195], v54 offset:18560
  ds_read_b128 v[228:231], v54 offset:27776
  v_mfma_f32_16x16x32_bf16 v[80:83], v[56:59], v[112:115], 0
  v_mfma_f32_16x16x32_bf16 v[84:87], v[56:59], v[148:151], 0
  ds_read_b64_tr_b16 v[64:65], v18 offset:8192
  ds_read_b64_tr_b16 v[66:67], v18 offset:8704
  v_mfma_f32_16x16x32_bf16 v[88:91], v[56:59], v[184:187], 0
  v_mfma_f32_16x16x32_bf16 v[92:95], v[56:59], v[220:223], 0
  ds_read_b128 v[124:127], v54 offset:192
  ds_read_b128 v[160:163], v54 offset:9408
  ds_read_b128 v[196:199], v54 offset:18624
  ds_read_b128 v[232:235], v54 offset:27840
  v_mfma_f32_16x16x32_bf16 v[80:83], v[60:63], v[116:119], v[80:83]
  v_mfma_f32_16x16x32_bf16 v[84:87], v[60:63], v[152:155], v[84:87]
  ds_read_b64_tr_b16 v[68:69], v18 offset:12288
  ds_read_b64_tr_b16 v[70:71], v18 offset:12800
  v_mfma_f32_16x16x32_bf16 v[88:91], v[60:63], v[188:191], v[88:91]
  v_mfma_f32_16x16x32_bf16 v[92:95], v[60:63], v[224:227], v[92:95]
  ds_read_b128 v[128:131], v54 offset:256
  ds_read_b128 v[164:167], v54 offset:9472
  ds_read_b128 v[200:203], v54 offset:18688
  ds_read_b128 v[236:239], v54 offset:27904
  s_waitcnt lgkmcnt(10)
  v_mfma_f32_16x16x32_bf16 v[80:83], v[64:67], v[120:123], v[80:83]
  v_mfma_f32_16x16x32_bf16 v[84:87], v[64:67], v[156:159], v[84:87]
  ds_read_b64_tr_b16 v[72:73], v18 offset:16384
  ds_read_b64_tr_b16 v[74:75], v18 offset:16896
  v_mfma_f32_16x16x32_bf16 v[88:91], v[64:67], v[192:195], v[88:91]
  ds_read_b128 v[132:135], v54 offset:320
  ds_read_b128 v[168:171], v54 offset:9536
  ds_read_b128 v[204:207], v54 offset:18752
  ds_read_b128 v[240:243], v54 offset:27968
  v_mfma_f32_16x16x32_bf16 v[92:95], v[64:67], v[228:231], v[92:95]
  s_waitcnt lgkmcnt(10)
  v_mfma_f32_16x16x32_bf16 v[80:83], v[68:71], v[124:127], v[80:83]
  ds_read_b64_tr_b16 v[76:77], v18 offset:20480
  ds_read_b64_tr_b16 v[78:79], v18 offset:20992
  v_mfma_f32_16x16x32_bf16 v[84:87], v[68:71], v[160:163], v[84:87]
  ds_read_b128 v[136:139], v54 offset:384
  ds_read_b128 v[172:175], v54 offset:9600
  ds_read_b128 v[208:211], v54 offset:18816
  ds_read_b128 v[244:247], v54 offset:28032
  v_mfma_f32_16x16x32_bf16 v[88:91], v[68:71], v[196:199], v[88:91]
  v_mfma_f32_16x16x32_bf16 v[92:95], v[68:71], v[232:235], v[92:95]
  ds_read_b64_tr_b16 v[56:57], v18 offset:24576
  ds_read_b64_tr_b16 v[58:59], v18 offset:25088
  ds_read_b128 v[140:143], v54 offset:448
  ds_read_b128 v[176:179], v54 offset:9664
  ds_read_b128 v[212:215], v54 offset:18880
  ds_read_b128 v[248:251], v54 offset:28096
  s_waitcnt lgkmcnt(15)
  v_mfma_f32_16x16x32_bf16 v[80:83], v[72:75], v[128:131], v[80:83]
  v_mfma_f32_16x16x32_bf16 v[84:87], v[72:75], v[164:167], v[84:87]
  ds_read_b64_tr_b16 v[60:61], v18 offset:28672
  ds_read_b64_tr_b16 v[62:63], v18 offset:29184
  ds_read_b128 v[144:147], v54 offset:512
  ds_read_b128 v[180:183], v54 offset:9728
  ds_read_b128 v[216:219], v54 offset:18944
  ds_read_b128 v[252:255], v54 offset:28160
  v_mfma_f32_16x16x32_bf16 v[88:91], v[72:75], v[200:203], v[88:91]
  v_mfma_f32_16x16x32_bf16 v[92:95], v[72:75], v[236:239], v[92:95]
  ds_read_b64_tr_b16 v[64:65], v18 offset:32768
  ds_read_b64_tr_b16 v[66:67], v18 offset:33280
  s_waitcnt lgkmcnt(15)
  v_mfma_f32_16x16x32_bf16 v[80:83], v[76:79], v[132:135], v[80:83]
  v_mfma_f32_16x16x32_bf16 v[84:87], v[76:79], v[168:171], v[84:87]
  v_mfma_f32_16x16x32_bf16 v[88:91], v[76:79], v[204:207], v[88:91]
  v_mfma_f32_16x16x32_bf16 v[92:95], v[76:79], v[240:243], v[92:95]
  s_waitcnt lgkmcnt(12)
  v_mfma_f32_16x16x32_bf16 v[80:83], v[56:59], v[136:139], v[80:83]
  v_mfma_f32_16x16x32_bf16 v[84:87], v[56:59], v[172:175], v[84:87]
  v_mfma_f32_16x16x32_bf16 v[88:91], v[56:59], v[208:211], v[88:91]
  v_mfma_f32_16x16x32_bf16 v[92:95], v[56:59], v[244:247], v[92:95]
  s_waitcnt lgkmcnt(0)
  s_barrier
  v_add_u32 v18, 36864, v18
  v_mfma_f32_16x16x32_bf16 v[80:83], v[60:63], v[140:143], v[80:83]
  v_mfma_f32_16x16x32_bf16 v[84:87], v[60:63], v[176:179], v[84:87]
  ds_read_b64_tr_b16 v[68:69], v18 offset:0
  ds_read_b64_tr_b16 v[70:71], v18 offset:512
  s_add_u32 m0, s47, 73728
  s_mov_b32 s49, 256
  buffer_load_dwordx4 v16, s[20:23], s49 offen lds
  v_mfma_f32_16x16x32_bf16 v[88:91], v[60:63], v[212:215], v[88:91]
  v_mfma_f32_16x16x32_bf16 v[92:95], v[60:63], v[248:251], v[92:95]
  s_add_u32 m0, s47, 77824
  s_mov_b32 s49, 37120
  buffer_load_dwordx4 v16, s[20:23], s49 offen lds
  v_mfma_f32_16x16x32_bf16 v[80:83], v[64:67], v[144:147], v[80:83]
  v_mfma_f32_16x16x32_bf16 v[84:87], v[64:67], v[180:183], v[84:87]
  ds_read_b64_tr_b16 v[72:73], v18 offset:4096
  ds_read_b64_tr_b16 v[74:75], v18 offset:4608
  s_add_u32 m0, s47, 81920
  s_mov_b32 s49, 73984
  buffer_load_dwordx4 v16, s[20:23], s49 offen lds
  v_mfma_f32_16x16x32_bf16 v[88:91], v[64:67], v[216:219], v[88:91]
  v_mfma_f32_16x16x32_bf16 v[92:95], v[64:67], v[252:255], v[92:95]
  s_waitcnt lgkmcnt(2)
  v_mfma_f32_16x16x32_bf16 v[96:99], v[68:71], v[112:115], 0
  s_add_u32 m0, s47, 86016
  s_mov_b32 s49, 110848
  buffer_load_dwordx4 v16, s[20:23], s49 offen lds
  v_mfma_f32_16x16x32_bf16 v[100:103], v[68:71], v[148:151], 0
  ds_read_b64_tr_b16 v[76:77], v18 offset:8192
  ds_read_b64_tr_b16 v[78:79], v18 offset:8704
  s_add_u32 m0, s47, 90112
  s_mov_b32 s49, 147712
  buffer_load_dwordx4 v16, s[20:23], s49 offen lds
  v_cvt_pk_bf16_f32 v40, v80, v81
  v_cvt_pk_bf16_f32 v41, v82, v83
  v_mfma_f32_16x16x32_bf16 v[104:107], v[68:71], v[184:187], 0
  v_cvt_pk_bf16_f32 v42, v84, v85
  v_mfma_f32_16x16x32_bf16 v[108:111], v[68:71], v[220:223], 0
  s_add_u32 m0, s47, 94208
  s_mov_b32 s49, 184576
  buffer_load_dwordx4 v16, s[20:23], s49 offen lds
  v_cvt_pk_bf16_f32 v43, v86, v87
  s_waitcnt lgkmcnt(2)
  v_mfma_f32_16x16x32_bf16 v[96:99], v[72:75], v[116:119], v[96:99]
  v_cvt_pk_bf16_f32 v44, v88, v89
  v_mfma_f32_16x16x32_bf16 v[100:103], v[72:75], v[152:155], v[100:103]
  ds_read_b64_tr_b16 v[56:57], v18 offset:12288
  ds_read_b64_tr_b16 v[58:59], v18 offset:12800
  s_add_u32 m0, s47, 98304
  s_mov_b32 s49, 221440
  buffer_load_dwordx4 v16, s[20:23], s49 offen lds
  v_cvt_pk_bf16_f32 v45, v90, v91
  v_mfma_f32_16x16x32_bf16 v[104:107], v[72:75], v[188:191], v[104:107]
  s_add_u32 m0, s47, 102400
  s_mov_b32 s49, 258304
  buffer_load_dwordx4 v16, s[20:23], s49 offen lds
  v_cvt_pk_bf16_f32 v46, v92, v93
  v_cvt_pk_bf16_f32 v47, v94, v95
  v_mfma_f32_16x16x32_bf16 v[108:111], v[72:75], v[224:227], v[108:111]
  v_permlane16_swap_b32 v40, v42
  s_waitcnt lgkmcnt(2)
  v_mfma_f32_16x16x32_bf16 v[96:99], v[76:79], v[120:123], v[96:99]
  s_add_u32 m0, s47, 106496
  s_mov_b32 s49, 295168
  buffer_load_dwordx4 v16, s[20:23], s49 offen lds
  v_permlane16_swap_b32 v41, v43
  v_mfma_f32_16x16x32_bf16 v[100:103], v[76:79], v[156:159], v[100:103]
  ds_read_b64_tr_b16 v[60:61], v18 offset:16384
  ds_read_b64_tr_b16 v[62:63], v18 offset:16896
  v_permlane16_swap_b32 v44, v46
  v_mfma_f32_16x16x32_bf16 v[104:107], v[76:79], v[192:195], v[104:107]
  s_add_u32 m0, s47, 0
  s_mov_b32 s49, 384
  buffer_load_dwordx4 v16, s[20:23], s49 offen lds
  v_permlane16_swap_b32 v45, v47
  v_mfma_f32_16x16x32_bf16 v[108:111], v[76:79], v[228:231], v[108:111]
  s_waitcnt lgkmcnt(2)
  v_mfma_f32_16x16x32_bf16 v[96:99], v[56:59], v[124:127], v[96:99]
  ds_read_b64_tr_b16 v[64:65], v18 offset:20480
  ds_read_b64_tr_b16 v[66:67], v18 offset:20992
  s_add_u32 m0, s47, 4096
  s_mov_b32 s49, 37248
  buffer_load_dwordx4 v16, s[20:23], s49 offen lds
  v_mfma_f32_16x16x32_bf16 v[100:103], v[56:59], v[160:163], v[100:103]
  s_add_u32 m0, s47, 8192
  s_mov_b32 s49, 74112
  buffer_load_dwordx4 v16, s[20:23], s49 offen lds
  v_mfma_f32_16x16x32_bf16 v[104:107], v[56:59], v[196:199], v[104:107]
  v_mfma_f32_16x16x32_bf16 v[108:111], v[56:59], v[232:235], v[108:111]
  ds_read_b64_tr_b16 v[68:69], v18 offset:24576
  ds_read_b64_tr_b16 v[70:71], v18 offset:25088
  s_add_u32 m0, s47, 12288
  s_mov_b32 s49, 110976
  buffer_load_dwordx4 v16, s[20:23], s49 offen lds
  s_waitcnt lgkmcnt(4)
  v_mfma_f32_16x16x32_bf16 v[96:99], v[60:63], v[128:131], v[96:99]
  v_mfma_f32_16x16x32_bf16 v[100:103], v[60:63], v[164:167], v[100:103]
  ds_read_b64_tr_b16 v[72:73], v18 offset:28672
  ds_read_b64_tr_b16 v[74:75], v18 offset:29184
  s_add_u32 m0, s47, 16384
  s_mov_b32 s49, 147840
  buffer_load_dwordx4 v16, s[20:23], s49 offen lds
  v_mfma_f32_16x16x32_bf16 v[104:107], v[60:63], v[200:203], v[104:107]
  v_mfma_f32_16x16x32_bf16 v[108:111], v[60:63], v[236:239], v[108:111]
  ds_read_b64_tr_b16 v[76:77], v18 offset:32768
  ds_read_b64_tr_b16 v[78:79], v18 offset:33280
  s_add_u32 m0, s47, 20480
  s_mov_b32 s49, 184704
  buffer_load_dwordx4 v16, s[20:23], s49 offen lds
  s_waitcnt lgkmcnt(6)
  v_mfma_f32_16x16x32_bf16 v[96:99], v[64:67], v[132:135], v[96:99]
  s_add_u32 m0, s47, 24576
  s_mov_b32 s49, 221568
  buffer_load_dwordx4 v16, s[20:23], s49 offen lds
  v_mfma_f32_16x16x32_bf16 v[100:103], v[64:67], v[168:171], v[100:103]
  ds_write_b128 v4, v[40:43] offset:0
  ds_write_b128 v4, v[44:47] offset:1024
  v_mfma_f32_16x16x32_bf16 v[104:107], v[64:67], v[204:207], v[104:107]
  s_add_u32 m0, s47, 28672
  s_mov_b32 s49, 258432
  buffer_load_dwordx4 v16, s[20:23], s49 offen lds
  v_mfma_f32_16x16x32_bf16 v[108:111], v[64:67], v[240:243], v[108:111]
  s_waitcnt lgkmcnt(6)
  v_mfma_f32_16x16x32_bf16 v[96:99], v[68:71], v[136:139], v[96:99]
  s_add_u32 m0, s47, 32768
  s_mov_b32 s49, 295296
  buffer_load_dwordx4 v16, s[20:23], s49 offen lds
  v_mfma_f32_16x16x32_bf16 v[100:103], v[68:71], v[172:175], v[100:103]
  v_mfma_f32_16x16x32_bf16 v[104:107], v[68:71], v[208:211], v[104:107]
  v_mfma_f32_16x16x32_bf16 v[108:111], v[68:71], v[244:247], v[108:111]
  s_waitcnt lgkmcnt(0)
  s_waitcnt vmcnt(9)
  s_barrier
  v_add_u32 v18, 36864, v18
  v_mfma_f32_16x16x32_bf16 v[96:99], v[72:75], v[140:143], v[96:99]
  v_mfma_f32_16x16x32_bf16 v[100:103], v[72:75], v[176:179], v[100:103]
  ds_read_b64_tr_b16 v[56:57], v18 offset:0
  ds_read_b64_tr_b16 v[58:59], v18 offset:512
  s_add_u32 m0, s47, 36864
  s_mov_b32 s49, 512
  buffer_load_dwordx4 v16, s[20:23], s49 offen lds
  v_mfma_f32_16x16x32_bf16 v[104:107], v[72:75], v[212:215], v[104:107]
  v_mfma_f32_16x16x32_bf16 v[108:111], v[72:75], v[248:251], v[108:111]
  v_mfma_f32_16x16x32_bf16 v[96:99], v[76:79], v[144:147], v[96:99]
  s_add_u32 m0, s47, 40960
  s_mov_b32 s49, 37376
  buffer_load_dwordx4 v16, s[20:23], s49 offen lds
  v_mfma_f32_16x16x32_bf16 v[100:103], v[76:79], v[180:183], v[100:103]
  ds_read_b64_tr_b16 v[60:61], v18 offset:4096
  ds_read_b64_tr_b16 v[62:63], v18 offset:4608
  v_mfma_f32_16x16x32_bf16 v[104:107], v[76:79], v[216:219], v[104:107]
  v_mfma_f32_16x16x32_bf16 v[108:111], v[76:79], v[252:255], v[108:111]
  s_waitcnt lgkmcnt(2)
  v_mfma_f32_16x16x32_bf16 v[80:83], v[56:59], v[112:115], 0
  s_add_u32 m0, s47, 45056
  s_mov_b32 s49, 74240
  buffer_load_dwordx4 v16, s[20:23], s49 offen lds
  v_mfma_f32_16x16x32_bf16 v[84:87], v[56:59], v[148:151], 0
  ds_read_b64_tr_b16 v[64:65], v18 offset:8192
  ds_read_b64_tr_b16 v[66:67], v18 offset:8704
  v_cvt_pk_bf16_f32 v40, v96, v97
  v_cvt_pk_bf16_f32 v41, v98, v99
  v_mfma_f32_16x16x32_bf16 v[88:91], v[56:59], v[184:187], 0
  v_cvt_pk_bf16_f32 v42, v100, v101
  v_mfma_f32_16x16x32_bf16 v[92:95], v[56:59], v[220:223], 0
  s_add_u32 m0, s47, 49152
  s_mov_b32 s49, 111104
  buffer_load_dwordx4 v16, s[20:23], s49 offen lds
  v_cvt_pk_bf16_f32 v43, v102, v103
  s_waitcnt lgkmcnt(2)
  v_mfma_f32_16x16x32_bf16 v[80:83], v[60:63], v[116:119], v[80:83]
  v_cvt_pk_bf16_f32 v44, v104, v105
  v_mfma_f32_16x16x32_bf16 v[84:87], v[60:63], v[152:155], v[84:87]
  ds_read_b64_tr_b16 v[68:69], v18 offset:12288
  ds_read_b64_tr_b16 v[70:71], v18 offset:12800
  v_cvt_pk_bf16_f32 v45, v106, v107
  v_mfma_f32_16x16x32_bf16 v[88:91], v[60:63], v[188:191], v[88:91]
  v_cvt_pk_bf16_f32 v46, v108, v109
  v_cvt_pk_bf16_f32 v47, v110, v111
  v_mfma_f32_16x16x32_bf16 v[92:95], v[60:63], v[224:227], v[92:95]
  s_add_u32 m0, s47, 53248
  s_mov_b32 s49, 147968
  buffer_load_dwordx4 v16, s[20:23], s49 offen lds
  v_permlane16_swap_b32 v40, v42
  s_waitcnt lgkmcnt(2)
  v_mfma_f32_16x16x32_bf16 v[80:83], v[64:67], v[120:123], v[80:83]
  v_permlane16_swap_b32 v41, v43
  v_mfma_f32_16x16x32_bf16 v[84:87], v[64:67], v[156:159], v[84:87]
  ds_read_b64_tr_b16 v[72:73], v18 offset:16384
  ds_read_b64_tr_b16 v[74:75], v18 offset:16896
  v_permlane16_swap_b32 v44, v46
  v_mfma_f32_16x16x32_bf16 v[88:91], v[64:67], v[192:195], v[88:91]
  v_permlane16_swap_b32 v45, v47
  v_mfma_f32_16x16x32_bf16 v[92:95], v[64:67], v[228:231], v[92:95]
  s_add_u32 m0, s47, 57344
  s_mov_b32 s49, 184832
  buffer_load_dwordx4 v16, s[20:23], s49 offen lds
  s_waitcnt lgkmcnt(2)
  v_mfma_f32_16x16x32_bf16 v[80:83], v[68:71], v[124:127], v[80:83]
  ds_read_b64_tr_b16 v[76:77], v18 offset:20480
  ds_read_b64_tr_b16 v[78:79], v18 offset:20992
  v_mfma_f32_16x16x32_bf16 v[84:87], v[68:71], v[160:163], v[84:87]
  v_mfma_f32_16x16x32_bf16 v[88:91], v[68:71], v[196:199], v[88:91]
  s_add_u32 m0, s47, 61440
  s_mov_b32 s49, 221696
  buffer_load_dwordx4 v16, s[20:23], s49 offen lds
  v_mfma_f32_16x16x32_bf16 v[92:95], v[68:71], v[232:235], v[92:95]
  ds_read_b64_tr_b16 v[56:57], v18 offset:24576
  ds_read_b64_tr_b16 v[58:59], v18 offset:25088
  s_waitcnt lgkmcnt(4)
  v_mfma_f32_16x16x32_bf16 v[80:83], v[72:75], v[128:131], v[80:83]
  v_mfma_f32_16x16x32_bf16 v[84:87], v[72:75], v[164:167], v[84:87]
  ds_read_b64_tr_b16 v[60:61], v18 offset:28672
  ds_read_b64_tr_b16 v[62:63], v18 offset:29184
  v_mfma_f32_16x16x32_bf16 v[88:91], v[72:75], v[200:203], v[88:91]
  s_add_u32 m0, s47, 65536
  s_mov_b32 s49, 258560
  buffer_load_dwordx4 v16, s[20:23], s49 offen lds
  v_mfma_f32_16x16x32_bf16 v[92:95], v[72:75], v[236:239], v[92:95]
  ds_read_b64_tr_b16 v[64:65], v18 offset:32768
  ds_read_b64_tr_b16 v[66:67], v18 offset:33280
  s_waitcnt lgkmcnt(6)
  v_mfma_f32_16x16x32_bf16 v[80:83], v[76:79], v[132:135], v[80:83]
  v_mfma_f32_16x16x32_bf16 v[84:87], v[76:79], v[168:171], v[84:87]
  ds_write_b128 v4, v[40:43] offset:8192
  ds_write_b128 v4, v[44:47] offset:9216
  v_mfma_f32_16x16x32_bf16 v[88:91], v[76:79], v[204:207], v[88:91]
  s_add_u32 m0, s47, 69632
  s_mov_b32 s49, 295424
  buffer_load_dwordx4 v16, s[20:23], s49 offen lds
  v_mfma_f32_16x16x32_bf16 v[92:95], v[76:79], v[240:243], v[92:95]
  s_waitcnt lgkmcnt(6)
  v_mfma_f32_16x16x32_bf16 v[80:83], v[56:59], v[136:139], v[80:83]
  v_mfma_f32_16x16x32_bf16 v[84:87], v[56:59], v[172:175], v[84:87]
  v_mfma_f32_16x16x32_bf16 v[88:91], v[56:59], v[208:211], v[88:91]
  v_mfma_f32_16x16x32_bf16 v[92:95], v[56:59], v[244:247], v[92:95]
  s_waitcnt lgkmcnt(0)
  s_waitcnt vmcnt(9)
  s_barrier
  v_subrev_u32 v18, 73728, v18
  v_mfma_f32_16x16x32_bf16 v[80:83], v[60:63], v[140:143], v[80:83]
  s_lshl_b32 s54, s2, 2
  s_add_u32 s54, s54, 244535296
  v_cmp_eq_u32 vcc, 0, v0
  s_nop 1
  v_cndmask_b32 v7, v20, v0, vcc
  v_mov_b32 v8, s57
  buffer_store_dword v8, v7, s[24:27], s54 offen sc1
  v_mfma_f32_16x16x32_bf16 v[84:87], v[60:63], v[176:179], v[84:87]
  ds_read_b64_tr_b16 v[68:69], v18 offset:0
  ds_read_b64_tr_b16 v[70:71], v18 offset:512
  s_add_u32 m0, s47, 73728
  s_mov_b32 s49, 640
  buffer_load_dwordx4 v16, s[20:23], s49 offen lds
  v_mfma_f32_16x16x32_bf16 v[88:91], v[60:63], v[212:215], v[88:91]
  v_mfma_f32_16x16x32_bf16 v[92:95], v[60:63], v[248:251], v[92:95]
  v_mfma_f32_16x16x32_bf16 v[80:83], v[64:67], v[144:147], v[80:83]
  s_add_u32 m0, s47, 77824
  s_mov_b32 s49, 37504
  buffer_load_dwordx4 v16, s[20:23], s49 offen lds
  v_mfma_f32_16x16x32_bf16 v[84:87], v[64:67], v[180:183], v[84:87]
  ds_read_b64_tr_b16 v[72:73], v18 offset:4096
  ds_read_b64_tr_b16 v[74:75], v18 offset:4608
  v_mfma_f32_16x16x32_bf16 v[88:91], v[64:67], v[216:219], v[88:91]
  v_mfma_f32_16x16x32_bf16 v[92:95], v[64:67], v[252:255], v[92:95]
  s_waitcnt lgkmcnt(2)
  v_mfma_f32_16x16x32_bf16 v[96:99], v[68:71], v[112:115], 0
  s_add_u32 m0, s47, 81920
  s_mov_b32 s49, 74368
  buffer_load_dwordx4 v16, s[20:23], s49 offen lds
  s_mov_b32 s74, 0xffff
  v_and_b32 v6, 255, v0
  v_mfma_f32_16x16x32_bf16 v[100:103], v[68:71], v[148:151], 0
  ds_read_b64_tr_b16 v[76:77], v18 offset:8192
  ds_read_b64_tr_b16 v[78:79], v18 offset:8704
  v_cvt_pk_bf16_f32 v40, v80, v81
  v_cvt_pk_bf16_f32 v41, v82, v83
  v_lshlrev_b32 v6, 4, v6
  v_mfma_f32_16x16x32_bf16 v[104:107], v[68:71], v[184:187], 0
  v_cvt_pk_bf16_f32 v42, v84, v85
  s_mov_b32 s53, 118288
  v_sub_u32 v5, s53, v6
  v_mfma_f32_16x16x32_bf16 v[108:111], v[68:71], v[220:223], 0
  s_add_u32 m0, s47, 86016
  s_mov_b32 s49, 111232
  buffer_load_dwordx4 v16, s[20:23], s49 offen lds
  v_cvt_pk_bf16_f32 v43, v86, v87
  v_alignbit_b32 v6, v31, v31, 16
  s_waitcnt lgkmcnt(2)
  v_mfma_f32_16x16x32_bf16 v[96:99], v[72:75], v[116:119], v[96:99]
  v_cvt_pk_bf16_f32 v44, v88, v89
  v_alignbit_b32 v7, v30, v30, 16
  v_alignbit_b32 v8, v29, v29, 16
  v_mfma_f32_16x16x32_bf16 v[100:103], v[72:75], v[152:155], v[100:103]
  ds_read_b64_tr_b16 v[56:57], v18 offset:12288
  ds_read_b64_tr_b16 v[58:59], v18 offset:12800
  v_cvt_pk_bf16_f32 v45, v90, v91
  v_alignbit_b32 v9, v28, v28, 16
  v_mfma_f32_16x16x32_bf16 v[104:107], v[72:75], v[188:191], v[104:107]
  v_cvt_pk_bf16_f32 v46, v92, v93
  v_cvt_pk_bf16_f32 v47, v94, v95
  v_alignbit_b32 v10, v27, v27, 16
  v_mfma_f32_16x16x32_bf16 v[108:111], v[72:75], v[224:227], v[108:111]
  s_add_u32 m0, s47, 90112
  s_mov_b32 s49, 148096
  buffer_load_dwordx4 v16, s[20:23], s49 offen lds
  v_permlane16_swap_b32 v40, v42
  v_alignbit_b32 v11, v26, v26, 16
  ds_write_b128 v5, v[6:9] offset:0
  s_waitcnt lgkmcnt(3)
  v_mfma_f32_16x16x32_bf16 v[96:99], v[76:79], v[120:123], v[96:99]
  v_permlane16_swap_b32 v41, v43
  ds_write_b128 v5, v[8:11] offset:16640
  v_mfma_f32_16x16x32_bf16 v[100:103], v[76:79], v[156:159], v[100:103]
  ds_read_b64_tr_b16 v[60:61], v18 offset:16384
  ds_read_b64_tr_b16 v[62:63], v18 offset:16896
  v_permlane16_swap_b32 v44, v46
  v_alignbit_b32 v6, v30, v30, 16
  v_alignbit_b32 v7, v29, v29, 16
  v_mfma_f32_16x16x32_bf16 v[104:107], v[76:79], v[192:195], v[104:107]
  v_permlane16_swap_b32 v45, v47
  v_alignbit_b32 v8, v28, v28, 16
  v_mfma_f32_16x16x32_bf16 v[108:111], v[76:79], v[228:231], v[108:111]
  s_add_u32 m0, s47, 94208
  s_mov_b32 s49, 184960
  buffer_load_dwordx4 v16, s[20:23], s49 offen lds
  v_alignbit_b32 v9, v27, v27, 16
  v_alignbit_b32 v10, v26, v26, 16
  s_waitcnt lgkmcnt(4)
  v_mfma_f32_16x16x32_bf16 v[96:99], v[56:59], v[124:127], v[96:99]
  ds_read_b64_tr_b16 v[64:65], v18 offset:20480
  ds_read_b64_tr_b16 v[66:67], v18 offset:20992
  v_alignbit_b32 v11, v25, v25, 16
  v_mfma_f32_16x16x32_bf16 v[100:103], v[56:59], v[160:163], v[100:103]
  ds_write_b128 v5, v[6:9] offset:8320
  v_mfma_f32_16x16x32_bf16 v[104:107], v[56:59], v[196:199], v[104:107]
  s_add_u32 m0, s47, 98304
  s_mov_b32 s49, 221824
  buffer_load_dwordx4 v16, s[20:23], s49 offen lds
  ds_write_b128 v5, v[8:11] offset:24960
  v_bfi_b32 v6, s74, v31, v30
  v_mfma_f32_16x16x32_bf16 v[108:111], v[56:59], v[232:235], v[108:111]
  ds_read_b64_tr_b16 v[68:69], v18 offset:24576
  ds_read_b64_tr_b16 v[70:71], v18 offset:25088
  v_bfi_b32 v7, s74, v30, v29
  s_waitcnt lgkmcnt(6)
  v_mfma_f32_16x16x32_bf16 v[96:99], v[60:63], v[128:131], v[96:99]
  v_bfi_b32 v8, s74, v29, v28
  v_bfi_b32 v9, s74, v28, v27
  v_mfma_f32_16x16x32_bf16 v[100:103], v[60:63], v[164:167], v[100:103]
  ds_read_b64_tr_b16 v[72:73], v18 offset:28672
  ds_read_b64_tr_b16 v[74:75], v18 offset:29184
  v_bfi_b32 v10, s74, v27, v26
  v_mfma_f32_16x16x32_bf16 v[104:107], v[60:63], v[200:203], v[104:107]
  s_add_u32 m0, s47, 102400
  s_mov_b32 s49, 258688
  buffer_load_dwordx4 v16, s[20:23], s49 offen lds
  v_bfi_b32 v11, s74, v26, v25
  ds_write_b128 v5, v[6:9] offset:4160
  v_mfma_f32_16x16x32_bf16 v[108:111], v[60:63], v[236:239], v[108:111]
  ds_read_b64_tr_b16 v[76:77], v18 offset:32768
  ds_read_b64_tr_b16 v[78:79], v18 offset:33280
  ds_write_b128 v5, v[8:11] offset:20800
  s_waitcnt lgkmcnt(10)
  v_mfma_f32_16x16x32_bf16 v[96:99], v[64:67], v[132:135], v[96:99]
  v_bfi_b32 v6, s74, v30, v29
  v_mfma_f32_16x16x32_bf16 v[100:103], v[64:67], v[168:171], v[100:103]
  ds_write_b128 v4, v[40:43] offset:0
  ds_write_b128 v4, v[44:47] offset:1024
  v_bfi_b32 v7, s74, v29, v28
  v_bfi_b32 v8, s74, v28, v27
  v_mfma_f32_16x16x32_bf16 v[104:107], v[64:67], v[204:207], v[104:107]
  s_add_u32 m0, s47, 106496
  s_mov_b32 s49, 295552
  buffer_load_dwordx4 v16, s[20:23], s49 offen lds
  v_bfi_b32 v9, s74, v27, v26
  v_mfma_f32_16x16x32_bf16 v[108:111], v[64:67], v[240:243], v[108:111]
  v_bfi_b32 v10, s74, v26, v25
  v_bfi_b32 v11, s74, v25, v24
  s_waitcnt lgkmcnt(8)
  v_mfma_f32_16x16x32_bf16 v[96:99], v[68:71], v[136:139], v[96:99]
  ds_write_b128 v5, v[6:9] offset:12480
  v_mfma_f32_16x16x32_bf16 v[100:103], v[68:71], v[172:175], v[100:103]
  ds_write_b128 v5, v[8:11] offset:29120
  v_mfma_f32_16x16x32_bf16 v[104:107], v[68:71], v[208:211], v[104:107]
  v_mfma_f32_16x16x32_bf16 v[108:111], v[68:71], v[244:247], v[108:111]
  s_waitcnt lgkmcnt(0)
  s_waitcnt vmcnt(10)
  s_barrier
  v_add_u32 v18, 36864, v18
  v_mfma_f32_16x16x32_bf16 v[96:99], v[72:75], v[140:143], v[96:99]
  v_mfma_f32_16x16x32_bf16 v[100:103], v[72:75], v[176:179], v[100:103]
  ds_read_b64_tr_b16 v[56:57], v18 offset:0
  ds_read_b64_tr_b16 v[58:59], v18 offset:512
  s_add_u32 m0, s47, 0
  s_mov_b32 s49, 768
  buffer_load_dwordx4 v16, s[20:23], s49 offen lds
  v_mfma_f32_16x16x32_bf16 v[104:107], v[72:75], v[212:215], v[104:107]
  v_mfma_f32_16x16x32_bf16 v[108:111], v[72:75], v[248:251], v[108:111]
  v_mfma_f32_16x16x32_bf16 v[96:99], v[76:79], v[144:147], v[96:99]
  s_add_u32 m0, s47, 4096
  s_mov_b32 s49, 37632
  buffer_load_dwordx4 v16, s[20:23], s49 offen lds
  v_mfma_f32_16x16x32_bf16 v[100:103], v[76:79], v[180:183], v[100:103]
  ds_read_b64_tr_b16 v[60:61], v18 offset:4096
  ds_read_b64_tr_b16 v[62:63], v18 offset:4608
  v_mfma_f32_16x16x32_bf16 v[104:107], v[76:79], v[216:219], v[104:107]
  v_mfma_f32_16x16x32_bf16 v[108:111], v[76:79], v[252:255], v[108:111]
  s_waitcnt lgkmcnt(2)
  v_mfma_f32_16x16x32_bf16 v[80:83], v[56:59], v[112:115], 0
  s_add_u32 m0, s47, 8192
  s_mov_b32 s49, 74496
  buffer_load_dwordx4 v16, s[20:23], s49 offen lds
  v_mfma_f32_16x16x32_bf16 v[84:87], v[56:59], v[148:151], 0
  ds_read_b64_tr_b16 v[64:65], v18 offset:8192
  ds_read_b64_tr_b16 v[66:67], v18 offset:8704
  v_cvt_pk_bf16_f32 v40, v96, v97
  v_cvt_pk_bf16_f32 v41, v98, v99
  v_mfma_f32_16x16x32_bf16 v[88:91], v[56:59], v[184:187], 0
  v_cvt_pk_bf16_f32 v42, v100, v101
  v_mfma_f32_16x16x32_bf16 v[92:95], v[56:59], v[220:223], 0
  s_add_u32 m0, s47, 12288
  s_mov_b32 s49, 111360
  buffer_load_dwordx4 v16, s[20:23], s49 offen lds
  v_cvt_pk_bf16_f32 v43, v102, v103
  s_waitcnt lgkmcnt(2)
  v_mfma_f32_16x16x32_bf16 v[80:83], v[60:63], v[116:119], v[80:83]
  v_cvt_pk_bf16_f32 v44, v104, v105
  v_mfma_f32_16x16x32_bf16 v[84:87], v[60:63], v[152:155], v[84:87]
  ds_read_b64_tr_b16 v[68:69], v18 offset:12288
  ds_read_b64_tr_b16 v[70:71], v18 offset:12800
  v_cvt_pk_bf16_f32 v45, v106, v107
  v_mfma_f32_16x16x32_bf16 v[88:91], v[60:63], v[188:191], v[88:91]
  v_cvt_pk_bf16_f32 v46, v108, v109
  v_cvt_pk_bf16_f32 v47, v110, v111
  v_mfma_f32_16x16x32_bf16 v[92:95], v[60:63], v[224:227], v[92:95]
  s_add_u32 m0, s47, 16384
  s_mov_b32 s49, 148224
  buffer_load_dwordx4 v16, s[20:23], s49 offen lds
  v_permlane16_swap_b32 v40, v42
  s_waitcnt lgkmcnt(2)
  v_mfma_f32_16x16x32_bf16 v[80:83], v[64:67], v[120:123], v[80:83]
  v_permlane16_swap_b32 v41, v43
  v_mfma_f32_16x16x32_bf16 v[84:87], v[64:67], v[156:159], v[84:87]
  ds_read_b64_tr_b16 v[72:73], v18 offset:16384
  ds_read_b64_tr_b16 v[74:75], v18 offset:16896
  v_permlane16_swap_b32 v44, v46
  v_mfma_f32_16x16x32_bf16 v[88:91], v[64:67], v[192:195], v[88:91]
  v_permlane16_swap_b32 v45, v47
  v_mfma_f32_16x16x32_bf16 v[92:95], v[64:67], v[228:231], v[92:95]
  s_add_u32 m0, s47, 20480
  s_mov_b32 s49, 185088
  buffer_load_dwordx4 v16, s[20:23], s49 offen lds
  s_waitcnt lgkmcnt(2)
  v_mfma_f32_16x16x32_bf16 v[80:83], v[68:71], v[124:127], v[80:83]
  ds_read_b64_tr_b16 v[76:77], v18 offset:20480
  ds_read_b64_tr_b16 v[78:79], v18 offset:20992
  v_mfma_f32_16x16x32_bf16 v[84:87], v[68:71], v[160:163], v[84:87]
  v_mfma_f32_16x16x32_bf16 v[88:91], v[68:71], v[196:199], v[88:91]
  s_add_u32 m0, s47, 24576
  s_mov_b32 s49, 221952
  buffer_load_dwordx4 v16, s[20:23], s49 offen lds
  v_mfma_f32_16x16x32_bf16 v[92:95], v[68:71], v[232:235], v[92:95]
  ds_read_b64_tr_b16 v[56:57], v18 offset:24576
  ds_read_b64_tr_b16 v[58:59], v18 offset:25088
  s_waitcnt lgkmcnt(4)
  v_mfma_f32_16x16x32_bf16 v[80:83], v[72:75], v[128:131], v[80:83]
  v_mfma_f32_16x16x32_bf16 v[84:87], v[72:75], v[164:167], v[84:87]
  ds_read_b64_tr_b16 v[60:61], v18 offset:28672
  ds_read_b64_tr_b16 v[62:63], v18 offset:29184
  v_mfma_f32_16x16x32_bf16 v[88:91], v[72:75], v[200:203], v[88:91]
  s_add_u32 m0, s47, 28672
  s_mov_b32 s49, 258816
  buffer_load_dwordx4 v16, s[20:23], s49 offen lds
  v_mfma_f32_16x16x32_bf16 v[92:95], v[72:75], v[236:239], v[92:95]
  ds_read_b64_tr_b16 v[64:65], v18 offset:32768
  ds_read_b64_tr_b16 v[66:67], v18 offset:33280
  s_waitcnt lgkmcnt(6)
  v_mfma_f32_16x16x32_bf16 v[80:83], v[76:79], v[132:135], v[80:83]
  v_mfma_f32_16x16x32_bf16 v[84:87], v[76:79], v[168:171], v[84:87]
  ds_write_b128 v4, v[40:43] offset:8192
  ds_write_b128 v4, v[44:47] offset:9216
  v_mfma_f32_16x16x32_bf16 v[88:91], v[76:79], v[204:207], v[88:91]
  s_add_u32 m0, s47, 32768
  s_mov_b32 s49, 295680
  buffer_load_dwordx4 v16, s[20:23], s49 offen lds
  v_mfma_f32_16x16x32_bf16 v[92:95], v[76:79], v[240:243], v[92:95]
  s_waitcnt lgkmcnt(6)
  v_mfma_f32_16x16x32_bf16 v[80:83], v[56:59], v[136:139], v[80:83]
  v_mfma_f32_16x16x32_bf16 v[84:87], v[56:59], v[172:175], v[84:87]
  v_mfma_f32_16x16x32_bf16 v[88:91], v[56:59], v[208:211], v[88:91]
  v_mfma_f32_16x16x32_bf16 v[92:95], v[56:59], v[244:247], v[92:95]
  s_waitcnt lgkmcnt(0)
  s_waitcnt vmcnt(9)
  s_barrier
  v_add_u32 v18, 36864, v18
  v_mfma_f32_16x16x32_bf16 v[80:83], v[60:63], v[140:143], v[80:83]
  v_mfma_f32_16x16x32_bf16 v[84:87], v[60:63], v[176:179], v[84:87]
  ds_read_b64_tr_b16 v[68:69], v18 offset:0
  ds_read_b64_tr_b16 v[70:71], v18 offset:512
  s_add_u32 m0, s47, 36864
  s_mov_b32 s49, 896
  buffer_load_dwordx4 v16, s[20:23], s49 offen lds
  v_mfma_f32_16x16x32_bf16 v[88:91], v[60:63], v[212:215], v[88:91]
  v_mfma_f32_16x16x32_bf16 v[92:95], v[60:63], v[248:251], v[92:95]
  v_mfma_f32_16x16x32_bf16 v[80:83], v[64:67], v[144:147], v[80:83]
  s_add_u32 m0, s47, 40960
  s_mov_b32 s49, 37760
  buffer_load_dwordx4 v16, s[20:23], s49 offen lds
  v_mfma_f32_16x16x32_bf16 v[84:87], v[64:67], v[180:183], v[84:87]
  ds_read_b64_tr_b16 v[72:73], v18 offset:4096
  ds_read_b64_tr_b16 v[74:75], v18 offset:4608
  v_mfma_f32_16x16x32_bf16 v[88:91], v[64:67], v[216:219], v[88:91]
  v_mfma_f32_16x16x32_bf16 v[92:95], v[64:67], v[252:255], v[92:95]
  s_waitcnt lgkmcnt(2)
  v_mfma_f32_16x16x32_bf16 v[96:99], v[68:71], v[112:115], 0
  s_add_u32 m0, s47, 45056
  s_mov_b32 s49, 74624
  buffer_load_dwordx4 v16, s[20:23], s49 offen lds
  v_mfma_f32_16x16x32_bf16 v[100:103], v[68:71], v[148:151], 0
  ds_read_b64_tr_b16 v[76:77], v18 offset:8192
  ds_read_b64_tr_b16 v[78:79], v18 offset:8704
  v_cvt_pk_bf16_f32 v40, v80, v81
  v_cvt_pk_bf16_f32 v41, v82, v83
  v_mfma_f32_16x16x32_bf16 v[104:107], v[68:71], v[184:187], 0
  v_cvt_pk_bf16_f32 v42, v84, v85
  v_mfma_f32_16x16x32_bf16 v[108:111], v[68:71], v[220:223], 0
  s_add_u32 m0, s47, 49152
  s_mov_b32 s49, 111488
  buffer_load_dwordx4 v16, s[20:23], s49 offen lds
  v_cvt_pk_bf16_f32 v43, v86, v87
  s_waitcnt lgkmcnt(2)
  v_mfma_f32_16x16x32_bf16 v[96:99], v[72:75], v[116:119], v[96:99]
  v_cvt_pk_bf16_f32 v44, v88, v89
  v_mfma_f32_16x16x32_bf16 v[100:103], v[72:75], v[152:155], v[100:103]
  ds_read_b64_tr_b16 v[56:57], v18 offset:12288
  ds_read_b64_tr_b16 v[58:59], v18 offset:12800
  v_cvt_pk_bf16_f32 v45, v90, v91
  v_mfma_f32_16x16x32_bf16 v[104:107], v[72:75], v[188:191], v[104:107]
  v_cvt_pk_bf16_f32 v46, v92, v93
  v_cvt_pk_bf16_f32 v47, v94, v95
  v_mfma_f32_16x16x32_bf16 v[108:111], v[72:75], v[224:227], v[108:111]
  s_add_u32 m0, s47, 53248
  s_mov_b32 s49, 148352
  buffer_load_dwordx4 v16, s[20:23], s49 offen lds
  v_permlane16_swap_b32 v40, v42
  s_waitcnt lgkmcnt(2)
  v_mfma_f32_16x16x32_bf16 v[96:99], v[76:79], v[120:123], v[96:99]
  v_permlane16_swap_b32 v41, v43
  v_mfma_f32_16x16x32_bf16 v[100:103], v[76:79], v[156:159], v[100:103]
  ds_read_b64_tr_b16 v[60:61], v18 offset:16384
  ds_read_b64_tr_b16 v[62:63], v18 offset:16896
  v_permlane16_swap_b32 v44, v46
  v_mfma_f32_16x16x32_bf16 v[104:107], v[76:79], v[192:195], v[104:107]
  v_permlane16_swap_b32 v45, v47
  v_mfma_f32_16x16x32_bf16 v[108:111], v[76:79], v[228:231], v[108:111]
  s_add_u32 m0, s47, 57344
  s_mov_b32 s49, 185216
  buffer_load_dwordx4 v16, s[20:23], s49 offen lds
  s_waitcnt lgkmcnt(2)
  v_mfma_f32_16x16x32_bf16 v[96:99], v[56:59], v[124:127], v[96:99]
  ds_read_b64_tr_b16 v[64:65], v18 offset:20480
  ds_read_b64_tr_b16 v[66:67], v18 offset:20992
  v_mfma_f32_16x16x32_bf16 v[100:103], v[56:59], v[160:163], v[100:103]
  v_mfma_f32_16x16x32_bf16 v[104:107], v[56:59], v[196:199], v[104:107]
  s_add_u32 m0, s47, 61440
  s_mov_b32 s49, 222080
  buffer_load_dwordx4 v16, s[20:23], s49 offen lds
  v_mfma_f32_16x16x32_bf16 v[108:111], v[56:59], v[232:235], v[108:111]
  ds_read_b64_tr_b16 v[68:69], v18 offset:24576
  ds_read_b64_tr_b16 v[70:71], v18 offset:25088
  s_waitcnt lgkmcnt(4)
  v_mfma_f32_16x16x32_bf16 v[96:99], v[60:63], v[128:131], v[96:99]
  v_mfma_f32_16x16x32_bf16 v[100:103], v[60:63], v[164:167], v[100:103]
  ds_read_b64_tr_b16 v[72:73], v18 offset:28672
  ds_read_b64_tr_b16 v[74:75], v18 offset:29184
  v_mfma_f32_16x16x32_bf16 v[104:107], v[60:63], v[200:203], v[104:107]
  s_add_u32 m0, s47, 65536
  s_mov_b32 s49, 258944
  buffer_load_dwordx4 v16, s[20:23], s49 offen lds
  v_mfma_f32_16x16x32_bf16 v[108:111], v[60:63], v[236:239], v[108:111]
  ds_read_b64_tr_b16 v[76:77], v18 offset:32768
  ds_read_b64_tr_b16 v[78:79], v18 offset:33280
  s_waitcnt lgkmcnt(6)
  v_mfma_f32_16x16x32_bf16 v[96:99], v[64:67], v[132:135], v[96:99]
  v_mfma_f32_16x16x32_bf16 v[100:103], v[64:67], v[168:171], v[100:103]
  ds_write_b128 v4, v[40:43] offset:0
  ds_write_b128 v4, v[44:47] offset:1024
  v_mfma_f32_16x16x32_bf16 v[104:107], v[64:67], v[204:207], v[104:107]
  s_add_u32 m0, s47, 69632
  s_mov_b32 s49, 295808
  buffer_load_dwordx4 v16, s[20:23], s49 offen lds
  v_mfma_f32_16x16x32_bf16 v[108:111], v[64:67], v[240:243], v[108:111]
  s_waitcnt lgkmcnt(6)
  v_mfma_f32_16x16x32_bf16 v[96:99], v[68:71], v[136:139], v[96:99]
  v_mfma_f32_16x16x32_bf16 v[100:103], v[68:71], v[172:175], v[100:103]
  v_mfma_f32_16x16x32_bf16 v[104:107], v[68:71], v[208:211], v[104:107]
  s_mul_i32 s54, s7, 3
  s_add_u32 s55, s54, 2
  s_lshr_b32 s54, s54, 6
  s_lshr_b32 s55, s55, 6
  s_lshl_b32 s54, s54, 4
  s_lshl_b32 s55, s55, 4
  v_add_u32 v12, s54, v2
  v_add_u32 v13, s55, v2
  v_cmp_gt_u32 vcc, 16, v1
  s_nop 1
  v_cndmask_b32 v12, v13, v12, vcc
  v_lshlrev_b32 v12, 2, v12
  v_add_u32 v12, 20480, v12
  s_mov_b32 s53, 244514816
  buffer_load_dword v14, v12, s[24:27], s53 offen sc1
  v_mfma_f32_16x16x32_bf16 v[108:111], v[68:71], v[244:247], v[108:111]
  s_waitcnt lgkmcnt(0)
  s_waitcnt vmcnt(10)
  s_barrier
  v_subrev_u32 v18, 73728, v18
  v_mfma_f32_16x16x32_bf16 v[96:99], v[72:75], v[140:143], v[96:99]
  v_mfma_f32_16x16x32_bf16 v[100:103], v[72:75], v[176:179], v[100:103]
  ds_read_b64_tr_b16 v[56:57], v18 offset:0
  ds_read_b64_tr_b16 v[58:59], v18 offset:512
  s_add_u32 m0, s47, 73728
  s_mov_b32 s49, 1024
  buffer_load_dwordx4 v16, s[20:23], s49 offen lds
  v_mfma_f32_16x16x32_bf16 v[104:107], v[72:75], v[212:215], v[104:107]
  v_mfma_f32_16x16x32_bf16 v[108:111], v[72:75], v[248:251], v[108:111]
  v_mfma_f32_16x16x32_bf16 v[96:99], v[76:79], v[144:147], v[96:99]
  s_add_u32 m0, s47, 77824
  s_mov_b32 s49, 37888
  buffer_load_dwordx4 v16, s[20:23], s49 offen lds
  v_mfma_f32_16x16x32_bf16 v[100:103], v[76:79], v[180:183], v[100:103]
  ds_read_b64_tr_b16 v[60:61], v18 offset:4096
  ds_read_b64_tr_b16 v[62:63], v18 offset:4608
  v_mfma_f32_16x16x32_bf16 v[104:107], v[76:79], v[216:219], v[104:107]
  v_mfma_f32_16x16x32_bf16 v[108:111], v[76:79], v[252:255], v[108:111]
  s_waitcnt lgkmcnt(2)
  v_mfma_f32_16x16x32_bf16 v[80:83], v[56:59], v[112:115], 0
  s_add_u32 m0, s47, 81920
  s_mov_b32 s49, 74752
  buffer_load_dwordx4 v16, s[20:23], s49 offen lds
  s_waitcnt vmcnt(3)
  v_readfirstlane_b32 s53, v14
  v_cmp_ne_u32 vcc, s57, v14
  s_nop 3
  s_cmp_eq_u64 vcc, 0
  s_cbranch_scc1 L_spind_60
  s_mov_b32 s54, 0x20000
  s_mov_b32 s53, 244514816
L_spin_59:
  s_sleep 4
  buffer_load_dword v14, v12, s[24:27], s53 offen sc1
  s_waitcnt vmcnt(0)
  v_cmp_ne_u32 vcc, s57, v14
  s_nop 4
  s_sub_u32 s54, s54, 1
  s_cmp_eq_u32 s54, 0
  s_cbranch_scc1 L_spind_60
  s_cmp_lg_u64 vcc, 0
  s_cbranch_scc1 L_spin_59
L_spind_60:
  v_mfma_f32_16x16x32_bf16 v[84:87], v[56:59], v[148:151], 0
  ds_read_b64_tr_b16 v[64:65], v18 offset:8192
  ds_read_b64_tr_b16 v[66:67], v18 offset:8704
  v_cvt_pk_bf16_f32 v40, v96, v97
  v_cvt_pk_bf16_f32 v41, v98, v99
  v_mfma_f32_16x16x32_bf16 v[88:91], v[56:59], v[184:187], 0
  v_cvt_pk_bf16_f32 v42, v100, v101
  s_mul_i32 s53, s7, 12288
  v_mfma_f32_16x16x32_bf16 v[92:95], v[56:59], v[220:223], 0
  s_add_u32 m0, s47, 86016
  s_mov_b32 s49, 111616
  buffer_load_dwordx4 v16, s[20:23], s49 offen lds
  v_cvt_pk_bf16_f32 v43, v102, v103
  s_waitcnt lgkmcnt(2)
  v_mfma_f32_16x16x32_bf16 v[80:83], v[60:63], v[116:119], v[80:83]
  v_cvt_pk_bf16_f32 v44, v104, v105
  v_mfma_f32_16x16x32_bf16 v[84:87], v[60:63], v[152:155], v[84:87]
  ds_read_b64_tr_b16 v[68:69], v18 offset:12288
  ds_read_b64_tr_b16 v[70:71], v18 offset:12800
  v_cvt_pk_bf16_f32 v45, v106, v107
  s_add_u32 s53, s53, 239075328
  v_mfma_f32_16x16x32_bf16 v[88:91], v[60:63], v[188:191], v[88:91]
  v_cvt_pk_bf16_f32 v46, v108, v109
  v_cvt_pk_bf16_f32 v47, v110, v111
  v_mfma_f32_16x16x32_bf16 v[92:95], v[60:63], v[224:227], v[92:95]
  s_add_u32 m0, s47, 90112
  s_mov_b32 s49, 148480
  buffer_load_dwordx4 v16, s[20:23], s49 offen lds
  v_permlane16_swap_b32 v40, v42
  s_waitcnt lgkmcnt(2)
  v_mfma_f32_16x16x32_bf16 v[80:83], v[64:67], v[120:123], v[80:83]
  v_permlane16_swap_b32 v41, v43
  v_lshlrev_b32 v5, 4, v0
  v_mfma_f32_16x16x32_bf16 v[84:87], v[64:67], v[156:159], v[84:87]
  ds_read_b64_tr_b16 v[72:73], v18 offset:16384
  ds_read_b64_tr_b16 v[74:75], v18 offset:16896
  v_permlane16_swap_b32 v44, v46
  v_mfma_f32_16x16x32_bf16 v[88:91], v[64:67], v[192:195], v[88:91]
  v_permlane16_swap_b32 v45, v47
  v_mfma_f32_16x16x32_bf16 v[92:95], v[64:67], v[228:231], v[92:95]
  s_add_u32 m0, s47, 94208
  s_mov_b32 s49, 185344
  buffer_load_dwordx4 v16, s[20:23], s49 offen lds
  v_add_u32 v6, 8192, v5
  s_waitcnt lgkmcnt(2)
  v_mfma_f32_16x16x32_bf16 v[80:83], v[68:71], v[124:127], v[80:83]
  ds_read_b64_tr_b16 v[76:77], v18 offset:20480
  ds_read_b64_tr_b16 v[78:79], v18 offset:20992
  v_mfma_f32_16x16x32_bf16 v[84:87], v[68:71], v[160:163], v[84:87]
  v_mfma_f32_16x16x32_bf16 v[88:91], v[68:71], v[196:199], v[88:91]
  s_add_u32 m0, s47, 98304
  s_mov_b32 s49, 222208
  buffer_load_dwordx4 v16, s[20:23], s49 offen lds
  v_cmp_gt_u32 vcc, 256, v0
  v_mfma_f32_16x16x32_bf16 v[92:95], v[68:71], v[232:235], v[92:95]
  ds_read_b64_tr_b16 v[56:57], v18 offset:24576
  ds_read_b64_tr_b16 v[58:59], v18 offset:25088
  s_waitcnt lgkmcnt(4)
  v_mfma_f32_16x16x32_bf16 v[80:83], v[72:75], v[128:131], v[80:83]
  v_mfma_f32_16x16x32_bf16 v[84:87], v[72:75], v[164:167], v[84:87]
  ds_read_b64_tr_b16 v[60:61], v18 offset:28672
  ds_read_b64_tr_b16 v[62:63], v18 offset:29184
  v_cndmask_b32 v6, v20, v6, vcc
  v_mfma_f32_16x16x32_bf16 v[88:91], v[72:75], v[200:203], v[88:91]
  s_add_u32 m0, s47, 102400
  s_mov_b32 s49, 259072
  buffer_load_dwordx4 v16, s[20:23], s49 offen lds
  v_mfma_f32_16x16x32_bf16 v[92:95], v[72:75], v[236:239], v[92:95]
  ds_read_b64_tr_b16 v[64:65], v18 offset:32768
  ds_read_b64_tr_b16 v[66:67], v18 offset:33280
  s_waitcnt lgkmcnt(6)
  v_mfma_f32_16x16x32_bf16 v[80:83], v[76:79], v[132:135], v[80:83]
  buffer_load_dwordx4 v[48:51], v5, s[24:27], s53 offen sc1
  v_mfma_f32_16x16x32_bf16 v[84:87], v[76:79], v[168:171], v[84:87]
  ds_write_b128 v4, v[40:43] offset:8192
  ds_write_b128 v4, v[44:47] offset:9216
  v_mfma_f32_16x16x32_bf16 v[88:91], v[76:79], v[204:207], v[88:91]
  s_add_u32 m0, s47, 106496
  s_mov_b32 s49, 295936
  buffer_load_dwordx4 v16, s[20:23], s49 offen lds
  v_mfma_f32_16x16x32_bf16 v[92:95], v[76:79], v[240:243], v[92:95]
  buffer_load_dwordx4 v[52:55], v6, s[24:27], s53 offen sc1
  s_waitcnt lgkmcnt(6)
  v_mfma_f32_16x16x32_bf16 v[80:83], v[56:59], v[136:139], v[80:83]
  v_mfma_f32_16x16x32_bf16 v[84:87], v[56:59], v[172:175], v[84:87]
  v_mfma_f32_16x16x32_bf16 v[88:91], v[56:59], v[208:211], v[88:91]
  v_mfma_f32_16x16x32_bf16 v[92:95], v[56:59], v[244:247], v[92:95]
  s_waitcnt lgkmcnt(0)
  s_barrier
  v_add_u32 v18, 36864, v18
  v_mfma_f32_16x16x32_bf16 v[80:83], v[60:63], v[140:143], v[80:83]
  v_mfma_f32_16x16x32_bf16 v[84:87], v[60:63], v[176:179], v[84:87]
  ds_read_b64_tr_b16 v[68:69], v18 offset:0
  ds_read_b64_tr_b16 v[70:71], v18 offset:512
  v_mfma_f32_16x16x32_bf16 v[88:91], v[60:63], v[212:215], v[88:91]
  v_mfma_f32_16x16x32_bf16 v[92:95], v[60:63], v[248:251], v[92:95]
  v_mfma_f32_16x16x32_bf16 v[80:83], v[64:67], v[144:147], v[80:83]
  v_mfma_f32_16x16x32_bf16 v[84:87], v[64:67], v[180:183], v[84:87]
  ds_read_b64_tr_b16 v[72:73], v18 offset:4096
  ds_read_b64_tr_b16 v[74:75], v18 offset:4608
  v_mfma_f32_16x16x32_bf16 v[88:91], v[64:67], v[216:219], v[88:91]
  v_mfma_f32_16x16x32_bf16 v[92:95], v[64:67], v[252:255], v[92:95]
  s_waitcnt lgkmcnt(2)
  v_mfma_f32_16x16x32_bf16 v[96:99], v[68:71], v[112:115], 0
  v_mfma_f32_16x16x32_bf16 v[100:103], v[68:71], v[148:151], 0
  ds_read_b64_tr_b16 v[76:77], v18 offset:8192
  ds_read_b64_tr_b16 v[78:79], v18 offset:8704
  v_cvt_pk_bf16_f32 v40, v80, v81
  v_cvt_pk_bf16_f32 v41, v82, v83
  v_mfma_f32_16x16x32_bf16 v[104:107], v[68:71], v[184:187], 0
  v_cvt_pk_bf16_f32 v42, v84, v85
  v_mfma_f32_16x16x32_bf16 v[108:111], v[68:71], v[220:223], 0
  v_cvt_pk_bf16_f32 v43, v86, v87
  s_waitcnt lgkmcnt(2)
  v_mfma_f32_16x16x32_bf16 v[96:99], v[72:75], v[116:119], v[96:99]
  v_cvt_pk_bf16_f32 v44, v88, v89
  v_mfma_f32_16x16x32_bf16 v[100:103], v[72:75], v[152:155], v[100:103]
  ds_read_b64_tr_b16 v[56:57], v18 offset:12288
  ds_read_b64_tr_b16 v[58:59], v18 offset:12800
  v_cvt_pk_bf16_f32 v45, v90, v91
  v_mfma_f32_16x16x32_bf16 v[104:107], v[72:75], v[188:191], v[104:107]
  v_cvt_pk_bf16_f32 v46, v92, v93
  v_cvt_pk_bf16_f32 v47, v94, v95
  v_mfma_f32_16x16x32_bf16 v[108:111], v[72:75], v[224:227], v[108:111]
  v_permlane16_swap_b32 v40, v42
  s_waitcnt lgkmcnt(2)
  v_mfma_f32_16x16x32_bf16 v[96:99], v[76:79], v[120:123], v[96:99]
  v_permlane16_swap_b32 v41, v43
  v_mfma_f32_16x16x32_bf16 v[100:103], v[76:79], v[156:159], v[100:103]
  ds_read_b64_tr_b16 v[60:61], v18 offset:16384
  ds_read_b64_tr_b16 v[62:63], v18 offset:16896
  v_permlane16_swap_b32 v44, v46
  v_mfma_f32_16x16x32_bf16 v[104:107], v[76:79], v[192:195], v[104:107]
  v_permlane16_swap_b32 v45, v47
  v_mfma_f32_16x16x32_bf16 v[108:111], v[76:79], v[228:231], v[108:111]
  s_waitcnt lgkmcnt(2)
  v_mfma_f32_16x16x32_bf16 v[96:99], v[56:59], v[124:127], v[96:99]
  ds_read_b64_tr_b16 v[64:65], v18 offset:20480
  ds_read_b64_tr_b16 v[66:67], v18 offset:20992
  v_mfma_f32_16x16x32_bf16 v[100:103], v[56:59], v[160:163], v[100:103]
  v_mfma_f32_16x16x32_bf16 v[104:107], v[56:59], v[196:199], v[104:107]
  v_mfma_f32_16x16x32_bf16 v[108:111], v[56:59], v[232:235], v[108:111]
  ds_read_b64_tr_b16 v[68:69], v18 offset:24576
  ds_read_b64_tr_b16 v[70:71], v18 offset:25088
  s_waitcnt lgkmcnt(4)
  v_mfma_f32_16x16x32_bf16 v[96:99], v[60:63], v[128:131], v[96:99]
  v_mfma_f32_16x16x32_bf16 v[100:103], v[60:63], v[164:167], v[100:103]
  ds_read_b64_tr_b16 v[72:73], v18 offset:28672
  ds_read_b64_tr_b16 v[74:75], v18 offset:29184
  v_mfma_f32_16x16x32_bf16 v[104:107], v[60:63], v[200:203], v[104:107]
  v_mfma_f32_16x16x32_bf16 v[108:111], v[60:63], v[236:239], v[108:111]
  ds_read_b64_tr_b16 v[76:77], v18 offset:32768
  ds_read_b64_tr_b16 v[78:79], v18 offset:33280
  s_waitcnt lgkmcnt(6)
  v_mfma_f32_16x16x32_bf16 v[96:99], v[64:67], v[132:135], v[96:99]
  v_mfma_f32_16x16x32_bf16 v[100:103], v[64:67], v[168:171], v[100:103]
  ds_write_b128 v4, v[40:43] offset:0
  ds_write_b128 v4, v[44:47] offset:1024
  v_mfma_f32_16x16x32_bf16 v[104:107], v[64:67], v[204:207], v[104:107]
  v_mfma_f32_16x16x32_bf16 v[108:111], v[64:67], v[240:243], v[108:111]
  s_waitcnt lgkmcnt(6)
  v_mfma_f32_16x16x32_bf16 v[96:99], v[68:71], v[136:139], v[96:99]
  v_mfma_f32_16x16x32_bf16 v[100:103], v[68:71], v[172:175], v[100:103]
  v_mfma_f32_16x16x32_bf16 v[104:107], v[68:71], v[208:211], v[104:107]
  v_mfma_f32_16x16x32_bf16 v[108:111], v[68:71], v[244:247], v[108:111]
  s_waitcnt lgkmcnt(0)
  s_waitcnt vmcnt(1)
  s_barrier
  v_add_u32 v18, 36864, v18
  v_mfma_f32_16x16x32_bf16 v[96:99], v[72:75], v[140:143], v[96:99]
  s_lshl_b32 s54, s45, 7
  s_lshl_b32 s55, s46, 2
  s_add_u32 s54, s54, s55
  s_add_u32 s54, s54, 244514816
  v_cmp_eq_u32 vcc, 0, v0
  s_nop 1
  v_cndmask_b32 v7, v20, v0, vcc
  v_mov_b32 v8, s57
  buffer_store_dword v8, v7, s[24:27], s54 offen sc1
  v_mfma_f32_16x16x32_bf16 v[100:103], v[72:75], v[176:179], v[100:103]
  ds_read_b64_tr_b16 v[56:57], v18 offset:0
  ds_read_b64_tr_b16 v[58:59], v18 offset:512
  v_mfma_f32_16x16x32_bf16 v[104:107], v[72:75], v[212:215], v[104:107]
  v_mfma_f32_16x16x32_bf16 v[108:111], v[72:75], v[248:251], v[108:111]
  v_mfma_f32_16x16x32_bf16 v[96:99], v[76:79], v[144:147], v[96:99]
  v_mfma_f32_16x16x32_bf16 v[100:103], v[76:79], v[180:183], v[100:103]
  ds_read_b64_tr_b16 v[60:61], v18 offset:4096
  ds_read_b64_tr_b16 v[62:63], v18 offset:4608
  v_mfma_f32_16x16x32_bf16 v[104:107], v[76:79], v[216:219], v[104:107]
  v_mfma_f32_16x16x32_bf16 v[108:111], v[76:79], v[252:255], v[108:111]
  s_waitcnt lgkmcnt(2)
  v_mfma_f32_16x16x32_bf16 v[80:83], v[56:59], v[112:115], 0
  v_mov_b32 v6, 0
  v_mov_b32 v7, 0
  v_mfma_f32_16x16x32_bf16 v[84:87], v[56:59], v[148:151], 0
  ds_read_b64_tr_b16 v[64:65], v18 offset:8192
  ds_read_b64_tr_b16 v[66:67], v18 offset:8704
  v_cvt_pk_bf16_f32 v40, v96, v97
  v_cvt_pk_bf16_f32 v41, v98, v99
  v_mov_b32 v8, 0
  v_mov_b32 v9, 0
  v_mfma_f32_16x16x32_bf16 v[88:91], v[56:59], v[184:187], 0
  v_cvt_pk_bf16_f32 v42, v100, v101
  v_lshlrev_b32 v12, 4, v1
  v_add_u32 v12, 112640, v12
  v_mfma_f32_16x16x32_bf16 v[92:95], v[56:59], v[220:223], 0
  v_cvt_pk_bf16_f32 v43, v102, v103
  v_lshrrev_b32 v10, 5, v0
  v_mul_u32_u24 v10, 4608, v10
  s_waitcnt lgkmcnt(2)
  v_mfma_f32_16x16x32_bf16 v[80:83], v[60:63], v[116:119], v[80:83]
  v_cvt_pk_bf16_f32 v44, v104, v105
  v_and_b32 v11, 31, v0
  v_lshlrev_b32 v11, 4, v11
  v_mfma_f32_16x16x32_bf16 v[84:87], v[60:63], v[152:155], v[84:87]
  ds_read_b64_tr_b16 v[68:69], v18 offset:12288
  ds_read_b64_tr_b16 v[70:71], v18 offset:12800
  v_cvt_pk_bf16_f32 v45, v106, v107
  v_add_u32 v10, v10, v11
  v_mfma_f32_16x16x32_bf16 v[88:91], v[60:63], v[188:191], v[88:91]
  v_cvt_pk_bf16_f32 v46, v108, v109
  v_cvt_pk_bf16_f32 v47, v110, v111
  v_add_u32 v10, 0, v10
  v_cmp_gt_u32 vcc, 96, v0
  v_mfma_f32_16x16x32_bf16 v[92:95], v[60:63], v[224:227], v[92:95]
  v_permlane16_swap_b32 v40, v42
  v_cndmask_b32 v10, v12, v10, vcc
  ds_write_b128 v10, v[6:9]
  s_waitcnt lgkmcnt(3)
  v_mfma_f32_16x16x32_bf16 v[80:83], v[64:67], v[120:123], v[80:83]
  v_permlane16_swap_b32 v41, v43
  v_and_b32 v10, 7, v0
  v_mul_u32_u24 v10, 4160, v10
  v_mfma_f32_16x16x32_bf16 v[84:87], v[64:67], v[156:159], v[84:87]
  ds_read_b64_tr_b16 v[72:73], v18 offset:16384
  ds_read_b64_tr_b16 v[74:75], v18 offset:16896
  v_permlane16_swap_b32 v44, v46
  v_add_u32 v10, 118304, v10
  v_cmp_gt_u32 vcc, 8, v0
  v_mfma_f32_16x16x32_bf16 v[88:91], v[64:67], v[192:195], v[88:91]
  v_permlane16_swap_b32 v45, v47
  v_cndmask_b32 v10, v12, v10, vcc
  ds_write_b128 v10, v[6:9]
  v_mfma_f32_16x16x32_bf16 v[92:95], v[64:67], v[228:231], v[92:95]
  v_lshlrev_b32 v11, 4, v0
  s_waitcnt lgkmcnt(4)
  v_mfma_f32_16x16x32_bf16 v[80:83], v[68:71], v[124:127], v[80:83]
  ds_read_b64_tr_b16 v[76:77], v18 offset:20480
  ds_read_b64_tr_b16 v[78:79], v18 offset:20992
  v_lshrrev_b32 v10, 8, v0
  v_lshlrev_b32 v10, 9, v10
  v_mfma_f32_16x16x32_bf16 v[84:87], v[68:71], v[160:163], v[84:87]
  v_add_u32 v10, v10, v11
  v_add_u32 v10, 512, v10
  v_mfma_f32_16x16x32_bf16 v[88:91], v[68:71], v[196:199], v[88:91]
  ds_write_b128 v10, v[48:51]
  v_add_u32 v10, 9728, v11
  v_mfma_f32_16x16x32_bf16 v[92:95], v[68:71], v[232:235], v[92:95]
  ds_read_b64_tr_b16 v[56:57], v18 offset:24576
  ds_read_b64_tr_b16 v[58:59], v18 offset:25088
  v_cmp_gt_u32 vcc, 256, v0
  s_nop 1
  v_cndmask_b32 v10, v12, v10, vcc
  s_waitcnt lgkmcnt(6)
  v_mfma_f32_16x16x32_bf16 v[80:83], v[72:75], v[128:131], v[80:83]
  s_waitcnt vmcnt(1)
  ds_write_b128 v10, v[52:55]
  v_and_b32 v10, 7, v2
  v_mfma_f32_16x16x32_bf16 v[84:87], v[72:75], v[164:167], v[84:87]
  ds_read_b64_tr_b16 v[60:61], v18 offset:28672
  ds_read_b64_tr_b16 v[62:63], v18 offset:29184
  v_sub_u32 v10, 7, v10
  v_mfma_f32_16x16x32_bf16 v[88:91], v[72:75], v[200:203], v[88:91]
  v_mul_u32_u24 v10, 4160, v10
  v_lshrrev_b32 v11, 3, v2
  v_mfma_f32_16x16x32_bf16 v[92:95], v[72:75], v[236:239], v[92:95]
  ds_read_b64_tr_b16 v[64:65], v18 offset:32768
  ds_read_b64_tr_b16 v[66:67], v18 offset:33280
  v_sub_u32 v11, v3, v11
  v_add_u32 v11, 255, v11
  s_waitcnt lgkmcnt(8)
  v_mfma_f32_16x16x32_bf16 v[80:83], v[76:79], v[132:135], v[80:83]
  v_lshlrev_b32 v11, 4, v11
  v_add_u32 v10, v10, v11
  v_mfma_f32_16x16x32_bf16 v[84:87], v[76:79], v[168:171], v[84:87]
  ds_write_b128 v4, v[40:43] offset:8192
  ds_write_b128 v4, v[44:47] offset:9216
  s_lshl_b32 s53, s44, 6
  s_add_u32 s53, s53, 3584
  v_mfma_f32_16x16x32_bf16 v[88:91], v[76:79], v[204:207], v[88:91]
  v_subrev_u32 v10, s53, v10
  v_add_u32 v50, 114176, v10
  v_mfma_f32_16x16x32_bf16 v[92:95], v[76:79], v[240:243], v[92:95]
  v_add_u32 v49, 13824, v10
  s_waitcnt lgkmcnt(7)
  v_mfma_f32_16x16x32_bf16 v[80:83], v[56:59], v[136:139], v[80:83]
  v_lshlrev_b32 v10, 5, v2
  v_lshlrev_b32 v11, 4, v3
  v_mfma_f32_16x16x32_bf16 v[84:87], v[56:59], v[172:175], v[84:87]
  v_add_u32 v10, v10, v11
  v_add_u32 v10, 480, v10
  v_mfma_f32_16x16x32_bf16 v[88:91], v[56:59], v[208:211], v[88:91]
  s_lshl_b32 s53, s44, 6
  v_subrev_u32 v51, s53, v10
  v_mfma_f32_16x16x32_bf16 v[92:95], v[56:59], v[244:247], v[92:95]
  v_lshlrev_b32 v52, 3, v1
  s_lshl_b32 s53, s44, 9
  s_waitcnt lgkmcnt(0)
  s_barrier
  v_mfma_f32_16x16x32_bf16 v[80:83], v[60:63], v[140:143], v[80:83]
  v_add_u32 v52, s53, v52
  v_add_u32 v52, 47104, v52
  v_mfma_f32_16x16x32_bf16 v[84:87], v[60:63], v[176:179], v[84:87]
  v_lshlrev_b32 v53, 3, v1
  v_mfma_f32_16x16x32_bf16 v[88:91], v[60:63], v[212:215], v[88:91]
  s_lshl_b32 s53, s51, 12
  v_add_u32 v53, s53, v53
  v_mfma_f32_16x16x32_bf16 v[92:95], v[60:63], v[248:251], v[92:95]
  v_add_u32 v53, 47104, v53
  v_lshlrev_b32 v54, 5, v2
  v_mfma_f32_16x16x32_bf16 v[80:83], v[64:67], v[144:147], v[80:83]
  v_lshlrev_b32 v55, 3, v3
  v_add_u32 v54, v54, v55
  v_mfma_f32_16x16x32_bf16 v[84:87], v[64:67], v[180:183], v[84:87]
  s_lshl_b32 s53, s51, 9
  v_add_u32 v54, s53, v54
  v_mfma_f32_16x16x32_bf16 v[88:91], v[64:67], v[216:219], v[88:91]
  v_add_u32 v55, 512, v54
  v_mfma_f32_16x16x32_bf16 v[92:95], v[64:67], v[252:255], v[92:95]
  v_cvt_pk_bf16_f32 v40, v80, v81
  v_cvt_pk_bf16_f32 v41, v82, v83
  s_nop 0
  v_cvt_pk_bf16_f32 v42, v84, v85
  v_cvt_pk_bf16_f32 v43, v86, v87
  s_nop 0
  v_cvt_pk_bf16_f32 v44, v88, v89
  v_cvt_pk_bf16_f32 v45, v90, v91
  v_cvt_pk_bf16_f32 v46, v92, v93
  v_cvt_pk_bf16_f32 v47, v94, v95
  v_permlane16_swap_b32 v40, v42
  v_permlane16_swap_b32 v41, v43
  v_permlane16_swap_b32 v44, v46
  v_permlane16_swap_b32 v45, v47
  ds_write_b128 v4, v[40:43] offset:0
  ds_write_b128 v4, v[44:47] offset:1024
  s_waitcnt lgkmcnt(0)
  s_branch L_g2end
L_g2B:
  v_lshlrev_b32 v4, 4, v1
  s_lshl_b32 s53, s51, 11
  s_add_u32 s53, s53, 147456
  v_add_u32 v4, s53, v4
  ds_read_b128 v[120:123], v54 offset:128
  ds_read_b128 v[156:159], v54 offset:9344
  ds_read_b128 v[192:195], v54 offset:18560
  ds_read_b128 v[228:231], v54 offset:27776
  v_mfma_f32_16x16x32_bf16 v[80:83], v[56:59], v[112:115], 0
  v_and_b32 v5, 255, v0
  v_and_b32 v6, 15, v5
  v_mfma_f32_16x16x32_bf16 v[84:87], v[56:59], v[148:151], 0
  ds_read_b64_tr_b16 v[64:65], v18 offset:8192
  ds_read_b64_tr_b16 v[66:67], v18 offset:8704
  v_lshrrev_b32 v8, 4, v5
  v_lshlrev_b32 v9, 12, v8
  v_mfma_f32_16x16x32_bf16 v[88:91], v[56:59], v[184:187], 0
  v_lshlrev_b32 v10, 4, v6
  v_add_u32 v9, v9, v10
  v_mfma_f32_16x16x32_bf16 v[92:95], v[56:59], v[220:223], 0
  ds_read_b128 v[124:127], v54 offset:192
  ds_read_b128 v[160:163], v54 offset:9408
  ds_read_b128 v[196:199], v54 offset:18624
  ds_read_b128 v[232:235], v54 offset:27840
  s_cmp_lt_u32 s2, 144
  s_cselect_b32 s53, 0, 0x80000000
  v_mfma_f32_16x16x32_bf16 v[80:83], v[60:63], v[116:119], v[80:83]
  v_add_u32 v9, s53, v9
  v_lshrrev_b32 v10, 6, v5
  v_mfma_f32_16x16x32_bf16 v[84:87], v[60:63], v[152:155], v[84:87]
  ds_read_b64_tr_b16 v[68:69], v18 offset:12288
  ds_read_b64_tr_b16 v[70:71], v18 offset:12800
  v_lshlrev_b32 v8, 8, v8
  v_add_u32 v8, 147456, v8
  v_mfma_f32_16x16x32_bf16 v[88:91], v[60:63], v[188:191], v[88:91]
  s_lshr_b32 s53, s2, 4
  s_mul_i32 s53, s53, 262144
  v_mfma_f32_16x16x32_bf16 v[92:95], v[60:63], v[224:227], v[92:95]
  ds_read_b128 v[128:131], v54 offset:256
  ds_read_b128 v[164:167], v54 offset:9472
  ds_read_b128 v[200:203], v54 offset:18688
  ds_read_b128 v[236:239], v54 offset:27904
  s_and_b32 s54, s2, 15
  s_waitcnt lgkmcnt(10)
  v_mfma_f32_16x16x32_bf16 v[80:83], v[64:67], v[120:123], v[80:83]
  s_lshl_b32 s54, s54, 8
  s_add_u32 s53, s53, s54
  v_mfma_f32_16x16x32_bf16 v[84:87], v[64:67], v[156:159], v[84:87]
  ds_read_b64_tr_b16 v[72:73], v18 offset:16384
  ds_read_b64_tr_b16 v[74:75], v18 offset:16896
  s_add_u32 s53, s53, 239075328
  v_add_u32 v11, 0, v10
  v_mfma_f32_16x16x32_bf16 v[88:91], v[64:67], v[192:195], v[88:91]
  ds_read_b128 v[132:135], v54 offset:320
  ds_read_b128 v[168:171], v54 offset:9536
  ds_read_b128 v[204:207], v54 offset:18752
  ds_read_b128 v[240:243], v54 offset:27968
  v_xor_b32 v11, v11, v6
  v_and_b32 v11, 15, v11
  v_mfma_f32_16x16x32_bf16 v[92:95], v[64:67], v[228:231], v[92:95]
  v_lshlrev_b32 v11, 4, v11
  s_waitcnt lgkmcnt(10)
  v_mfma_f32_16x16x32_bf16 v[80:83], v[68:71], v[124:127], v[80:83]
  ds_read_b64_tr_b16 v[76:77], v18 offset:20480
  ds_read_b64_tr_b16 v[78:79], v18 offset:20992
  v_add_u32 v11, v11, v8
  ds_read_b128 v[40:43], v11 offset:0
  v_mfma_f32_16x16x32_bf16 v[84:87], v[68:71], v[160:163], v[84:87]
  ds_read_b128 v[136:139], v54 offset:384
  ds_read_b128 v[172:175], v54 offset:9600
  ds_read_b128 v[208:211], v54 offset:18816
  ds_read_b128 v[244:247], v54 offset:28032
  s_waitcnt lgkmcnt(4)
  buffer_store_dwordx4 v[40:43], v9, s[24:27], s53 offen sc1
  s_add_u32 s53, s53, 65536
  v_add_u32 v11, 4, v10
  v_mfma_f32_16x16x32_bf16 v[88:91], v[68:71], v[196:199], v[88:91]
  v_xor_b32 v11, v11, v6
  v_mfma_f32_16x16x32_bf16 v[92:95], v[68:71], v[232:235], v[92:95]
  ds_read_b64_tr_b16 v[56:57], v18 offset:24576
  ds_read_b64_tr_b16 v[58:59], v18 offset:25088
  ds_read_b128 v[140:143], v54 offset:448
  ds_read_b128 v[176:179], v54 offset:9664
  ds_read_b128 v[212:215], v54 offset:18880
  ds_read_b128 v[248:251], v54 offset:28096
  v_and_b32 v11, 15, v11
  v_lshlrev_b32 v11, 4, v11
  v_mfma_f32_16x16x32_bf16 v[80:83], v[72:75], v[128:131], v[80:83]
  v_add_u32 v11, v11, v8
  ds_read_b128 v[44:47], v11 offset:4096
  v_mfma_f32_16x16x32_bf16 v[84:87], v[72:75], v[164:167], v[84:87]
  ds_read_b64_tr_b16 v[60:61], v18 offset:28672
  ds_read_b64_tr_b16 v[62:63], v18 offset:29184
  ds_read_b128 v[144:147], v54 offset:512
  ds_read_b128 v[180:183], v54 offset:9728
  ds_read_b128 v[216:219], v54 offset:18944
  ds_read_b128 v[252:255], v54 offset:28160
  s_waitcnt lgkmcnt(6)
  buffer_store_dwordx4 v[44:47], v9, s[24:27], s53 offen sc1
  s_add_u32 s53, s53, 65536
  v_add_u32 v11, 8, v10
  v_mfma_f32_16x16x32_bf16 v[88:91], v[72:75], v[200:203], v[88:91]
  v_xor_b32 v11, v11, v6
  v_mfma_f32_16x16x32_bf16 v[92:95], v[72:75], v[236:239], v[92:95]
  ds_read_b64_tr_b16 v[64:65], v18 offset:32768
  ds_read_b64_tr_b16 v[66:67], v18 offset:33280
  v_and_b32 v11, 15, v11
  v_lshlrev_b32 v11, 4, v11
  v_mfma_f32_16x16x32_bf16 v[80:83], v[76:79], v[132:135], v[80:83]
  v_add_u32 v11, v11, v8
  ds_read_b128 v[40:43], v11 offset:8192
  v_mfma_f32_16x16x32_bf16 v[84:87], v[76:79], v[168:171], v[84:87]
  s_waitcnt lgkmcnt(0)
  buffer_store_dwordx4 v[40:43], v9, s[24:27], s53 offen sc1
  s_add_u32 s53, s53, 65536
  v_add_u32 v11, 12, v10
  v_mfma_f32_16x16x32_bf16 v[88:91], v[76:79], v[204:207], v[88:91]
  v_xor_b32 v11, v11, v6
  v_mfma_f32_16x16x32_bf16 v[92:95], v[76:79], v[240:243], v[92:95]
  v_and_b32 v11, 15, v11
  v_lshlrev_b32 v11, 4, v11
  v_mfma_f32_16x16x32_bf16 v[80:83], v[56:59], v[136:139], v[80:83]
  v_add_u32 v11, v11, v8
  ds_read_b128 v[44:47], v11 offset:12288
  v_mfma_f32_16x16x32_bf16 v[84:87], v[56:59], v[172:175], v[84:87]
  s_waitcnt lgkmcnt(0)
  buffer_store_dwordx4 v[44:47], v9, s[24:27], s53 offen sc1
  v_mfma_f32_16x16x32_bf16 v[88:91], v[56:59], v[208:211], v[88:91]
  v_mfma_f32_16x16x32_bf16 v[92:95], v[56:59], v[244:247], v[92:95]
  s_barrier
  v_add_u32 v18, 36864, v18
  v_mfma_f32_16x16x32_bf16 v[80:83], v[60:63], v[140:143], v[80:83]
  v_mfma_f32_16x16x32_bf16 v[84:87], v[60:63], v[176:179], v[84:87]
  ds_read_b64_tr_b16 v[68:69], v18 offset:0
  ds_read_b64_tr_b16 v[70:71], v18 offset:512
  v_mfma_f32_16x16x32_bf16 v[88:91], v[60:63], v[212:215], v[88:91]
  v_mfma_f32_16x16x32_bf16 v[92:95], v[60:63], v[248:251], v[92:95]
  v_mfma_f32_16x16x32_bf16 v[80:83], v[64:67], v[144:147], v[80:83]
  v_mfma_f32_16x16x32_bf16 v[84:87], v[64:67], v[180:183], v[84:87]
  ds_read_b64_tr_b16 v[72:73], v18 offset:4096
  ds_read_b64_tr_b16 v[74:75], v18 offset:4608
  v_mfma_f32_16x16x32_bf16 v[88:91], v[64:67], v[216:219], v[88:91]
  v_mfma_f32_16x16x32_bf16 v[92:95], v[64:67], v[252:255], v[92:95]
  s_waitcnt lgkmcnt(2)
  v_mfma_f32_16x16x32_bf16 v[96:99], v[68:71], v[112:115], 0
  v_mfma_f32_16x16x32_bf16 v[100:103], v[68:71], v[148:151], 0
  ds_read_b64_tr_b16 v[76:77], v18 offset:8192
  ds_read_b64_tr_b16 v[78:79], v18 offset:8704
  v_cvt_pk_bf16_f32 v40, v80, v81
  v_cvt_pk_bf16_f32 v41, v82, v83
  v_mfma_f32_16x16x32_bf16 v[104:107], v[68:71], v[184:187], 0
  v_cvt_pk_bf16_f32 v42, v84, v85
  v_mfma_f32_16x16x32_bf16 v[108:111], v[68:71], v[220:223], 0
  v_cvt_pk_bf16_f32 v43, v86, v87
  s_waitcnt lgkmcnt(2)
  v_mfma_f32_16x16x32_bf16 v[96:99], v[72:75], v[116:119], v[96:99]
  v_cvt_pk_bf16_f32 v44, v88, v89
  v_mfma_f32_16x16x32_bf16 v[100:103], v[72:75], v[152:155], v[100:103]
  ds_read_b64_tr_b16 v[56:57], v18 offset:12288
  ds_read_b64_tr_b16 v[58:59], v18 offset:12800
  v_cvt_pk_bf16_f32 v45, v90, v91
  v_mfma_f32_16x16x32_bf16 v[104:107], v[72:75], v[188:191], v[104:107]
  v_cvt_pk_bf16_f32 v46, v92, v93
  v_cvt_pk_bf16_f32 v47, v94, v95
  v_mfma_f32_16x16x32_bf16 v[108:111], v[72:75], v[224:227], v[108:111]
  v_permlane16_swap_b32 v40, v42
  s_waitcnt lgkmcnt(2)
  v_mfma_f32_16x16x32_bf16 v[96:99], v[76:79], v[120:123], v[96:99]
  v_permlane16_swap_b32 v41, v43
  v_mfma_f32_16x16x32_bf16 v[100:103], v[76:79], v[156:159], v[100:103]
  ds_read_b64_tr_b16 v[60:61], v18 offset:16384
  ds_read_b64_tr_b16 v[62:63], v18 offset:16896
  v_permlane16_swap_b32 v44, v46
  v_mfma_f32_16x16x32_bf16 v[104:107], v[76:79], v[192:195], v[104:107]
  v_permlane16_swap_b32 v45, v47
  v_mfma_f32_16x16x32_bf16 v[108:111], v[76:79], v[228:231], v[108:111]
  s_add_u32 s58, s56, 0
  buffer_store_dwordx4 v[40:43], v19, s[24:27], s58 offen sc1
  s_waitcnt lgkmcnt(2)
  v_mfma_f32_16x16x32_bf16 v[96:99], v[56:59], v[124:127], v[96:99]
  ds_read_b64_tr_b16 v[64:65], v18 offset:20480
  ds_read_b64_tr_b16 v[66:67], v18 offset:20992
  v_mfma_f32_16x16x32_bf16 v[100:103], v[56:59], v[160:163], v[100:103]
  v_mfma_f32_16x16x32_bf16 v[104:107], v[56:59], v[196:199], v[104:107]
  v_mfma_f32_16x16x32_bf16 v[108:111], v[56:59], v[232:235], v[108:111]
  ds_read_b64_tr_b16 v[68:69], v18 offset:24576
  ds_read_b64_tr_b16 v[70:71], v18 offset:25088
  s_add_u32 s58, s56, 589824
  buffer_store_dwordx4 v[44:47], v19, s[24:27], s58 offen sc1
  s_waitcnt lgkmcnt(4)
  v_mfma_f32_16x16x32_bf16 v[96:99], v[60:63], v[128:131], v[96:99]
  v_mfma_f32_16x16x32_bf16 v[100:103], v[60:63], v[164:167], v[100:103]
  ds_read_b64_tr_b16 v[72:73], v18 offset:28672
  ds_read_b64_tr_b16 v[74:75], v18 offset:29184
  v_mfma_f32_16x16x32_bf16 v[104:107], v[60:63], v[200:203], v[104:107]
  v_mfma_f32_16x16x32_bf16 v[108:111], v[60:63], v[236:239], v[108:111]
  ds_read_b64_tr_b16 v[76:77], v18 offset:32768
  ds_read_b64_tr_b16 v[78:79], v18 offset:33280
  s_waitcnt lgkmcnt(6)
  v_mfma_f32_16x16x32_bf16 v[96:99], v[64:67], v[132:135], v[96:99]
  v_mfma_f32_16x16x32_bf16 v[100:103], v[64:67], v[168:171], v[100:103]
  v_mfma_f32_16x16x32_bf16 v[104:107], v[64:67], v[204:207], v[104:107]
  v_mfma_f32_16x16x32_bf16 v[108:111], v[64:67], v[240:243], v[108:111]
  s_waitcnt lgkmcnt(4)
  v_mfma_f32_16x16x32_bf16 v[96:99], v[68:71], v[136:139], v[96:99]
  v_mfma_f32_16x16x32_bf16 v[100:103], v[68:71], v[172:175], v[100:103]
  v_mfma_f32_16x16x32_bf16 v[104:107], v[68:71], v[208:211], v[104:107]
  v_mfma_f32_16x16x32_bf16 v[108:111], v[68:71], v[244:247], v[108:111]
  s_waitcnt lgkmcnt(0)
  s_barrier
  v_add_u32 v18, 36864, v18
  v_mfma_f32_16x16x32_bf16 v[96:99], v[72:75], v[140:143], v[96:99]
  v_mfma_f32_16x16x32_bf16 v[100:103], v[72:75], v[176:179], v[100:103]
  ds_read_b64_tr_b16 v[56:57], v18 offset:0
  ds_read_b64_tr_b16 v[58:59], v18 offset:512
  v_mfma_f32_16x16x32_bf16 v[104:107], v[72:75], v[212:215], v[104:107]
  v_mfma_f32_16x16x32_bf16 v[108:111], v[72:75], v[248:251], v[108:111]
  v_mfma_f32_16x16x32_bf16 v[96:99], v[76:79], v[144:147], v[96:99]
  v_mfma_f32_16x16x32_bf16 v[100:103], v[76:79], v[180:183], v[100:103]
  ds_read_b64_tr_b16 v[60:61], v18 offset:4096
  ds_read_b64_tr_b16 v[62:63], v18 offset:4608
  v_mfma_f32_16x16x32_bf16 v[104:107], v[76:79], v[216:219], v[104:107]
  v_mfma_f32_16x16x32_bf16 v[108:111], v[76:79], v[252:255], v[108:111]
  s_waitcnt lgkmcnt(2)
  v_mfma_f32_16x16x32_bf16 v[80:83], v[56:59], v[112:115], 0
  v_mfma_f32_16x16x32_bf16 v[84:87], v[56:59], v[148:151], 0
  ds_read_b64_tr_b16 v[64:65], v18 offset:8192
  ds_read_b64_tr_b16 v[66:67], v18 offset:8704
  v_cvt_pk_bf16_f32 v40, v96, v97
  v_cvt_pk_bf16_f32 v41, v98, v99
  v_mfma_f32_16x16x32_bf16 v[88:91], v[56:59], v[184:187], 0
  v_cvt_pk_bf16_f32 v42, v100, v101
  v_mfma_f32_16x16x32_bf16 v[92:95], v[56:59], v[220:223], 0
  v_cvt_pk_bf16_f32 v43, v102, v103
  s_waitcnt lgkmcnt(2)
  v_mfma_f32_16x16x32_bf16 v[80:83], v[60:63], v[116:119], v[80:83]
  v_cvt_pk_bf16_f32 v44, v104, v105
  v_mfma_f32_16x16x32_bf16 v[84:87], v[60:63], v[152:155], v[84:87]
  ds_read_b64_tr_b16 v[68:69], v18 offset:12288
  ds_read_b64_tr_b16 v[70:71], v18 offset:12800
  v_cvt_pk_bf16_f32 v45, v106, v107
  v_mfma_f32_16x16x32_bf16 v[88:91], v[60:63], v[188:191], v[88:91]
  v_cvt_pk_bf16_f32 v46, v108, v109
  v_cvt_pk_bf16_f32 v47, v110, v111
  v_mfma_f32_16x16x32_bf16 v[92:95], v[60:63], v[224:227], v[92:95]
  v_permlane16_swap_b32 v40, v42
  s_waitcnt lgkmcnt(2)
  v_mfma_f32_16x16x32_bf16 v[80:83], v[64:67], v[120:123], v[80:83]
  v_permlane16_swap_b32 v41, v43
  v_mfma_f32_16x16x32_bf16 v[84:87], v[64:67], v[156:159], v[84:87]
  ds_read_b64_tr_b16 v[72:73], v18 offset:16384
  ds_read_b64_tr_b16 v[74:75], v18 offset:16896
  v_permlane16_swap_b32 v44, v46
  v_mfma_f32_16x16x32_bf16 v[88:91], v[64:67], v[192:195], v[88:91]
  v_permlane16_swap_b32 v45, v47
  v_mfma_f32_16x16x32_bf16 v[92:95], v[64:67], v[228:231], v[92:95]
  s_add_u32 s58, s56, 16384
  buffer_store_dwordx4 v[40:43], v19, s[24:27], s58 offen sc1
  s_waitcnt lgkmcnt(2)
  v_mfma_f32_16x16x32_bf16 v[80:83], v[68:71], v[124:127], v[80:83]
  ds_read_b64_tr_b16 v[76:77], v18 offset:20480
  ds_read_b64_tr_b16 v[78:79], v18 offset:20992
  v_mfma_f32_16x16x32_bf16 v[84:87], v[68:71], v[160:163], v[84:87]
  v_mfma_f32_16x16x32_bf16 v[88:91], v[68:71], v[196:199], v[88:91]
  v_mfma_f32_16x16x32_bf16 v[92:95], v[68:71], v[232:235], v[92:95]
  ds_read_b64_tr_b16 v[56:57], v18 offset:24576
  ds_read_b64_tr_b16 v[58:59], v18 offset:25088
  s_add_u32 s58, s56, 606208
  buffer_store_dwordx4 v[44:47], v19, s[24:27], s58 offen sc1
  s_waitcnt lgkmcnt(4)
  v_mfma_f32_16x16x32_bf16 v[80:83], v[72:75], v[128:131], v[80:83]
  v_mfma_f32_16x16x32_bf16 v[84:87], v[72:75], v[164:167], v[84:87]
  ds_read_b64_tr_b16 v[60:61], v18 offset:28672
  ds_read_b64_tr_b16 v[62:63], v18 offset:29184
  v_mfma_f32_16x16x32_bf16 v[88:91], v[72:75], v[200:203], v[88:91]
  v_mfma_f32_16x16x32_bf16 v[92:95], v[72:75], v[236:239], v[92:95]
  ds_read_b64_tr_b16 v[64:65], v18 offset:32768
  ds_read_b64_tr_b16 v[66:67], v18 offset:33280
  s_waitcnt lgkmcnt(6)
  v_mfma_f32_16x16x32_bf16 v[80:83], v[76:79], v[132:135], v[80:83]
  ds_read_b128 v[40:43], v4 offset:0
  ds_read_b128 v[44:47], v4 offset:1024
  v_mfma_f32_16x16x32_bf16 v[84:87], v[76:79], v[168:171], v[84:87]
  v_mfma_f32_16x16x32_bf16 v[88:91], v[76:79], v[204:207], v[88:91]
  v_mfma_f32_16x16x32_bf16 v[92:95], v[76:79], v[240:243], v[92:95]
  s_waitcnt lgkmcnt(6)
  v_mfma_f32_16x16x32_bf16 v[80:83], v[56:59], v[136:139], v[80:83]
  v_mfma_f32_16x16x32_bf16 v[84:87], v[56:59], v[172:175], v[84:87]
  v_mfma_f32_16x16x32_bf16 v[88:91], v[56:59], v[208:211], v[88:91]
  v_mfma_f32_16x16x32_bf16 v[92:95], v[56:59], v[244:247], v[92:95]
  s_waitcnt lgkmcnt(0)
  s_waitcnt vmcnt(4)
  s_barrier
  v_subrev_u32 v18, 73728, v18
  v_mfma_f32_16x16x32_bf16 v[80:83], v[60:63], v[140:143], v[80:83]
  s_lshl_b32 s54, s2, 2
  s_add_u32 s54, s54, 244535296
  v_cmp_eq_u32 vcc, 0, v0
  s_nop 1
  v_cndmask_b32 v7, v20, v0, vcc
  v_mov_b32 v8, s57
  buffer_store_dword v8, v7, s[24:27], s54 offen sc1
  v_mfma_f32_16x16x32_bf16 v[84:87], v[60:63], v[176:179], v[84:87]
  s_add_u32 s58, s56, 4293787648
  buffer_store_dwordx4 v[40:43], v19, s[24:27], s58 offen sc1
  ds_read_b64_tr_b16 v[68:69], v18 offset:0
  ds_read_b64_tr_b16 v[70:71], v18 offset:512
  v_mfma_f32_16x16x32_bf16 v[88:91], v[60:63], v[212:215], v[88:91]
  v_mfma_f32_16x16x32_bf16 v[92:95], v[60:63], v[248:251], v[92:95]
  v_mfma_f32_16x16x32_bf16 v[80:83], v[64:67], v[144:147], v[80:83]
  s_add_u32 s58, s56, 4294377472
  buffer_store_dwordx4 v[44:47], v19, s[24:27], s58 offen sc1
  v_mfma_f32_16x16x32_bf16 v[84:87], v[64:67], v[180:183], v[84:87]
  ds_read_b64_tr_b16 v[72:73], v18 offset:4096
  ds_read_b64_tr_b16 v[74:75], v18 offset:4608
  v_mfma_f32_16x16x32_bf16 v[88:91], v[64:67], v[216:219], v[88:91]
  v_mfma_f32_16x16x32_bf16 v[92:95], v[64:67], v[252:255], v[92:95]
  s_waitcnt lgkmcnt(2)
  v_mfma_f32_16x16x32_bf16 v[96:99], v[68:71], v[112:115], 0
  v_mfma_f32_16x16x32_bf16 v[100:103], v[68:71], v[148:151], 0
  ds_read_b64_tr_b16 v[76:77], v18 offset:8192
  ds_read_b64_tr_b16 v[78:79], v18 offset:8704
  v_cvt_pk_bf16_f32 v40, v80, v81
  v_cvt_pk_bf16_f32 v41, v82, v83
  v_mfma_f32_16x16x32_bf16 v[104:107], v[68:71], v[184:187], 0
  v_cvt_pk_bf16_f32 v42, v84, v85
  v_mfma_f32_16x16x32_bf16 v[108:111], v[68:71], v[220:223], 0
  v_cvt_pk_bf16_f32 v43, v86, v87
  s_waitcnt lgkmcnt(2)
  v_mfma_f32_16x16x32_bf16 v[96:99], v[72:75], v[116:119], v[96:99]
  v_cvt_pk_bf16_f32 v44, v88, v89
  v_mfma_f32_16x16x32_bf16 v[100:103], v[72:75], v[152:155], v[100:103]
  ds_read_b64_tr_b16 v[56:57], v18 offset:12288
  ds_read_b64_tr_b16 v[58:59], v18 offset:12800
  v_cvt_pk_bf16_f32 v45, v90, v91
  v_mfma_f32_16x16x32_bf16 v[104:107], v[72:75], v[188:191], v[104:107]
  v_cvt_pk_bf16_f32 v46, v92, v93
  v_cvt_pk_bf16_f32 v47, v94, v95
  v_mfma_f32_16x16x32_bf16 v[108:111], v[72:75], v[224:227], v[108:111]
  v_permlane16_swap_b32 v40, v42
  s_waitcnt lgkmcnt(2)
  v_mfma_f32_16x16x32_bf16 v[96:99], v[76:79], v[120:123], v[96:99]
  v_permlane16_swap_b32 v41, v43
  v_mfma_f32_16x16x32_bf16 v[100:103], v[76:79], v[156:159], v[100:103]
  ds_read_b64_tr_b16 v[60:61], v18 offset:16384
  ds_read_b64_tr_b16 v[62:63], v18 offset:16896
  v_permlane16_swap_b32 v44, v46
  v_mfma_f32_16x16x32_bf16 v[104:107], v[76:79], v[192:195], v[104:107]
  v_permlane16_swap_b32 v45, v47
  v_mfma_f32_16x16x32_bf16 v[108:111], v[76:79], v[228:231], v[108:111]
  s_add_u32 s58, s56, 32768
  buffer_store_dwordx4 v[40:43], v19, s[24:27], s58 offen sc1
  s_waitcnt lgkmcnt(2)
  v_mfma_f32_16x16x32_bf16 v[96:99], v[56:59], v[124:127], v[96:99]
  ds_read_b64_tr_b16 v[64:65], v18 offset:20480
  ds_read_b64_tr_b16 v[66:67], v18 offset:20992
  v_mfma_f32_16x16x32_bf16 v[100:103], v[56:59], v[160:163], v[100:103]
  v_mfma_f32_16x16x32_bf16 v[104:107], v[56:59], v[196:199], v[104:107]
  v_mfma_f32_16x16x32_bf16 v[108:111], v[56:59], v[232:235], v[108:111]
  ds_read_b64_tr_b16 v[68:69], v18 offset:24576
  ds_read_b64_tr_b16 v[70:71], v18 offset:25088
  s_add_u32 s58, s56, 622592
  buffer_store_dwordx4 v[44:47], v19, s[24:27], s58 offen sc1
  s_waitcnt lgkmcnt(4)
  v_mfma_f32_16x16x32_bf16 v[96:99], v[60:63], v[128:131], v[96:99]
  v_mfma_f32_16x16x32_bf16 v[100:103], v[60:63], v[164:167], v[100:103]
  ds_read_b64_tr_b16 v[72:73], v18 offset:28672
  ds_read_b64_tr_b16 v[74:75], v18 offset:29184
  v_mfma_f32_16x16x32_bf16 v[104:107], v[60:63], v[200:203], v[104:107]
  v_mfma_f32_16x16x32_bf16 v[108:111], v[60:63], v[236:239], v[108:111]
  ds_read_b64_tr_b16 v[76:77], v18 offset:32768
  ds_read_b64_tr_b16 v[78:79], v18 offset:33280
  s_waitcnt lgkmcnt(6)
  v_mfma_f32_16x16x32_bf16 v[96:99], v[64:67], v[132:135], v[96:99]
  ds_read_b128 v[40:43], v4 offset:8192
  ds_read_b128 v[44:47], v4 offset:9216
  v_mfma_f32_16x16x32_bf16 v[100:103], v[64:67], v[168:171], v[100:103]
  v_mfma_f32_16x16x32_bf16 v[104:107], v[64:67], v[204:207], v[104:107]
  v_mfma_f32_16x16x32_bf16 v[108:111], v[64:67], v[240:243], v[108:111]
  s_waitcnt lgkmcnt(6)
  v_mfma_f32_16x16x32_bf16 v[96:99], v[68:71], v[136:139], v[96:99]
  v_mfma_f32_16x16x32_bf16 v[100:103], v[68:71], v[172:175], v[100:103]
  v_mfma_f32_16x16x32_bf16 v[104:107], v[68:71], v[208:211], v[104:107]
  v_mfma_f32_16x16x32_bf16 v[108:111], v[68:71], v[244:247], v[108:111]
  s_waitcnt lgkmcnt(0)
  s_barrier
  v_add_u32 v18, 36864, v18
  v_mfma_f32_16x16x32_bf16 v[96:99], v[72:75], v[140:143], v[96:99]
  v_mfma_f32_16x16x32_bf16 v[100:103], v[72:75], v[176:179], v[100:103]
  s_add_u32 s58, s56, 4293804032
  buffer_store_dwordx4 v[40:43], v19, s[24:27], s58 offen sc1
  ds_read_b64_tr_b16 v[56:57], v18 offset:0
  ds_read_b64_tr_b16 v[58:59], v18 offset:512
  v_mfma_f32_16x16x32_bf16 v[104:107], v[72:75], v[212:215], v[104:107]
  v_mfma_f32_16x16x32_bf16 v[108:111], v[72:75], v[248:251], v[108:111]
  v_mfma_f32_16x16x32_bf16 v[96:99], v[76:79], v[144:147], v[96:99]
  s_add_u32 s58, s56, 4294393856
  buffer_store_dwordx4 v[44:47], v19, s[24:27], s58 offen sc1
  v_mfma_f32_16x16x32_bf16 v[100:103], v[76:79], v[180:183], v[100:103]
  ds_read_b64_tr_b16 v[60:61], v18 offset:4096
  ds_read_b64_tr_b16 v[62:63], v18 offset:4608
  v_mfma_f32_16x16x32_bf16 v[104:107], v[76:79], v[216:219], v[104:107]
  v_mfma_f32_16x16x32_bf16 v[108:111], v[76:79], v[252:255], v[108:111]
  s_waitcnt lgkmcnt(2)
  v_mfma_f32_16x16x32_bf16 v[80:83], v[56:59], v[112:115], 0
  v_mfma_f32_16x16x32_bf16 v[84:87], v[56:59], v[148:151], 0
  ds_read_b64_tr_b16 v[64:65], v18 offset:8192
  ds_read_b64_tr_b16 v[66:67], v18 offset:8704
  v_cvt_pk_bf16_f32 v40, v96, v97
  v_cvt_pk_bf16_f32 v41, v98, v99
  v_mfma_f32_16x16x32_bf16 v[88:91], v[56:59], v[184:187], 0
  v_cvt_pk_bf16_f32 v42, v100, v101
  v_mfma_f32_16x16x32_bf16 v[92:95], v[56:59], v[220:223], 0
  v_cvt_pk_bf16_f32 v43, v102, v103
  s_waitcnt lgkmcnt(2)
  v_mfma_f32_16x16x32_bf16 v[80:83], v[60:63], v[116:119], v[80:83]
  v_cvt_pk_bf16_f32 v44, v104, v105
  v_mfma_f32_16x16x32_bf16 v[84:87], v[60:63], v[152:155], v[84:87]
  ds_read_b64_tr_b16 v[68:69], v18 offset:12288
  ds_read_b64_tr_b16 v[70:71], v18 offset:12800
  v_cvt_pk_bf16_f32 v45, v106, v107
  v_mfma_f32_16x16x32_bf16 v[88:91], v[60:63], v[188:191], v[88:91]
  v_cvt_pk_bf16_f32 v46, v108, v109
  v_cvt_pk_bf16_f32 v47, v110, v111
  v_mfma_f32_16x16x32_bf16 v[92:95], v[60:63], v[224:227], v[92:95]
  v_permlane16_swap_b32 v40, v42
  s_waitcnt lgkmcnt(2)
  v_mfma_f32_16x16x32_bf16 v[80:83], v[64:67], v[120:123], v[80:83]
  v_permlane16_swap_b32 v41, v43
  v_mfma_f32_16x16x32_bf16 v[84:87], v[64:67], v[156:159], v[84:87]
  ds_read_b64_tr_b16 v[72:73], v18 offset:16384
  ds_read_b64_tr_b16 v[74:75], v18 offset:16896
  v_permlane16_swap_b32 v44, v46
  v_mfma_f32_16x16x32_bf16 v[88:91], v[64:67], v[192:195], v[88:91]
  v_permlane16_swap_b32 v45, v47
  v_mfma_f32_16x16x32_bf16 v[92:95], v[64:67], v[228:231], v[92:95]
  s_add_u32 s58, s56, 49152
  buffer_store_dwordx4 v[40:43], v19, s[24:27], s58 offen sc1
  s_waitcnt lgkmcnt(2)
  v_mfma_f32_16x16x32_bf16 v[80:83], v[68:71], v[124:127], v[80:83]
  ds_read_b64_tr_b16 v[76:77], v18 offset:20480
  ds_read_b64_tr_b16 v[78:79], v18 offset:20992
  v_mfma_f32_16x16x32_bf16 v[84:87], v[68:71], v[160:163], v[84:87]
  v_mfma_f32_16x16x32_bf16 v[88:91], v[68:71], v[196:199], v[88:91]
  v_mfma_f32_16x16x32_bf16 v[92:95], v[68:71], v[232:235], v[92:95]
  ds_read_b64_tr_b16 v[56:57], v18 offset:24576
  ds_read_b64_tr_b16 v[58:59], v18 offset:25088
  s_add_u32 s58, s56, 638976
  buffer_store_dwordx4 v[44:47], v19, s[24:27], s58 offen sc1
  s_waitcnt lgkmcnt(4)
  v_mfma_f32_16x16x32_bf16 v[80:83], v[72:75], v[128:131], v[80:83]
  v_mfma_f32_16x16x32_bf16 v[84:87], v[72:75], v[164:167], v[84:87]
  ds_read_b64_tr_b16 v[60:61], v18 offset:28672
  ds_read_b64_tr_b16 v[62:63], v18 offset:29184
  v_mfma_f32_16x16x32_bf16 v[88:91], v[72:75], v[200:203], v[88:91]
  v_mfma_f32_16x16x32_bf16 v[92:95], v[72:75], v[236:239], v[92:95]
  ds_read_b64_tr_b16 v[64:65], v18 offset:32768
  ds_read_b64_tr_b16 v[66:67], v18 offset:33280
  s_waitcnt lgkmcnt(6)
  v_mfma_f32_16x16x32_bf16 v[80:83], v[76:79], v[132:135], v[80:83]
  ds_read_b128 v[40:43], v4 offset:0
  ds_read_b128 v[44:47], v4 offset:1024
  v_mfma_f32_16x16x32_bf16 v[84:87], v[76:79], v[168:171], v[84:87]
  v_mfma_f32_16x16x32_bf16 v[88:91], v[76:79], v[204:207], v[88:91]
  v_mfma_f32_16x16x32_bf16 v[92:95], v[76:79], v[240:243], v[92:95]
  s_waitcnt lgkmcnt(6)
  v_mfma_f32_16x16x32_bf16 v[80:83], v[56:59], v[136:139], v[80:83]
  v_mfma_f32_16x16x32_bf16 v[84:87], v[56:59], v[172:175], v[84:87]
  v_mfma_f32_16x16x32_bf16 v[88:91], v[56:59], v[208:211], v[88:91]
  v_mfma_f32_16x16x32_bf16 v[92:95], v[56:59], v[244:247], v[92:95]
  s_waitcnt lgkmcnt(0)
  s_barrier
  v_add_u32 v18, 36864, v18
  v_mfma_f32_16x16x32_bf16 v[80:83], v[60:63], v[140:143], v[80:83]
  v_mfma_f32_16x16x32_bf16 v[84:87], v[60:63], v[176:179], v[84:87]
  s_add_u32 s58, s56, 4293820416
  buffer_store_dwordx4 v[40:43], v19, s[24:27], s58 offen sc1
  ds_read_b64_tr_b16 v[68:69], v18 offset:0
  ds_read_b64_tr_b16 v[70:71], v18 offset:512
  v_mfma_f32_16x16x32_bf16 v[88:91], v[60:63], v[212:215], v[88:91]
  v_mfma_f32_16x16x32_bf16 v[92:95], v[60:63], v[248:251], v[92:95]
  v_mfma_f32_16x16x32_bf16 v[80:83], v[64:67], v[144:147], v[80:83]
  s_add_u32 s58, s56, 4294410240
  buffer_store_dwordx4 v[44:47], v19, s[24:27], s58 offen sc1
  v_mfma_f32_16x16x32_bf16 v[84:87], v[64:67], v[180:183], v[84:87]
  ds_read_b64_tr_b16 v[72:73], v18 offset:4096
  ds_read_b64_tr_b16 v[74:75], v18 offset:4608
  v_mfma_f32_16x16x32_bf16 v[88:91], v[64:67], v[216:219], v[88:91]
  v_mfma_f32_16x16x32_bf16 v[92:95], v[64:67], v[252:255], v[92:95]
  s_waitcnt lgkmcnt(2)
  v_mfma_f32_16x16x32_bf16 v[96:99], v[68:71], v[112:115], 0
  v_mfma_f32_16x16x32_bf16 v[100:103], v[68:71], v[148:151], 0
  ds_read_b64_tr_b16 v[76:77], v18 offset:8192
  ds_read_b64_tr_b16 v[78:79], v18 offset:8704
  v_cvt_pk_bf16_f32 v40, v80, v81
  v_cvt_pk_bf16_f32 v41, v82, v83
  v_mfma_f32_16x16x32_bf16 v[104:107], v[68:71], v[184:187], 0
  v_cvt_pk_bf16_f32 v42, v84, v85
  v_mfma_f32_16x16x32_bf16 v[108:111], v[68:71], v[220:223], 0
  v_cvt_pk_bf16_f32 v43, v86, v87
  s_waitcnt lgkmcnt(2)
  v_mfma_f32_16x16x32_bf16 v[96:99], v[72:75], v[116:119], v[96:99]
  v_cvt_pk_bf16_f32 v44, v88, v89
  v_mfma_f32_16x16x32_bf16 v[100:103], v[72:75], v[152:155], v[100:103]
  ds_read_b64_tr_b16 v[56:57], v18 offset:12288
  ds_read_b64_tr_b16 v[58:59], v18 offset:12800
  v_cvt_pk_bf16_f32 v45, v90, v91
  v_mfma_f32_16x16x32_bf16 v[104:107], v[72:75], v[188:191], v[104:107]
  v_cvt_pk_bf16_f32 v46, v92, v93
  v_cvt_pk_bf16_f32 v47, v94, v95
  v_mfma_f32_16x16x32_bf16 v[108:111], v[72:75], v[224:227], v[108:111]
  v_permlane16_swap_b32 v40, v42
  s_waitcnt lgkmcnt(2)
  v_mfma_f32_16x16x32_bf16 v[96:99], v[76:79], v[120:123], v[96:99]
  v_permlane16_swap_b32 v41, v43
  v_mfma_f32_16x16x32_bf16 v[100:103], v[76:79], v[156:159], v[100:103]
  ds_read_b64_tr_b16 v[60:61], v18 offset:16384
  ds_read_b64_tr_b16 v[62:63], v18 offset:16896
  v_permlane16_swap_b32 v44, v46
  v_mfma_f32_16x16x32_bf16 v[104:107], v[76:79], v[192:195], v[104:107]
  v_permlane16_swap_b32 v45, v47
  v_mfma_f32_16x16x32_bf16 v[108:111], v[76:79], v[228:231], v[108:111]
  s_add_u32 s58, s56, 65536
  buffer_store_dwordx4 v[40:43], v19, s[24:27], s58 offen sc1
  s_waitcnt lgkmcnt(2)
  v_mfma_f32_16x16x32_bf16 v[96:99], v[56:59], v[124:127], v[96:99]
  ds_read_b64_tr_b16 v[64:65], v18 offset:20480
  ds_read_b64_tr_b16 v[66:67], v18 offset:20992
  v_mfma_f32_16x16x32_bf16 v[100:103], v[56:59], v[160:163], v[100:103]
  v_mfma_f32_16x16x32_bf16 v[104:107], v[56:59], v[196:199], v[104:107]
  v_mfma_f32_16x16x32_bf16 v[108:111], v[56:59], v[232:235], v[108:111]
  ds_read_b64_tr_b16 v[68:69], v18 offset:24576
  ds_read_b64_tr_b16 v[70:71], v18 offset:25088
  s_add_u32 s58, s56, 655360
  buffer_store_dwordx4 v[44:47], v19, s[24:27], s58 offen sc1
  s_waitcnt lgkmcnt(4)
  v_mfma_f32_16x16x32_bf16 v[96:99], v[60:63], v[128:131], v[96:99]
  v_mfma_f32_16x16x32_bf16 v[100:103], v[60:63], v[164:167], v[100:103]
  ds_read_b64_tr_b16 v[72:73], v18 offset:28672
  ds_read_b64_tr_b16 v[74:75], v18 offset:29184
  v_mfma_f32_16x16x32_bf16 v[104:107], v[60:63], v[200:203], v[104:107]
  v_mfma_f32_16x16x32_bf16 v[108:111], v[60:63], v[236:239], v[108:111]
  ds_read_b64_tr_b16 v[76:77], v18 offset:32768
  ds_read_b64_tr_b16 v[78:79], v18 offset:33280
  s_waitcnt lgkmcnt(6)
  v_mfma_f32_16x16x32_bf16 v[96:99], v[64:67], v[132:135], v[96:99]
  ds_read_b128 v[40:43], v4 offset:8192
  ds_read_b128 v[44:47], v4 offset:9216
  v_mfma_f32_16x16x32_bf16 v[100:103], v[64:67], v[168:171], v[100:103]
  v_mfma_f32_16x16x32_bf16 v[104:107], v[64:67], v[204:207], v[104:107]
  v_mfma_f32_16x16x32_bf16 v[108:111], v[64:67], v[240:243], v[108:111]
  s_waitcnt lgkmcnt(6)
  v_mfma_f32_16x16x32_bf16 v[96:99], v[68:71], v[136:139], v[96:99]
  v_mfma_f32_16x16x32_bf16 v[100:103], v[68:71], v[172:175], v[100:103]
  v_mfma_f32_16x16x32_bf16 v[104:107], v[68:71], v[208:211], v[104:107]
  s_mul_i32 s54, s7, 3
  s_add_u32 s55, s54, 2
  s_lshr_b32 s54, s54, 6
  s_lshr_b32 s55, s55, 6
  s_lshl_b32 s54, s54, 4
  s_lshl_b32 s55, s55, 4
  v_add_u32 v12, s54, v2
  v_add_u32 v13, s55, v2
  v_cmp_gt_u32 vcc, 16, v1
  s_nop 1
  v_cndmask_b32 v12, v13, v12, vcc
  v_lshlrev_b32 v12, 2, v12
  v_add_u32 v12, 20480, v12
  s_mov_b32 s53, 244514816
  buffer_load_dword v14, v12, s[24:27], s53 offen sc1
  v_mfma_f32_16x16x32_bf16 v[108:111], v[68:71], v[244:247], v[108:111]
  s_waitcnt lgkmcnt(0)
  s_barrier
  v_subrev_u32 v18, 73728, v18
  v_mfma_f32_16x16x32_bf16 v[96:99], v[72:75], v[140:143], v[96:99]
  v_mfma_f32_16x16x32_bf16 v[100:103], v[72:75], v[176:179], v[100:103]
  s_add_u32 s58, s56, 4293836800
  buffer_store_dwordx4 v[40:43], v19, s[24:27], s58 offen sc1
  ds_read_b64_tr_b16 v[56:57], v18 offset:0
  ds_read_b64_tr_b16 v[58:59], v18 offset:512
  v_mfma_f32_16x16x32_bf16 v[104:107], v[72:75], v[212:215], v[104:107]
  v_mfma_f32_16x16x32_bf16 v[108:111], v[72:75], v[248:251], v[108:111]
  v_mfma_f32_16x16x32_bf16 v[96:99], v[76:79], v[144:147], v[96:99]
  s_add_u32 s58, s56, 4294426624
  buffer_store_dwordx4 v[44:47], v19, s[24:27], s58 offen sc1
  v_mfma_f32_16x16x32_bf16 v[100:103], v[76:79], v[180:183], v[100:103]
  ds_read_b64_tr_b16 v[60:61], v18 offset:4096
  ds_read_b64_tr_b16 v[62:63], v18 offset:4608
  v_mfma_f32_16x16x32_bf16 v[104:107], v[76:79], v[216:219], v[104:107]
  v_mfma_f32_16x16x32_bf16 v[108:111], v[76:79], v[252:255], v[108:111]
  s_waitcnt lgkmcnt(2)
  v_mfma_f32_16x16x32_bf16 v[80:83], v[56:59], v[112:115], 0
  s_waitcnt vmcnt(2)
  v_readfirstlane_b32 s53, v14
  v_cmp_ne_u32 vcc, s57, v14
  s_nop 3
  s_cmp_eq_u64 vcc, 0
  s_cbranch_scc1 L_spind_62
  s_mov_b32 s54, 0x20000
  s_mov_b32 s53, 244514816
L_spin_61:
  s_sleep 4
  buffer_load_dword v14, v12, s[24:27], s53 offen sc1
  s_waitcnt vmcnt(0)
  v_cmp_ne_u32 vcc, s57, v14
  s_nop 4
  s_sub_u32 s54, s54, 1
  s_cmp_eq_u32 s54, 0
  s_cbranch_scc1 L_spind_62
  s_cmp_lg_u64 vcc, 0
  s_cbranch_scc1 L_spin_61
L_spind_62:
  v_mfma_f32_16x16x32_bf16 v[84:87], v[56:59], v[148:151], 0
  ds_read_b64_tr_b16 v[64:65], v18 offset:8192
  ds_read_b64_tr_b16 v[66:67], v18 offset:8704
  v_cvt_pk_bf16_f32 v40, v96, v97
  v_cvt_pk_bf16_f32 v41, v98, v99
  v_mfma_f32_16x16x32_bf16 v[88:91], v[56:59], v[184:187], 0
  v_cvt_pk_bf16_f32 v42, v100, v101
  s_mul_i32 s53, s7, 12288
  v_mfma_f32_16x16x32_bf16 v[92:95], v[56:59], v[220:223], 0
  v_cvt_pk_bf16_f32 v43, v102, v103
  s_waitcnt lgkmcnt(2)
  v_mfma_f32_16x16x32_bf16 v[80:83], v[60:63], v[116:119], v[80:83]
  v_cvt_pk_bf16_f32 v44, v104, v105
  v_mfma_f32_16x16x32_bf16 v[84:87], v[60:63], v[152:155], v[84:87]
  ds_read_b64_tr_b16 v[68:69], v18 offset:12288
  ds_read_b64_tr_b16 v[70:71], v18 offset:12800
  v_cvt_pk_bf16_f32 v45, v106, v107
  s_add_u32 s53, s53, 239075328
  v_mfma_f32_16x16x32_bf16 v[88:91], v[60:63], v[188:191], v[88:91]
  v_cvt_pk_bf16_f32 v46, v108, v109
  v_cvt_pk_bf16_f32 v47, v110, v111
  v_mfma_f32_16x16x32_bf16 v[92:95], v[60:63], v[224:227], v[92:95]
  v_permlane16_swap_b32 v40, v42
  s_waitcnt lgkmcnt(2)
  v_mfma_f32_16x16x32_bf16 v[80:83], v[64:67], v[120:123], v[80:83]
  v_permlane16_swap_b32 v41, v43
  v_lshlrev_b32 v5, 4, v0
  v_mfma_f32_16x16x32_bf16 v[84:87], v[64:67], v[156:159], v[84:87]
  ds_read_b64_tr_b16 v[72:73], v18 offset:16384
  ds_read_b64_tr_b16 v[74:75], v18 offset:16896
  v_permlane16_swap_b32 v44, v46
  v_mfma_f32_16x16x32_bf16 v[88:91], v[64:67], v[192:195], v[88:91]
  v_permlane16_swap_b32 v45, v47
  v_mfma_f32_16x16x32_bf16 v[92:95], v[64:67], v[228:231], v[92:95]
  s_add_u32 s58, s56, 81920
  buffer_store_dwordx4 v[40:43], v19, s[24:27], s58 offen sc1
  v_add_u32 v6, 8192, v5
  s_waitcnt lgkmcnt(2)
  v_mfma_f32_16x16x32_bf16 v[80:83], v[68:71], v[124:127], v[80:83]
  ds_read_b64_tr_b16 v[76:77], v18 offset:20480
  ds_read_b64_tr_b16 v[78:79], v18 offset:20992
  v_mfma_f32_16x16x32_bf16 v[84:87], v[68:71], v[160:163], v[84:87]
  v_mfma_f32_16x16x32_bf16 v[88:91], v[68:71], v[196:199], v[88:91]
  v_cmp_gt_u32 vcc, 256, v0
  v_mfma_f32_16x16x32_bf16 v[92:95], v[68:71], v[232:235], v[92:95]
  ds_read_b64_tr_b16 v[56:57], v18 offset:24576
  ds_read_b64_tr_b16 v[58:59], v18 offset:25088
  s_add_u32 s58, s56, 671744
  buffer_store_dwordx4 v[44:47], v19, s[24:27], s58 offen sc1
  s_waitcnt lgkmcnt(4)
  v_mfma_f32_16x16x32_bf16 v[80:83], v[72:75], v[128:131], v[80:83]
  v_mfma_f32_16x16x32_bf16 v[84:87], v[72:75], v[164:167], v[84:87]
  ds_read_b64_tr_b16 v[60:61], v18 offset:28672
  ds_read_b64_tr_b16 v[62:63], v18 offset:29184
  v_cndmask_b32 v6, v20, v6, vcc
  v_mfma_f32_16x16x32_bf16 v[88:91], v[72:75], v[200:203], v[88:91]
  v_mfma_f32_16x16x32_bf16 v[92:95], v[72:75], v[236:239], v[92:95]
  ds_read_b64_tr_b16 v[64:65], v18 offset:32768
  ds_read_b64_tr_b16 v[66:67], v18 offset:33280
  s_waitcnt lgkmcnt(6)
  v_mfma_f32_16x16x32_bf16 v[80:83], v[76:79], v[132:135], v[80:83]
  ds_read_b128 v[40:43], v4 offset:0
  ds_read_b128 v[44:47], v4 offset:1024
  buffer_load_dwordx4 v[48:51], v5, s[24:27], s53 offen sc1
  v_mfma_f32_16x16x32_bf16 v[84:87], v[76:79], v[168:171], v[84:87]
  v_mfma_f32_16x16x32_bf16 v[88:91], v[76:79], v[204:207], v[88:91]
  v_mfma_f32_16x16x32_bf16 v[92:95], v[76:79], v[240:243], v[92:95]
  buffer_load_dwordx4 v[52:55], v6, s[24:27], s53 offen sc1
  s_waitcnt lgkmcnt(6)
  v_mfma_f32_16x16x32_bf16 v[80:83], v[56:59], v[136:139], v[80:83]
  v_mfma_f32_16x16x32_bf16 v[84:87], v[56:59], v[172:175], v[84:87]
  v_mfma_f32_16x16x32_bf16 v[88:91], v[56:59], v[208:211], v[88:91]
  v_mfma_f32_16x16x32_bf16 v[92:95], v[56:59], v[244:247], v[92:95]
  s_waitcnt lgkmcnt(0)
  s_barrier
  v_add_u32 v18, 36864, v18
  v_mfma_f32_16x16x32_bf16 v[80:83], v[60:63], v[140:143], v[80:83]
  v_mfma_f32_16x16x32_bf16 v[84:87], v[60:63], v[176:179], v[84:87]
  s_add_u32 s58, s56, 4293853184
  buffer_store_dwordx4 v[40:43], v19, s[24:27], s58 offen sc1
  ds_read_b64_tr_b16 v[68:69], v18 offset:0
  ds_read_b64_tr_b16 v[70:71], v18 offset:512
  v_mfma_f32_16x16x32_bf16 v[88:91], v[60:63], v[212:215], v[88:91]
  v_mfma_f32_16x16x32_bf16 v[92:95], v[60:63], v[248:251], v[92:95]
  v_mfma_f32_16x16x32_bf16 v[80:83], v[64:67], v[144:147], v[80:83]
  s_add_u32 s58, s56, 4294443008
  buffer_store_dwordx4 v[44:47], v19, s[24:27], s58 offen sc1
  v_mfma_f32_16x16x32_bf16 v[84:87], v[64:67], v[180:183], v[84:87]
  ds_read_b64_tr_b16 v[72:73], v18 offset:4096
  ds_read_b64_tr_b16 v[74:75], v18 offset:4608
  v_mfma_f32_16x16x32_bf16 v[88:91], v[64:67], v[216:219], v[88:91]
  v_mfma_f32_16x16x32_bf16 v[92:95], v[64:67], v[252:255], v[92:95]
  s_waitcnt lgkmcnt(2)
  v_mfma_f32_16x16x32_bf16 v[96:99], v[68:71], v[112:115], 0
  v_mfma_f32_16x16x32_bf16 v[100:103], v[68:71], v[148:151], 0
  ds_read_b64_tr_b16 v[76:77], v18 offset:8192
  ds_read_b64_tr_b16 v[78:79], v18 offset:8704
  v_cvt_pk_bf16_f32 v40, v80, v81
  v_cvt_pk_bf16_f32 v41, v82, v83
  v_mfma_f32_16x16x32_bf16 v[104:107], v[68:71], v[184:187], 0
  v_cvt_pk_bf16_f32 v42, v84, v85
  v_mfma_f32_16x16x32_bf16 v[108:111], v[68:71], v[220:223], 0
  v_cvt_pk_bf16_f32 v43, v86, v87
  s_waitcnt lgkmcnt(2)
  v_mfma_f32_16x16x32_bf16 v[96:99], v[72:75], v[116:119], v[96:99]
  v_cvt_pk_bf16_f32 v44, v88, v89
  v_mfma_f32_16x16x32_bf16 v[100:103], v[72:75], v[152:155], v[100:103]
  ds_read_b64_tr_b16 v[56:57], v18 offset:12288
  ds_read_b64_tr_b16 v[58:59], v18 offset:12800
  v_cvt_pk_bf16_f32 v45, v90, v91
  v_mfma_f32_16x16x32_bf16 v[104:107], v[72:75], v[188:191], v[104:107]
  v_cvt_pk_bf16_f32 v46, v92, v93
  v_cvt_pk_bf16_f32 v47, v94, v95
  v_mfma_f32_16x16x32_bf16 v[108:111], v[72:75], v[224:227], v[108:111]
  v_permlane16_swap_b32 v40, v42
  s_waitcnt lgkmcnt(2)
  v_mfma_f32_16x16x32_bf16 v[96:99], v[76:79], v[120:123], v[96:99]
  v_permlane16_swap_b32 v41, v43
  v_mfma_f32_16x16x32_bf16 v[100:103], v[76:79], v[156:159], v[100:103]
  ds_read_b64_tr_b16 v[60:61], v18 offset:16384
  ds_read_b64_tr_b16 v[62:63], v18 offset:16896
  v_permlane16_swap_b32 v44, v46
  v_mfma_f32_16x16x32_bf16 v[104:107], v[76:79], v[192:195], v[104:107]
  v_permlane16_swap_b32 v45, v47
  v_mfma_f32_16x16x32_bf16 v[108:111], v[76:79], v[228:231], v[108:111]
  s_add_u32 s58, s56, 98304
  buffer_store_dwordx4 v[40:43], v19, s[24:27], s58 offen sc1
  s_waitcnt lgkmcnt(2)
  v_mfma_f32_16x16x32_bf16 v[96:99], v[56:59], v[124:127], v[96:99]
  ds_read_b64_tr_b16 v[64:65], v18 offset:20480
  ds_read_b64_tr_b16 v[66:67], v18 offset:20992
  v_mfma_f32_16x16x32_bf16 v[100:103], v[56:59], v[160:163], v[100:103]
  v_mfma_f32_16x16x32_bf16 v[104:107], v[56:59], v[196:199], v[104:107]
  v_mfma_f32_16x16x32_bf16 v[108:111], v[56:59], v[232:235], v[108:111]
  ds_read_b64_tr_b16 v[68:69], v18 offset:24576
  ds_read_b64_tr_b16 v[70:71], v18 offset:25088
  s_add_u32 s58, s56, 688128
  buffer_store_dwordx4 v[44:47], v19, s[24:27], s58 offen sc1
  s_waitcnt lgkmcnt(4)
  v_mfma_f32_16x16x32_bf16 v[96:99], v[60:63], v[128:131], v[96:99]
  v_mfma_f32_16x16x32_bf16 v[100:103], v[60:63], v[164:167], v[100:103]
  ds_read_b64_tr_b16 v[72:73], v18 offset:28672
  ds_read_b64_tr_b16 v[74:75], v18 offset:29184
  v_mfma_f32_16x16x32_bf16 v[104:107], v[60:63], v[200:203], v[104:107]
  v_mfma_f32_16x16x32_bf16 v[108:111], v[60:63], v[236:239], v[108:111]
  ds_read_b64_tr_b16 v[76:77], v18 offset:32768
  ds_read_b64_tr_b16 v[78:79], v18 offset:33280
  s_waitcnt lgkmcnt(6)
  v_mfma_f32_16x16x32_bf16 v[96:99], v[64:67], v[132:135], v[96:99]
  ds_read_b128 v[40:43], v4 offset:8192
  ds_read_b128 v[44:47], v4 offset:9216
  v_mfma_f32_16x16x32_bf16 v[100:103], v[64:67], v[168:171], v[100:103]
  v_mfma_f32_16x16x32_bf16 v[104:107], v[64:67], v[204:207], v[104:107]
  v_mfma_f32_16x16x32_bf16 v[108:111], v[64:67], v[240:243], v[108:111]
  s_waitcnt lgkmcnt(6)
  v_mfma_f32_16x16x32_bf16 v[96:99], v[68:71], v[136:139], v[96:99]
  v_mfma_f32_16x16x32_bf16 v[100:103], v[68:71], v[172:175], v[100:103]
  v_mfma_f32_16x16x32_bf16 v[104:107], v[68:71], v[208:211], v[104:107]
  v_mfma_f32_16x16x32_bf16 v[108:111], v[68:71], v[244:247], v[108:111]
  s_waitcnt lgkmcnt(0)
  s_waitcnt vmcnt(8)
  s_barrier
  v_add_u32 v18, 36864, v18
  v_mfma_f32_16x16x32_bf16 v[96:99], v[72:75], v[140:143], v[96:99]
  s_lshl_b32 s54, s45, 7
  s_lshl_b32 s55, s46, 2
  s_add_u32 s54, s54, s55
  s_add_u32 s54, s54, 244514816
  v_cmp_eq_u32 vcc, 0, v0
  s_nop 1
  v_cndmask_b32 v7, v20, v0, vcc
  v_mov_b32 v8, s57
  buffer_store_dword v8, v7, s[24:27], s54 offen sc1
  v_mfma_f32_16x16x32_bf16 v[100:103], v[72:75], v[176:179], v[100:103]
  s_add_u32 s58, s56, 4293869568
  buffer_store_dwordx4 v[40:43], v19, s[24:27], s58 offen sc1
  ds_read_b64_tr_b16 v[56:57], v18 offset:0
  ds_read_b64_tr_b16 v[58:59], v18 offset:512
  v_mfma_f32_16x16x32_bf16 v[104:107], v[72:75], v[212:215], v[104:107]
  v_mfma_f32_16x16x32_bf16 v[108:111], v[72:75], v[248:251], v[108:111]
  v_mfma_f32_16x16x32_bf16 v[96:99], v[76:79], v[144:147], v[96:99]
  s_add_u32 s58, s56, 4294459392
  buffer_store_dwordx4 v[44:47], v19, s[24:27], s58 offen sc1
  v_mfma_f32_16x16x32_bf16 v[100:103], v[76:79], v[180:183], v[100:103]
  ds_read_b64_tr_b16 v[60:61], v18 offset:4096
  ds_read_b64_tr_b16 v[62:63], v18 offset:4608
  v_mfma_f32_16x16x32_bf16 v[104:107], v[76:79], v[216:219], v[104:107]
  v_mfma_f32_16x16x32_bf16 v[108:111], v[76:79], v[252:255], v[108:111]
  s_waitcnt lgkmcnt(2)
  v_mfma_f32_16x16x32_bf16 v[80:83], v[56:59], v[112:115], 0
  v_mov_b32 v6, 0
  v_mov_b32 v7, 0
  v_mfma_f32_16x16x32_bf16 v[84:87], v[56:59], v[148:151], 0
  ds_read_b64_tr_b16 v[64:65], v18 offset:8192
  ds_read_b64_tr_b16 v[66:67], v18 offset:8704
  v_cvt_pk_bf16_f32 v40, v96, v97
  v_cvt_pk_bf16_f32 v41, v98, v99
  v_mov_b32 v8, 0
  v_mov_b32 v9, 0
  v_mfma_f32_16x16x32_bf16 v[88:91], v[56:59], v[184:187], 0
  v_cvt_pk_bf16_f32 v42, v100, v101
  v_lshlrev_b32 v12, 4, v1
  v_add_u32 v12, 112640, v12
  v_mfma_f32_16x16x32_bf16 v[92:95], v[56:59], v[220:223], 0
  v_cvt_pk_bf16_f32 v43, v102, v103
  v_lshrrev_b32 v10, 5, v0
  v_mul_u32_u24 v10, 4608, v10
  s_waitcnt lgkmcnt(2)
  v_mfma_f32_16x16x32_bf16 v[80:83], v[60:63], v[116:119], v[80:83]
  v_cvt_pk_bf16_f32 v44, v104, v105
  v_and_b32 v11, 31, v0
  v_lshlrev_b32 v11, 4, v11
  v_mfma_f32_16x16x32_bf16 v[84:87], v[60:63], v[152:155], v[84:87]
  ds_read_b64_tr_b16 v[68:69], v18 offset:12288
  ds_read_b64_tr_b16 v[70:71], v18 offset:12800
  v_cvt_pk_bf16_f32 v45, v106, v107
  v_add_u32 v10, v10, v11
  v_mfma_f32_16x16x32_bf16 v[88:91], v[60:63], v[188:191], v[88:91]
  v_cvt_pk_bf16_f32 v46, v108, v109
  v_cvt_pk_bf16_f32 v47, v110, v111
  v_add_u32 v10, 0, v10
  v_cmp_gt_u32 vcc, 96, v0
  v_mfma_f32_16x16x32_bf16 v[92:95], v[60:63], v[224:227], v[92:95]
  v_permlane16_swap_b32 v40, v42
  v_cndmask_b32 v10, v12, v10, vcc
  ds_write_b128 v10, v[6:9]
  s_waitcnt lgkmcnt(3)
  v_mfma_f32_16x16x32_bf16 v[80:83], v[64:67], v[120:123], v[80:83]
  v_permlane16_swap_b32 v41, v43
  v_and_b32 v10, 7, v0
  v_mul_u32_u24 v10, 4160, v10
  v_mfma_f32_16x16x32_bf16 v[84:87], v[64:67], v[156:159], v[84:87]
  ds_read_b64_tr_b16 v[72:73], v18 offset:16384
  ds_read_b64_tr_b16 v[74:75], v18 offset:16896
  v_permlane16_swap_b32 v44, v46
  v_add_u32 v10, 118304, v10
  v_cmp_gt_u32 vcc, 8, v0
  v_mfma_f32_16x16x32_bf16 v[88:91], v[64:67], v[192:195], v[88:91]
  v_permlane16_swap_b32 v45, v47
  v_cndmask_b32 v10, v12, v10, vcc
  ds_write_b128 v10, v[6:9]
  v_mfma_f32_16x16x32_bf16 v[92:95], v[64:67], v[228:231], v[92:95]
  s_add_u32 s58, s56, 114688
  buffer_store_dwordx4 v[40:43], v19, s[24:27], s58 offen sc1
  v_lshlrev_b32 v11, 4, v0
  s_waitcnt lgkmcnt(4)
  v_mfma_f32_16x16x32_bf16 v[80:83], v[68:71], v[124:127], v[80:83]
  ds_read_b64_tr_b16 v[76:77], v18 offset:20480
  ds_read_b64_tr_b16 v[78:79], v18 offset:20992
  v_lshrrev_b32 v10, 8, v0
  v_lshlrev_b32 v10, 9, v10
  v_mfma_f32_16x16x32_bf16 v[84:87], v[68:71], v[160:163], v[84:87]
  v_add_u32 v10, v10, v11
  v_add_u32 v10, 512, v10
  v_mfma_f32_16x16x32_bf16 v[88:91], v[68:71], v[196:199], v[88:91]
  s_waitcnt vmcnt(9)
  ds_write_b128 v10, v[48:51]
  v_add_u32 v10, 9728, v11
  v_mfma_f32_16x16x32_bf16 v[92:95], v[68:71], v[232:235], v[92:95]
  ds_read_b64_tr_b16 v[56:57], v18 offset:24576
  ds_read_b64_tr_b16 v[58:59], v18 offset:25088
  s_add_u32 s58, s56, 704512
  buffer_store_dwordx4 v[44:47], v19, s[24:27], s58 offen sc1
  v_cmp_gt_u32 vcc, 256, v0
  s_nop 1
  v_cndmask_b32 v10, v12, v10, vcc
  s_waitcnt lgkmcnt(6)
  v_mfma_f32_16x16x32_bf16 v[80:83], v[72:75], v[128:131], v[80:83]
  s_waitcnt vmcnt(9)
  ds_write_b128 v10, v[52:55]
  v_and_b32 v10, 7, v2
  v_mfma_f32_16x16x32_bf16 v[84:87], v[72:75], v[164:167], v[84:87]
  ds_read_b64_tr_b16 v[60:61], v18 offset:28672
  ds_read_b64_tr_b16 v[62:63], v18 offset:29184
  v_sub_u32 v10, 7, v10
  v_mfma_f32_16x16x32_bf16 v[88:91], v[72:75], v[200:203], v[88:91]
  v_mul_u32_u24 v10, 4160, v10
  v_lshrrev_b32 v11, 3, v2
  v_mfma_f32_16x16x32_bf16 v[92:95], v[72:75], v[236:239], v[92:95]
  ds_read_b64_tr_b16 v[64:65], v18 offset:32768
  ds_read_b64_tr_b16 v[66:67], v18 offset:33280
  v_sub_u32 v11, v3, v11
  v_add_u32 v11, 255, v11
  s_waitcnt lgkmcnt(8)
  v_mfma_f32_16x16x32_bf16 v[80:83], v[76:79], v[132:135], v[80:83]
  ds_read_b128 v[40:43], v4 offset:0
  ds_read_b128 v[44:47], v4 offset:1024
  v_lshlrev_b32 v11, 4, v11
  v_add_u32 v10, v10, v11
  v_mfma_f32_16x16x32_bf16 v[84:87], v[76:79], v[168:171], v[84:87]
  s_lshl_b32 s53, s44, 6
  s_add_u32 s53, s53, 3584
  v_mfma_f32_16x16x32_bf16 v[88:91], v[76:79], v[204:207], v[88:91]
  v_subrev_u32 v10, s53, v10
  v_add_u32 v50, 114176, v10
  v_mfma_f32_16x16x32_bf16 v[92:95], v[76:79], v[240:243], v[92:95]
  v_add_u32 v49, 13824, v10
  s_waitcnt lgkmcnt(7)
  v_mfma_f32_16x16x32_bf16 v[80:83], v[56:59], v[136:139], v[80:83]
  v_lshlrev_b32 v10, 5, v2
  v_lshlrev_b32 v11, 4, v3
  v_mfma_f32_16x16x32_bf16 v[84:87], v[56:59], v[172:175], v[84:87]
  v_add_u32 v10, v10, v11
  v_add_u32 v10, 480, v10
  v_mfma_f32_16x16x32_bf16 v[88:91], v[56:59], v[208:211], v[88:91]
  s_lshl_b32 s53, s44, 6
  v_subrev_u32 v51, s53, v10
  v_mfma_f32_16x16x32_bf16 v[92:95], v[56:59], v[244:247], v[92:95]
  v_lshlrev_b32 v52, 3, v1
  s_lshl_b32 s53, s44, 9
  s_waitcnt lgkmcnt(0)
  s_barrier
  v_mfma_f32_16x16x32_bf16 v[80:83], v[60:63], v[140:143], v[80:83]
  v_add_u32 v52, s53, v52
  v_add_u32 v52, 47104, v52
  v_mfma_f32_16x16x32_bf16 v[84:87], v[60:63], v[176:179], v[84:87]
  s_add_u32 s58, s56, 4293885952
  buffer_store_dwordx4 v[40:43], v19, s[24:27], s58 offen sc1
  v_lshlrev_b32 v53, 3, v1
  v_mfma_f32_16x16x32_bf16 v[88:91], v[60:63], v[212:215], v[88:91]
  s_lshl_b32 s53, s51, 12
  v_add_u32 v53, s53, v53
  v_mfma_f32_16x16x32_bf16 v[92:95], v[60:63], v[248:251], v[92:95]
  v_add_u32 v53, 47104, v53
  v_lshlrev_b32 v54, 5, v2
  v_mfma_f32_16x16x32_bf16 v[80:83], v[64:67], v[144:147], v[80:83]
  s_add_u32 s58, s56, 4294475776
  buffer_store_dwordx4 v[44:47], v19, s[24:27], s58 offen sc1
  v_lshlrev_b32 v55, 3, v3
  v_add_u32 v54, v54, v55
  v_mfma_f32_16x16x32_bf16 v[84:87], v[64:67], v[180:183], v[84:87]
  s_lshl_b32 s53, s51, 9
  v_add_u32 v54, s53, v54
  v_mfma_f32_16x16x32_bf16 v[88:91], v[64:67], v[216:219], v[88:91]
  v_add_u32 v55, 512, v54
  v_mfma_f32_16x16x32_bf16 v[92:95], v[64:67], v[252:255], v[92:95]
  ds_read_b128 v[40:43], v4 offset:8192
  ds_read_b128 v[44:47], v4 offset:9216
  s_add_u32 s58, s56, 4293902336
  s_waitcnt lgkmcnt(1)
  buffer_store_dwordx4 v[40:43], v19, s[24:27], s58 offen sc1
  s_add_u32 s58, s56, 4294492160
  s_waitcnt lgkmcnt(0)
  buffer_store_dwordx4 v[44:47], v19, s[24:27], s58 offen sc1
  v_cvt_pk_bf16_f32 v40, v80, v81
  v_cvt_pk_bf16_f32 v41, v82, v83
  v_cvt_pk_bf16_f32 v42, v84, v85
  v_cvt_pk_bf16_f32 v43, v86, v87
  v_cvt_pk_bf16_f32 v44, v88, v89
  v_cvt_pk_bf16_f32 v45, v90, v91
  v_cvt_pk_bf16_f32 v46, v92, v93
  v_cvt_pk_bf16_f32 v47, v94, v95
  v_permlane16_swap_b32 v40, v42
  v_permlane16_swap_b32 v41, v43
  v_permlane16_swap_b32 v44, v46
  v_permlane16_swap_b32 v45, v47
  s_add_u32 s58, s56, 131072
  buffer_store_dwordx4 v[40:43], v19, s[24:27], s58 offen sc1
  s_add_u32 s58, s56, 720896
  buffer_store_dwordx4 v[44:47], v19, s[24:27], s58 offen sc1
L_g2end:
  s_lshl_b32 s59, s45, 4
  s_add_u32 s59, s59, s46
  s_mul_i32 s59, s59, 147456
  s_lshl_b32 s55, s44, 14
  s_add_u32 s59, s59, s55
  s_add_u32 s59, s59, 201326592
  v_lshlrev_b32 v18, 4, v1
  s_cmp_ge_u32 s2, 192
  s_cbranch_scc1 L_noconv
  s_cmp_ge_u32 s44, 4
  s_cbranch_scc1 L_cvB
  s_mov_b32 s73, 0
  s_barrier
  s_lshl_b32 s54, s45, 7
  v_lshlrev_b32 v16, 2, v2
  v_add_u32 v16, s54, v16
  v_add_u32 v16, 0, v16
  s_mov_b32 s53, 244514816
  buffer_load_dword v17, v16, s[24:27], s53 offen sc1
  ds_read_b128 v[176:179], v50 offset:3584
  ds_read_b128 v[208:211], v51 offset:0
  ds_read_b128 v[180:183], v50 offset:3072
  ds_read_b128 v[212:215], v51 offset:512
  ds_read_b128 v[184:187], v50 offset:2560
  ds_read_b128 v[216:219], v51 offset:1024
  ds_read_b128 v[188:191], v50 offset:2048
  ds_read_b128 v[220:223], v51 offset:1536
  ds_read_b128 v[192:195], v50 offset:1536
  ds_read_b128 v[224:227], v51 offset:2048
  ds_read_b128 v[196:199], v50 offset:1024
  ds_read_b128 v[228:231], v51 offset:2560
  ds_read_b128 v[200:203], v50 offset:512
  ds_read_b128 v[232:235], v51 offset:3072
  ds_read_b128 v[204:207], v50 offset:0
  ds_read_b128 v[236:239], v51 offset:3584
  s_waitcnt lgkmcnt(14)
  v_mfma_f32_16x16x32_bf16 v[80:83], v[176:179], v[208:211], 0
  s_waitcnt lgkmcnt(12)
  v_mfma_f32_16x16x32_bf16 v[84:87], v[176:179], v[212:215], 0
  v_mfma_f32_16x16x32_bf16 v[84:87], v[180:183], v[208:211], v[84:87]
  v_mfma_f32_16x16x32_bf16 v[88:91], v[180:183], v[212:215], 0
  s_waitcnt lgkmcnt(10)
  v_mfma_f32_16x16x32_bf16 v[88:91], v[176:179], v[216:219], v[88:91]
  v_mfma_f32_16x16x32_bf16 v[88:91], v[184:187], v[208:211], v[88:91]
  v_mfma_f32_16x16x32_bf16 v[92:95], v[180:183], v[216:219], 0
  v_mfma_f32_16x16x32_bf16 v[92:95], v[184:187], v[212:215], v[92:95]
  v_mfma_f32_16x16x32_bf16 v[96:99], v[184:187], v[216:219], 0
  s_waitcnt lgkmcnt(8)
  v_mfma_f32_16x16x32_bf16 v[92:95], v[176:179], v[220:223], v[92:95]
  v_mfma_f32_16x16x32_bf16 v[92:95], v[188:191], v[208:211], v[92:95]
  v_mfma_f32_16x16x32_bf16 v[96:99], v[180:183], v[220:223], v[96:99]
  v_mfma_f32_16x16x32_bf16 v[96:99], v[188:191], v[212:215], v[96:99]
  v_mfma_f32_16x16x32_bf16 v[100:103], v[184:187], v[220:223], 0
  v_mfma_f32_16x16x32_bf16 v[100:103], v[188:191], v[216:219], v[100:103]
  v_mfma_f32_16x16x32_bf16 v[104:107], v[188:191], v[220:223], 0
  s_waitcnt lgkmcnt(6)
  v_mfma_f32_16x16x32_bf16 v[96:99], v[176:179], v[224:227], v[96:99]
  v_mfma_f32_16x16x32_bf16 v[96:99], v[192:195], v[208:211], v[96:99]
  v_mfma_f32_16x16x32_bf16 v[100:103], v[180:183], v[224:227], v[100:103]
  v_mfma_f32_16x16x32_bf16 v[100:103], v[192:195], v[212:215], v[100:103]
  v_mfma_f32_16x16x32_bf16 v[104:107], v[184:187], v[224:227], v[104:107]
  v_mfma_f32_16x16x32_bf16 v[104:107], v[192:195], v[216:219], v[104:107]
  v_mfma_f32_16x16x32_bf16 v[108:111], v[188:191], v[224:227], 0
  v_mfma_f32_16x16x32_bf16 v[108:111], v[192:195], v[220:223], v[108:111]
  s_waitcnt lgkmcnt(4)
  v_mfma_f32_16x16x32_bf16 v[100:103], v[176:179], v[228:231], v[100:103]
  v_mfma_f32_16x16x32_bf16 v[100:103], v[196:199], v[208:211], v[100:103]
  v_mfma_f32_16x16x32_bf16 v[104:107], v[180:183], v[228:231], v[104:107]
  v_mfma_f32_16x16x32_bf16 v[104:107], v[196:199], v[212:215], v[104:107]
  v_mfma_f32_16x16x32_bf16 v[108:111], v[184:187], v[228:231], v[108:111]
  v_mfma_f32_16x16x32_bf16 v[108:111], v[196:199], v[216:219], v[108:111]
  s_waitcnt lgkmcnt(2)
  v_mfma_f32_16x16x32_bf16 v[104:107], v[176:179], v[232:235], v[104:107]
  v_mfma_f32_16x16x32_bf16 v[104:107], v[200:203], v[208:211], v[104:107]
  v_mfma_f32_16x16x32_bf16 v[108:111], v[180:183], v[232:235], v[108:111]
  v_mfma_f32_16x16x32_bf16 v[108:111], v[200:203], v[212:215], v[108:111]
  s_waitcnt lgkmcnt(0)
  v_mfma_f32_16x16x32_bf16 v[108:111], v[176:179], v[236:239], v[108:111]
  v_mfma_f32_16x16x32_bf16 v[108:111], v[204:207], v[208:211], v[108:111]
  v_cvt_pk_bf16_f32 v80, v80, v81
  v_cvt_pk_bf16_f32 v81, v82, v83
  ds_write_b64 v52, v[80:81] offset:0
  v_cvt_pk_bf16_f32 v84, v84, v85
  v_cvt_pk_bf16_f32 v85, v86, v87
  ds_write_b64 v52, v[84:85] offset:4096
  v_cvt_pk_bf16_f32 v88, v88, v89
  v_cvt_pk_bf16_f32 v89, v90, v91
  ds_write_b64 v52, v[88:89] offset:8192
  v_cvt_pk_bf16_f32 v92, v92, v93
  v_cvt_pk_bf16_f32 v93, v94, v95
  ds_write_b64 v52, v[92:93] offset:12288
  v_cvt_pk_bf16_f32 v96, v96, v97
  v_cvt_pk_bf16_f32 v97, v98, v99
  ds_write_b64 v52, v[96:97] offset:16384
  v_cvt_pk_bf16_f32 v100, v100, v101
  v_cvt_pk_bf16_f32 v101, v102, v103
  ds_write_b64 v52, v[100:101] offset:20480
  v_cvt_pk_bf16_f32 v104, v104, v105
  v_cvt_pk_bf16_f32 v105, v106, v107
  ds_write_b64 v52, v[104:105] offset:24576
  v_cvt_pk_bf16_f32 v108, v108, v109
  v_cvt_pk_bf16_f32 v109, v110, v111
  ds_write_b64 v52, v[108:109] offset:28672
  s_waitcnt vmcnt(0)
  v_cmp_ne_u32 vcc, s57, v17
  s_nop 4
  s_cmp_eq_u64 vcc, 0
  s_cselect_b32 s73, 1, 0
  s_lshl_b32 s53, s45, 7
  s_lshl_b32 s54, s46, 3
  s_add_u32 s53, s53, s54
  v_and_b32 v41, 7, v1
  v_add_u32 v41, s53, v41
  v_mul_u32_u24 v15, 1152, v41
  v_lshrrev_b32 v43, 3, v1
  v_lshlrev_b32 v43, 4, v43
  v_add_u32 v15, v15, v43
  s_mov_b32 s36, s60
  s_and_b32 s37, s61, 0xffff
  s_mov_b32 s38, 2359296
  s_mov_b32 s39, 0x20000
  s_lshl_b32 s54, s44, 7
  buffer_load_dwordx4 v[240:243], v15, s[36:39], s54 offen
  buffer_load_dwordx4 v[244:247], v15, s[36:39], 0 offen offset:1024
  buffer_load_dwordx4 v[248:251], v15, s[8:11], s54 offen sc1
  buffer_load_dwordx4 v[252:255], v15, s[8:11], 0 offen offset:1024 sc1
  s_waitcnt lgkmcnt(0)
  s_barrier
  s_lshl_b32 s54, s45, 7
  s_lshl_b32 s55, s46, 2
  s_add_u32 s54, s54, s55
  s_add_u32 s54, s54, 244523008
  v_cmp_eq_u32 vcc, 0, v0
  s_nop 1
  v_cndmask_b32 v44, v20, v0, vcc
  v_mov_b32 v45, s57
  buffer_store_dword v45, v44, s[24:27], s54 offen sc1
  ds_read_b128 v[176:179], v49 offset:3584
  ds_read_b128 v[208:211], v51 offset:4608
  ds_read_b128 v[180:183], v49 offset:3072
  ds_read_b128 v[212:215], v51 offset:5120
  ds_read_b128 v[184:187], v49 offset:2560
  ds_read_b128 v[216:219], v51 offset:5632
  ds_read_b128 v[188:191], v49 offset:2048
  ds_read_b128 v[220:223], v51 offset:6144
  ds_read_b128 v[192:195], v49 offset:1536
  ds_read_b128 v[224:227], v51 offset:6656
  ds_read_b128 v[196:199], v49 offset:1024
  ds_read_b128 v[228:231], v51 offset:7168
  ds_read_b128 v[200:203], v49 offset:512
  ds_read_b128 v[232:235], v51 offset:7680
  ds_read_b128 v[204:207], v49 offset:0
  ds_read_b128 v[236:239], v51 offset:8192
  s_waitcnt lgkmcnt(14)
  v_mfma_f32_16x16x32_bf16 v[80:83], v[176:179], v[208:211], 0
  s_mov_b32 s74, 0xffff
  v_and_b32 v6, 255, v0
  s_waitcnt lgkmcnt(12)
  v_mfma_f32_16x16x32_bf16 v[84:87], v[176:179], v[212:215], 0
  v_lshlrev_b32 v6, 4, v6
  s_cmp_eq_u32 s73, 1
  s_cbranch_scc0 L_pl_63
  buffer_load_dwordx4 v[112:115], v18, s[24:27], s59 offen sc1
  s_add_u32 s59, s59, 1024
L_pl_63:
  v_mfma_f32_16x16x32_bf16 v[84:87], v[180:183], v[208:211], v[84:87]
  s_mov_b32 s53, 118288
  v_mfma_f32_16x16x32_bf16 v[88:91], v[180:183], v[212:215], 0
  v_sub_u32 v5, s53, v6
  s_waitcnt lgkmcnt(10)
  v_mfma_f32_16x16x32_bf16 v[88:91], v[176:179], v[216:219], v[88:91]
  v_alignbit_b32 v6, v39, v39, 16
  v_mfma_f32_16x16x32_bf16 v[88:91], v[184:187], v[208:211], v[88:91]
  v_alignbit_b32 v7, v38, v38, 16
  s_cmp_eq_u32 s73, 1
  s_cbranch_scc0 L_pl_64
  buffer_load_dwordx4 v[116:119], v18, s[24:27], s59 offen sc1
  s_add_u32 s59, s59, 1024
L_pl_64:
  v_mfma_f32_16x16x32_bf16 v[92:95], v[180:183], v[216:219], 0
  v_alignbit_b32 v8, v37, v37, 16
  v_mfma_f32_16x16x32_bf16 v[92:95], v[184:187], v[212:215], v[92:95]
  v_alignbit_b32 v9, v36, v36, 16
  v_mfma_f32_16x16x32_bf16 v[96:99], v[184:187], v[216:219], 0
  v_alignbit_b32 v10, v35, v35, 16
  s_waitcnt lgkmcnt(8)
  v_mfma_f32_16x16x32_bf16 v[92:95], v[176:179], v[220:223], v[92:95]
  v_alignbit_b32 v11, v34, v34, 16
  s_cmp_eq_u32 s73, 1
  s_cbranch_scc0 L_pl_65
  buffer_load_dwordx4 v[120:123], v18, s[24:27], s59 offen sc1
  s_add_u32 s59, s59, 1024
L_pl_65:
  v_mfma_f32_16x16x32_bf16 v[92:95], v[188:191], v[208:211], v[92:95]
  ds_write_b128 v5, v[6:9] offset:0
  v_mfma_f32_16x16x32_bf16 v[96:99], v[180:183], v[220:223], v[96:99]
  ds_write_b128 v5, v[8:11] offset:16640
  v_mfma_f32_16x16x32_bf16 v[96:99], v[188:191], v[212:215], v[96:99]
  v_alignbit_b32 v6, v38, v38, 16
  v_mfma_f32_16x16x32_bf16 v[100:103], v[184:187], v[220:223], 0
  v_alignbit_b32 v7, v37, v37, 16
  s_cmp_eq_u32 s73, 1
  s_cbranch_scc0 L_pl_66
  buffer_load_dwordx4 v[124:127], v18, s[24:27], s59 offen sc1
  s_add_u32 s59, s59, 1024
L_pl_66:
  v_mfma_f32_16x16x32_bf16 v[100:103], v[188:191], v[216:219], v[100:103]
  v_alignbit_b32 v8, v36, v36, 16
  v_mfma_f32_16x16x32_bf16 v[104:107], v[188:191], v[220:223], 0
  v_alignbit_b32 v9, v35, v35, 16
  s_waitcnt lgkmcnt(8)
  v_mfma_f32_16x16x32_bf16 v[96:99], v[176:179], v[224:227], v[96:99]
  v_alignbit_b32 v10, v34, v34, 16
  v_mfma_f32_16x16x32_bf16 v[96:99], v[192:195], v[208:211], v[96:99]
  v_alignbit_b32 v11, v33, v33, 16
  ds_write_b128 v5, v[6:9] offset:8320
  v_mfma_f32_16x16x32_bf16 v[100:103], v[180:183], v[224:227], v[100:103]
  ds_write_b128 v5, v[8:11] offset:24960
  s_cmp_eq_u32 s73, 1
  s_cbranch_scc0 L_pl_67
  buffer_load_dwordx4 v[128:131], v18, s[24:27], s59 offen sc1
  s_add_u32 s59, s59, 1024
L_pl_67:
  v_mfma_f32_16x16x32_bf16 v[100:103], v[192:195], v[212:215], v[100:103]
  v_bfi_b32 v6, s74, v39, v38
  v_mfma_f32_16x16x32_bf16 v[104:107], v[184:187], v[224:227], v[104:107]
  v_bfi_b32 v7, s74, v38, v37
  v_mfma_f32_16x16x32_bf16 v[104:107], v[192:195], v[216:219], v[104:107]
  v_bfi_b32 v8, s74, v37, v36
  v_mfma_f32_16x16x32_bf16 v[108:111], v[188:191], v[224:227], 0
  v_bfi_b32 v9, s74, v36, v35
  s_cmp_eq_u32 s73, 1
  s_cbranch_scc0 L_pl_68
  buffer_load_dwordx4 v[132:135], v18, s[24:27], s59 offen sc1
  s_add_u32 s59, s59, 1024
L_pl_68:
  v_mfma_f32_16x16x32_bf16 v[108:111], v[192:195], v[220:223], v[108:111]
  v_bfi_b32 v10, s74, v35, v34
  s_waitcnt lgkmcnt(8)
  v_mfma_f32_16x16x32_bf16 v[100:103], v[176:179], v[228:231], v[100:103]
  v_bfi_b32 v11, s74, v34, v33
  v_mfma_f32_16x16x32_bf16 v[100:103], v[196:199], v[208:211], v[100:103]
  ds_write_b128 v5, v[6:9] offset:4160
  v_mfma_f32_16x16x32_bf16 v[104:107], v[180:183], v[228:231], v[104:107]
  ds_write_b128 v5, v[8:11] offset:20800
  s_cmp_eq_u32 s73, 1
  s_cbranch_scc0 L_pl_69
  buffer_load_dwordx4 v[136:139], v18, s[24:27], s59 offen sc1
  s_add_u32 s59, s59, 1024
L_pl_69:
  v_mfma_f32_16x16x32_bf16 v[104:107], v[196:199], v[212:215], v[104:107]
  v_bfi_b32 v6, s74, v38, v37
  v_mfma_f32_16x16x32_bf16 v[108:111], v[184:187], v[228:231], v[108:111]
  v_bfi_b32 v7, s74, v37, v36
  v_mfma_f32_16x16x32_bf16 v[108:111], v[196:199], v[216:219], v[108:111]
  v_bfi_b32 v8, s74, v36, v35
  s_waitcnt lgkmcnt(8)
  v_mfma_f32_16x16x32_bf16 v[104:107], v[176:179], v[232:235], v[104:107]
  v_bfi_b32 v9, s74, v35, v34
  s_cmp_eq_u32 s73, 1
  s_cbranch_scc0 L_pl_70
  buffer_load_dwordx4 v[140:143], v18, s[24:27], s59 offen sc1
  s_add_u32 s59, s59, 1024
L_pl_70:
  v_mfma_f32_16x16x32_bf16 v[104:107], v[200:203], v[208:211], v[104:107]
  v_bfi_b32 v10, s74, v34, v33
  v_mfma_f32_16x16x32_bf16 v[108:111], v[180:183], v[232:235], v[108:111]
  v_bfi_b32 v11, s74, v33, v32
  v_mfma_f32_16x16x32_bf16 v[108:111], v[200:203], v[212:215], v[108:111]
  ds_write_b128 v5, v[6:9] offset:12480
  s_waitcnt lgkmcnt(7)
  v_mfma_f32_16x16x32_bf16 v[108:111], v[176:179], v[236:239], v[108:111]
  ds_write_b128 v5, v[8:11] offset:29120
  v_mfma_f32_16x16x32_bf16 v[108:111], v[204:207], v[208:211], v[108:111]
  v_cvt_pk_bf16_f32 v80, v80, v81
  v_cvt_pk_bf16_f32 v81, v82, v83
  ds_write_b64 v52, v[80:81] offset:32768
  v_cvt_pk_bf16_f32 v84, v84, v85
  v_cvt_pk_bf16_f32 v85, v86, v87
  ds_write_b64 v52, v[84:85] offset:36864
  v_cvt_pk_bf16_f32 v88, v88, v89
  v_cvt_pk_bf16_f32 v89, v90, v91
  ds_write_b64 v52, v[88:89] offset:40960
  v_cvt_pk_bf16_f32 v92, v92, v93
  v_cvt_pk_bf16_f32 v93, v94, v95
  ds_write_b64 v52, v[92:93] offset:45056
  v_cvt_pk_bf16_f32 v96, v96, v97
  v_cvt_pk_bf16_f32 v97, v98, v99
  ds_write_b64 v52, v[96:97] offset:49152
  v_cvt_pk_bf16_f32 v100, v100, v101
  v_cvt_pk_bf16_f32 v101, v102, v103
  ds_write_b64 v52, v[100:101] offset:53248
  v_cvt_pk_bf16_f32 v104, v104, v105
  v_cvt_pk_bf16_f32 v105, v106, v107
  ds_write_b64 v52, v[104:105] offset:57344
  v_cvt_pk_bf16_f32 v108, v108, v109
  v_cvt_pk_bf16_f32 v109, v110, v111
  ds_write_b64 v52, v[108:109] offset:61440
  s_waitcnt lgkmcnt(0)
  s_barrier
  ds_read_b128 v[176:179], v50 offset:3584
  ds_read_b128 v[208:211], v51 offset:9216
  ds_read_b128 v[180:183], v50 offset:3072
  ds_read_b128 v[212:215], v51 offset:9728
  ds_read_b128 v[184:187], v50 offset:2560
  ds_read_b128 v[216:219], v51 offset:10240
  ds_read_b128 v[188:191], v50 offset:2048
  ds_read_b128 v[220:223], v51 offset:10752
  ds_read_b128 v[192:195], v50 offset:1536
  ds_read_b128 v[224:227], v51 offset:11264
  ds_read_b128 v[196:199], v50 offset:1024
  ds_read_b128 v[228:231], v51 offset:11776
  ds_read_b128 v[200:203], v50 offset:512
  ds_read_b128 v[232:235], v51 offset:12288
  ds_read_b128 v[204:207], v50 offset:0
  ds_read_b128 v[236:239], v51 offset:12800
  s_waitcnt lgkmcnt(14)
  v_mfma_f32_16x16x32_bf16 v[80:83], v[176:179], v[208:211], 0
  s_waitcnt lgkmcnt(12)
  v_mfma_f32_16x16x32_bf16 v[84:87], v[176:179], v[212:215], 0
  s_cmp_eq_u32 s73, 1
  s_cbranch_scc0 L_pl_71
  buffer_load_dwordx4 v[144:147], v18, s[24:27], s59 offen sc1
  s_add_u32 s59, s59, 1024
L_pl_71:
  v_mfma_f32_16x16x32_bf16 v[84:87], v[180:183], v[208:211], v[84:87]
  v_mfma_f32_16x16x32_bf16 v[88:91], v[180:183], v[212:215], 0
  s_waitcnt lgkmcnt(10)
  v_mfma_f32_16x16x32_bf16 v[88:91], v[176:179], v[216:219], v[88:91]
  v_mfma_f32_16x16x32_bf16 v[88:91], v[184:187], v[208:211], v[88:91]
  s_cmp_eq_u32 s73, 1
  s_cbranch_scc0 L_pl_72
  buffer_load_dwordx4 v[148:151], v18, s[24:27], s59 offen sc1
  s_add_u32 s59, s59, 1024
L_pl_72:
  v_mfma_f32_16x16x32_bf16 v[92:95], v[180:183], v[216:219], 0
  v_mfma_f32_16x16x32_bf16 v[92:95], v[184:187], v[212:215], v[92:95]
  v_mfma_f32_16x16x32_bf16 v[96:99], v[184:187], v[216:219], 0
  s_waitcnt lgkmcnt(8)
  v_mfma_f32_16x16x32_bf16 v[92:95], v[176:179], v[220:223], v[92:95]
  s_cmp_eq_u32 s73, 1
  s_cbranch_scc0 L_pl_73
  buffer_load_dwordx4 v[152:155], v18, s[24:27], s59 offen sc1
  s_add_u32 s59, s59, 1024
L_pl_73:
  v_mfma_f32_16x16x32_bf16 v[92:95], v[188:191], v[208:211], v[92:95]
  v_mfma_f32_16x16x32_bf16 v[96:99], v[180:183], v[220:223], v[96:99]
  v_mfma_f32_16x16x32_bf16 v[96:99], v[188:191], v[212:215], v[96:99]
  v_mfma_f32_16x16x32_bf16 v[100:103], v[184:187], v[220:223], 0
  s_cmp_eq_u32 s73, 1
  s_cbranch_scc0 L_pl_74
  buffer_load_dwordx4 v[156:159], v18, s[24:27], s59 offen sc1
  s_add_u32 s59, s59, 1024
L_pl_74:
  v_mfma_f32_16x16x32_bf16 v[100:103], v[188:191], v[216:219], v[100:103]
  v_mfma_f32_16x16x32_bf16 v[104:107], v[188:191], v[220:223], 0
  s_waitcnt lgkmcnt(6)
  v_mfma_f32_16x16x32_bf16 v[96:99], v[176:179], v[224:227], v[96:99]
  v_mfma_f32_16x16x32_bf16 v[96:99], v[192:195], v[208:211], v[96:99]
  v_mfma_f32_16x16x32_bf16 v[100:103], v[180:183], v[224:227], v[100:103]
  s_cmp_eq_u32 s73, 1
  s_cbranch_scc0 L_pl_75
  buffer_load_dwordx4 v[160:163], v18, s[24:27], s59 offen sc1
  s_add_u32 s59, s59, 1024
L_pl_75:
  v_mfma_f32_16x16x32_bf16 v[100:103], v[192:195], v[212:215], v[100:103]
  v_mfma_f32_16x16x32_bf16 v[104:107], v[184:187], v[224:227], v[104:107]
  v_mfma_f32_16x16x32_bf16 v[104:107], v[192:195], v[216:219], v[104:107]
  v_mfma_f32_16x16x32_bf16 v[108:111], v[188:191], v[224:227], 0
  s_cmp_eq_u32 s73, 1
  s_cbranch_scc0 L_pl_76
  buffer_load_dwordx4 v[164:167], v18, s[24:27], s59 offen sc1
  s_add_u32 s59, s59, 1024
L_pl_76:
  v_mfma_f32_16x16x32_bf16 v[108:111], v[192:195], v[220:223], v[108:111]
  s_waitcnt lgkmcnt(4)
  v_mfma_f32_16x16x32_bf16 v[100:103], v[176:179], v[228:231], v[100:103]
  v_mfma_f32_16x16x32_bf16 v[100:103], v[196:199], v[208:211], v[100:103]
  v_mfma_f32_16x16x32_bf16 v[104:107], v[180:183], v[228:231], v[104:107]
  s_cmp_eq_u32 s73, 1
  s_cbranch_scc0 L_pl_77
  buffer_load_dwordx4 v[168:171], v18, s[24:27], s59 offen sc1
  s_add_u32 s59, s59, 1024
L_pl_77:
  v_mfma_f32_16x16x32_bf16 v[104:107], v[196:199], v[212:215], v[104:107]
  v_mfma_f32_16x16x32_bf16 v[108:111], v[184:187], v[228:231], v[108:111]
  v_mfma_f32_16x16x32_bf16 v[108:111], v[196:199], v[216:219], v[108:111]
  s_waitcnt lgkmcnt(2)
  v_mfma_f32_16x16x32_bf16 v[104:107], v[176:179], v[232:235], v[104:107]
  s_cmp_eq_u32 s73, 1
  s_cbranch_scc0 L_pl_78
  buffer_load_dwordx4 v[172:175], v18, s[24:27], s59 offen sc1
  s_add_u32 s59, s59, 1024
L_pl_78:
  v_mfma_f32_16x16x32_bf16 v[104:107], v[200:203], v[208:211], v[104:107]
  v_mfma_f32_16x16x32_bf16 v[108:111], v[180:183], v[232:235], v[108:111]
  v_mfma_f32_16x16x32_bf16 v[108:111], v[200:203], v[212:215], v[108:111]
  s_waitcnt lgkmcnt(0)
  v_mfma_f32_16x16x32_bf16 v[108:111], v[176:179], v[236:239], v[108:111]
  v_mfma_f32_16x16x32_bf16 v[108:111], v[204:207], v[208:211], v[108:111]
  v_cvt_pk_bf16_f32 v80, v80, v81
  v_cvt_pk_bf16_f32 v81, v82, v83
  ds_write_b64 v52, v[80:81] offset:0
  v_cvt_pk_bf16_f32 v84, v84, v85
  v_cvt_pk_bf16_f32 v85, v86, v87
  ds_write_b64 v52, v[84:85] offset:4096
  v_cvt_pk_bf16_f32 v88, v88, v89
  v_cvt_pk_bf16_f32 v89, v90, v91
  ds_write_b64 v52, v[88:89] offset:8192
  v_cvt_pk_bf16_f32 v92, v92, v93
  v_cvt_pk_bf16_f32 v93, v94, v95
  ds_write_b64 v52, v[92:93] offset:12288
  v_cvt_pk_bf16_f32 v96, v96, v97
  v_cvt_pk_bf16_f32 v97, v98, v99
  ds_write_b64 v52, v[96:97] offset:16384
  v_cvt_pk_bf16_f32 v100, v100, v101
  v_cvt_pk_bf16_f32 v101, v102, v103
  ds_write_b64 v52, v[100:101] offset:20480
  v_cvt_pk_bf16_f32 v104, v104, v105
  v_cvt_pk_bf16_f32 v105, v106, v107
  ds_write_b64 v52, v[104:105] offset:24576
  v_cvt_pk_bf16_f32 v108, v108, v109
  v_cvt_pk_bf16_f32 v109, v110, v111
  ds_write_b64 v52, v[108:109] offset:28672
  s_waitcnt lgkmcnt(0)
  s_barrier
  s_barrier
  s_branch L_convdone
L_cvB:
  s_mov_b32 s73, 0
  s_barrier
  ds_read_b128 v[40:43], v4 offset:0
  ds_read_b128 v[44:47], v4 offset:1024
  s_add_u32 s58, s56, 4293918720
  s_waitcnt lgkmcnt(1)
  buffer_store_dwordx4 v[40:43], v19, s[24:27], s58 offen sc1
  s_add_u32 s58, s56, 4294508544
  s_waitcnt lgkmcnt(0)
  buffer_store_dwordx4 v[44:47], v19, s[24:27], s58 offen sc1
  s_nop 1
  v_lshlrev_b32 v19, 1, v54
  ds_read_b128 v[176:179], v50 offset:3584
  ds_read_b128 v[208:211], v51 offset:0
  ds_read_b128 v[180:183], v50 offset:3072
  ds_read_b128 v[212:215], v51 offset:512
  ds_read_b128 v[184:187], v50 offset:2560
  ds_read_b128 v[216:219], v51 offset:1024
  ds_read_b128 v[188:191], v50 offset:2048
  ds_read_b128 v[220:223], v51 offset:1536
  ds_read_b128 v[192:195], v50 offset:1536
  ds_read_b128 v[224:227], v51 offset:2048
  ds_read_b128 v[196:199], v50 offset:1024
  ds_read_b128 v[228:231], v51 offset:2560
  ds_read_b128 v[200:203], v50 offset:512
  ds_read_b128 v[232:235], v51 offset:3072
  ds_read_b128 v[204:207], v50 offset:0
  ds_read_b128 v[236:239], v51 offset:3584
  s_waitcnt lgkmcnt(14)
  v_mfma_f32_16x16x32_bf16 v[80:83], v[176:179], v[208:211], 0
  s_mov_b32 s74, 0xffff
  v_and_b32 v6, 255, v0
  s_waitcnt lgkmcnt(12)
  v_mfma_f32_16x16x32_bf16 v[84:87], v[176:179], v[212:215], 0
  v_lshlrev_b32 v6, 4, v6
  v_mfma_f32_16x16x32_bf16 v[84:87], v[180:183], v[208:211], v[84:87]
  s_mov_b32 s53, 17936
  v_mfma_f32_16x16x32_bf16 v[88:91], v[180:183], v[212:215], 0
  v_sub_u32 v5, s53, v6
  v_alignbit_b32 v6, v31, v31, 16
  s_waitcnt lgkmcnt(10)
  v_mfma_f32_16x16x32_bf16 v[88:91], v[176:179], v[216:219], v[88:91]
  v_alignbit_b32 v7, v30, v30, 16
  v_mfma_f32_16x16x32_bf16 v[88:91], v[184:187], v[208:211], v[88:91]
  v_alignbit_b32 v8, v29, v29, 16
  v_mfma_f32_16x16x32_bf16 v[92:95], v[180:183], v[216:219], 0
  v_alignbit_b32 v9, v28, v28, 16
  v_mfma_f32_16x16x32_bf16 v[92:95], v[184:187], v[212:215], v[92:95]
  v_alignbit_b32 v10, v27, v27, 16
  v_alignbit_b32 v11, v26, v26, 16
  v_mfma_f32_16x16x32_bf16 v[96:99], v[184:187], v[216:219], 0
  ds_write_b128 v5, v[6:9] offset:0
  s_waitcnt lgkmcnt(9)
  v_mfma_f32_16x16x32_bf16 v[92:95], v[176:179], v[220:223], v[92:95]
  ds_write_b128 v5, v[8:11] offset:16640
  v_mfma_f32_16x16x32_bf16 v[92:95], v[188:191], v[208:211], v[92:95]
  v_alignbit_b32 v6, v30, v30, 16
  v_alignbit_b32 v7, v29, v29, 16
  v_mfma_f32_16x16x32_bf16 v[96:99], v[180:183], v[220:223], v[96:99]
  v_alignbit_b32 v8, v28, v28, 16
  v_mfma_f32_16x16x32_bf16 v[96:99], v[188:191], v[212:215], v[96:99]
  v_alignbit_b32 v9, v27, v27, 16
  v_mfma_f32_16x16x32_bf16 v[100:103], v[184:187], v[220:223], 0
  v_alignbit_b32 v10, v26, v26, 16
  v_mfma_f32_16x16x32_bf16 v[100:103], v[188:191], v[216:219], v[100:103]
  v_alignbit_b32 v11, v25, v25, 16
  ds_write_b128 v5, v[6:9] offset:8320
  v_mfma_f32_16x16x32_bf16 v[104:107], v[188:191], v[220:223], 0
  ds_write_b128 v5, v[8:11] offset:24960
  s_waitcnt lgkmcnt(10)
  v_mfma_f32_16x16x32_bf16 v[96:99], v[176:179], v[224:227], v[96:99]
  v_bfi_b32 v6, s74, v31, v30
  v_mfma_f32_16x16x32_bf16 v[96:99], v[192:195], v[208:211], v[96:99]
  v_bfi_b32 v7, s74, v30, v29
  v_bfi_b32 v8, s74, v29, v28
  v_mfma_f32_16x16x32_bf16 v[100:103], v[180:183], v[224:227], v[100:103]
  v_bfi_b32 v9, s74, v28, v27
  v_mfma_f32_16x16x32_bf16 v[100:103], v[192:195], v[212:215], v[100:103]
  v_bfi_b32 v10, s74, v27, v26
  v_mfma_f32_16x16x32_bf16 v[104:107], v[184:187], v[224:227], v[104:107]
  v_bfi_b32 v11, s74, v26, v25
  v_mfma_f32_16x16x32_bf16 v[104:107], v[192:195], v[216:219], v[104:107]
  ds_write_b128 v5, v[6:9] offset:4160
  ds_write_b128 v5, v[8:11] offset:20800
  v_mfma_f32_16x16x32_bf16 v[108:111], v[188:191], v[224:227], 0
  v_bfi_b32 v6, s74, v30, v29
  v_mfma_f32_16x16x32_bf16 v[108:111], v[192:195], v[220:223], v[108:111]
  v_bfi_b32 v7, s74, v29, v28
  s_waitcnt lgkmcnt(10)
  v_mfma_f32_16x16x32_bf16 v[100:103], v[176:179], v[228:231], v[100:103]
  v_bfi_b32 v8, s74, v28, v27
  v_bfi_b32 v9, s74, v27, v26
  v_mfma_f32_16x16x32_bf16 v[100:103], v[196:199], v[208:211], v[100:103]
  v_bfi_b32 v10, s74, v26, v25
  v_mfma_f32_16x16x32_bf16 v[104:107], v[180:183], v[228:231], v[104:107]
  v_bfi_b32 v11, s74, v25, v24
  v_mfma_f32_16x16x32_bf16 v[104:107], v[196:199], v[212:215], v[104:107]
  ds_write_b128 v5, v[6:9] offset:12480
  v_mfma_f32_16x16x32_bf16 v[108:111], v[184:187], v[228:231], v[108:111]
  ds_write_b128 v5, v[8:11] offset:29120
  v_mov_b32 v6, 0
  v_mfma_f32_16x16x32_bf16 v[108:111], v[196:199], v[216:219], v[108:111]
  v_mov_b32 v7, 0
  s_waitcnt lgkmcnt(10)
  v_mfma_f32_16x16x32_bf16 v[104:107], v[176:179], v[232:235], v[104:107]
  v_mov_b32 v8, 0
  v_mfma_f32_16x16x32_bf16 v[104:107], v[200:203], v[208:211], v[104:107]
  v_mov_b32 v9, 0
  v_and_b32 v10, 7, v0
  v_mfma_f32_16x16x32_bf16 v[108:111], v[180:183], v[232:235], v[108:111]
  v_mul_u32_u24 v10, 4160, v10
  v_mfma_f32_16x16x32_bf16 v[108:111], v[200:203], v[212:215], v[108:111]
  v_add_u32 v10, 17952, v10
  s_waitcnt lgkmcnt(8)
  v_mfma_f32_16x16x32_bf16 v[108:111], v[176:179], v[236:239], v[108:111]
  ds_write_b128 v10, v[6:9]
  v_mfma_f32_16x16x32_bf16 v[108:111], v[204:207], v[208:211], v[108:111]
  v_cvt_pk_bf16_f32 v80, v80, v81
  v_cvt_pk_bf16_f32 v81, v82, v83
  ds_write_b64 v52, v[80:81] offset:0
  v_cvt_pk_bf16_f32 v84, v84, v85
  v_cvt_pk_bf16_f32 v85, v86, v87
  ds_write_b64 v52, v[84:85] offset:4096
  v_cvt_pk_bf16_f32 v88, v88, v89
  v_cvt_pk_bf16_f32 v89, v90, v91
  ds_write_b64 v52, v[88:89] offset:8192
  v_cvt_pk_bf16_f32 v92, v92, v93
  v_cvt_pk_bf16_f32 v93, v94, v95
  ds_write_b64 v52, v[92:93] offset:12288
  v_cvt_pk_bf16_f32 v96, v96, v97
  v_cvt_pk_bf16_f32 v97, v98, v99
  ds_write_b64 v52, v[96:97] offset:16384
  v_cvt_pk_bf16_f32 v100, v100, v101
  v_cvt_pk_bf16_f32 v101, v102, v103
  ds_write_b64 v52, v[100:101] offset:20480
  v_cvt_pk_bf16_f32 v104, v104, v105
  v_cvt_pk_bf16_f32 v105, v106, v107
  ds_write_b64 v52, v[104:105] offset:24576
  v_cvt_pk_bf16_f32 v108, v108, v109
  v_cvt_pk_bf16_f32 v109, v110, v111
  ds_write_b64 v52, v[108:109] offset:28672
  s_waitcnt vmcnt(0)
  s_lshl_b32 s53, s45, 7
  s_lshl_b32 s54, s46, 3
  s_add_u32 s53, s53, s54
  v_and_b32 v41, 7, v1
  v_add_u32 v41, s53, v41
  v_mul_u32_u24 v15, 1152, v41
  v_lshrrev_b32 v43, 3, v1
  v_lshlrev_b32 v43, 4, v43
  v_add_u32 v15, v15, v43
  s_mov_b32 s36, s60
  s_and_b32 s37, s61, 0xffff
  s_mov_b32 s38, 2359296
  s_mov_b32 s39, 0x20000
  s_lshl_b32 s54, s44, 7
  buffer_load_dwordx4 v[240:243], v15, s[36:39], s54 offen
  buffer_load_dwordx4 v[244:247], v15, s[36:39], 0 offen offset:1024
  buffer_load_dwordx4 v[248:251], v15, s[8:11], s54 offen sc1
  buffer_load_dwordx4 v[252:255], v15, s[8:11], 0 offen offset:1024 sc1
  s_waitcnt lgkmcnt(0)
  s_barrier
  s_lshl_b32 s54, s45, 7
  s_lshl_b32 s55, s46, 2
  s_add_u32 s54, s54, s55
  s_add_u32 s54, s54, 244523008
  v_cmp_eq_u32 vcc, 0, v0
  s_nop 1
  v_cndmask_b32 v44, v20, v0, vcc
  v_mov_b32 v45, s57
  buffer_store_dword v45, v44, s[24:27], s54 offen sc1
  ds_read_b128 v[176:179], v49 offset:3584
  ds_read_b128 v[208:211], v51 offset:4608
  ds_read_b128 v[180:183], v49 offset:3072
  ds_read_b128 v[212:215], v51 offset:5120
  ds_read_b128 v[184:187], v49 offset:2560
  ds_read_b128 v[216:219], v51 offset:5632
  ds_read_b128 v[188:191], v49 offset:2048
  ds_read_b128 v[220:223], v51 offset:6144
  ds_read_b128 v[192:195], v49 offset:1536
  ds_read_b128 v[224:227], v51 offset:6656
  ds_read_b128 v[196:199], v49 offset:1024
  ds_read_b128 v[228:231], v51 offset:7168
  ds_read_b128 v[200:203], v49 offset:512
  ds_read_b128 v[232:235], v51 offset:7680
  ds_read_b128 v[204:207], v49 offset:0
  ds_read_b128 v[236:239], v51 offset:8192
  s_waitcnt lgkmcnt(14)
  v_mfma_f32_16x16x32_bf16 v[80:83], v[176:179], v[208:211], 0
  ds_read_b64 v[56:57], v53 offset:0
  ds_read_b64 v[58:59], v53 offset:512
  ds_read_b64 v[60:61], v53 offset:1024
  ds_read_b64 v[62:63], v53 offset:1536
  ds_read_b64 v[64:65], v53 offset:2048
  s_waitcnt lgkmcnt(15)
  v_mfma_f32_16x16x32_bf16 v[84:87], v[176:179], v[212:215], 0
  ds_read_b64 v[66:67], v53 offset:2560
  ds_read_b64 v[68:69], v53 offset:3072
  ds_read_b64 v[70:71], v53 offset:3584
  ds_read_b64 v[76:77], v55 offset:0
  s_waitcnt lgkmcnt(8)
  v_lshlrev_b32 v72, 16, v56
  v_mfma_f32_16x16x32_bf16 v[84:87], v[180:183], v[208:211], v[84:87]
  v_and_b32 v73, 0xffff0000, v56
  v_lshlrev_b32 v74, 16, v57
  v_and_b32 v75, 0xffff0000, v57
  s_waitcnt lgkmcnt(7)
  v_lshlrev_b32 v78, 16, v58
  v_and_b32 v79, 0xffff0000, v58
  v_mfma_f32_16x16x32_bf16 v[88:91], v[180:183], v[212:215], 0
  v_add_f32 v72, v72, v78
  v_add_f32 v73, v73, v79
  v_lshlrev_b32 v78, 16, v59
  v_and_b32 v79, 0xffff0000, v59
  v_mfma_f32_16x16x32_bf16 v[88:91], v[176:179], v[216:219], v[88:91]
  v_add_f32 v74, v74, v78
  v_add_f32 v75, v75, v79
  s_waitcnt lgkmcnt(6)
  v_lshlrev_b32 v78, 16, v60
  v_and_b32 v79, 0xffff0000, v60
  v_add_f32 v72, v72, v78
  v_mfma_f32_16x16x32_bf16 v[88:91], v[184:187], v[208:211], v[88:91]
  v_add_f32 v73, v73, v79
  v_lshlrev_b32 v78, 16, v61
  v_and_b32 v79, 0xffff0000, v61
  v_add_f32 v74, v74, v78
  v_add_f32 v75, v75, v79
  v_mfma_f32_16x16x32_bf16 v[92:95], v[180:183], v[216:219], 0
  s_waitcnt lgkmcnt(5)
  v_lshlrev_b32 v78, 16, v62
  v_and_b32 v79, 0xffff0000, v62
  v_add_f32 v72, v72, v78
  v_add_f32 v73, v73, v79
  v_lshlrev_b32 v78, 16, v63
  v_mfma_f32_16x16x32_bf16 v[92:95], v[184:187], v[212:215], v[92:95]
  v_and_b32 v79, 0xffff0000, v63
  v_add_f32 v74, v74, v78
  v_add_f32 v75, v75, v79
  s_waitcnt lgkmcnt(4)
  v_lshlrev_b32 v78, 16, v64
  v_mfma_f32_16x16x32_bf16 v[96:99], v[184:187], v[216:219], 0
  v_and_b32 v79, 0xffff0000, v64
  v_add_f32 v72, v72, v78
  v_add_f32 v73, v73, v79
  v_lshlrev_b32 v78, 16, v65
  v_and_b32 v79, 0xffff0000, v65
  v_mfma_f32_16x16x32_bf16 v[92:95], v[176:179], v[220:223], v[92:95]
  v_add_f32 v74, v74, v78
  v_add_f32 v75, v75, v79
  s_waitcnt lgkmcnt(3)
  v_lshlrev_b32 v78, 16, v66
  v_and_b32 v79, 0xffff0000, v66
  v_add_f32 v72, v72, v78
  v_mfma_f32_16x16x32_bf16 v[92:95], v[188:191], v[208:211], v[92:95]
  v_add_f32 v73, v73, v79
  v_lshlrev_b32 v78, 16, v67
  v_and_b32 v79, 0xffff0000, v67
  v_add_f32 v74, v74, v78
  v_add_f32 v75, v75, v79
  v_mfma_f32_16x16x32_bf16 v[96:99], v[180:183], v[220:223], v[96:99]
  s_waitcnt lgkmcnt(2)
  v_lshlrev_b32 v78, 16, v68
  v_and_b32 v79, 0xffff0000, v68
  v_add_f32 v72, v72, v78
  v_add_f32 v73, v73, v79
  v_mfma_f32_16x16x32_bf16 v[96:99], v[188:191], v[212:215], v[96:99]
  v_lshlrev_b32 v78, 16, v69
  v_and_b32 v79, 0xffff0000, v69
  v_add_f32 v74, v74, v78
  v_add_f32 v75, v75, v79
  s_waitcnt lgkmcnt(1)
  v_lshlrev_b32 v78, 16, v70
  v_mfma_f32_16x16x32_bf16 v[100:103], v[184:187], v[220:223], 0
  v_and_b32 v79, 0xffff0000, v70
  v_add_f32 v72, v72, v78
  v_add_f32 v73, v73, v79
  v_lshlrev_b32 v78, 16, v71
  v_and_b32 v79, 0xffff0000, v71
  v_mfma_f32_16x16x32_bf16 v[100:103], v[188:191], v[216:219], v[100:103]
  v_add_f32 v74, v74, v78
  v_add_f32 v75, v75, v79
  v_lshlrev_b32 v48, 16, v21
  s_waitcnt lgkmcnt(0)
  v_lshlrev_b32 v78, 16, v76
  v_and_b32 v79, 0xffff0000, v76
  v_mfma_f32_16x16x32_bf16 v[104:107], v[188:191], v[220:223], 0
  v_fmac_f32 v72, v78, v48
  v_fmac_f32 v73, v79, v48
  v_lshlrev_b32 v78, 16, v77
  v_and_b32 v79, 0xffff0000, v77
  v_mfma_f32_16x16x32_bf16 v[96:99], v[176:179], v[224:227], v[96:99]
  v_fmac_f32 v74, v78, v48
  v_fmac_f32 v75, v79, v48
  v_cvt_pk_bf16_f32 v40, v72, v73
  v_mov_b32 v41, s57
  v_cvt_pk_bf16_f32 v42, v74, v75
  v_mfma_f32_16x16x32_bf16 v[96:99], v[192:195], v[208:211], v[96:99]
  v_mov_b32 v43, s57
  s_mul_i32 s53, s2, 24576
  s_add_u32 s53, s53, 247463936
  buffer_store_dwordx4 v[40:43], v19, s[24:27], s53 offen sc1
  ds_read_b64 v[56:57], v53 offset:16384
  ds_read_b64 v[58:59], v53 offset:16896
  ds_read_b64 v[60:61], v53 offset:17408
  v_mfma_f32_16x16x32_bf16 v[100:103], v[180:183], v[224:227], v[100:103]
  ds_read_b64 v[62:63], v53 offset:17920
  ds_read_b64 v[64:65], v53 offset:18432
  ds_read_b64 v[66:67], v53 offset:18944
  ds_read_b64 v[68:69], v53 offset:19456
  ds_read_b64 v[70:71], v53 offset:19968
  v_mfma_f32_16x16x32_bf16 v[100:103], v[192:195], v[212:215], v[100:103]
  ds_read_b64 v[76:77], v55 offset:2048
  s_waitcnt lgkmcnt(8)
  v_lshlrev_b32 v72, 16, v56
  v_and_b32 v73, 0xffff0000, v56
  v_lshlrev_b32 v74, 16, v57
  v_mfma_f32_16x16x32_bf16 v[104:107], v[184:187], v[224:227], v[104:107]
  v_and_b32 v75, 0xffff0000, v57
  s_waitcnt lgkmcnt(7)
  v_lshlrev_b32 v78, 16, v58
  v_and_b32 v79, 0xffff0000, v58
  v_add_f32 v72, v72, v78
  v_add_f32 v73, v73, v79
  v_mfma_f32_16x16x32_bf16 v[104:107], v[192:195], v[216:219], v[104:107]
  v_lshlrev_b32 v78, 16, v59
  v_and_b32 v79, 0xffff0000, v59
  v_add_f32 v74, v74, v78
  v_add_f32 v75, v75, v79
  s_waitcnt lgkmcnt(6)
  v_lshlrev_b32 v78, 16, v60
  v_mfma_f32_16x16x32_bf16 v[108:111], v[188:191], v[224:227], 0
  v_and_b32 v79, 0xffff0000, v60
  v_add_f32 v72, v72, v78
  v_add_f32 v73, v73, v79
  v_lshlrev_b32 v78, 16, v61
  v_and_b32 v79, 0xffff0000, v61
  v_mfma_f32_16x16x32_bf16 v[108:111], v[192:195], v[220:223], v[108:111]
  v_add_f32 v74, v74, v78
  v_add_f32 v75, v75, v79
  s_waitcnt lgkmcnt(5)
  v_lshlrev_b32 v78, 16, v62
  v_and_b32 v79, 0xffff0000, v62
  v_mfma_f32_16x16x32_bf16 v[100:103], v[176:179], v[228:231], v[100:103]
  v_add_f32 v72, v72, v78
  v_add_f32 v73, v73, v79
  v_lshlrev_b32 v78, 16, v63
  v_and_b32 v79, 0xffff0000, v63
  v_add_f32 v74, v74, v78
  v_mfma_f32_16x16x32_bf16 v[100:103], v[196:199], v[208:211], v[100:103]
  v_add_f32 v75, v75, v79
  s_waitcnt lgkmcnt(4)
  v_lshlrev_b32 v78, 16, v64
  v_and_b32 v79, 0xffff0000, v64
  v_add_f32 v72, v72, v78
  v_add_f32 v73, v73, v79
  v_mfma_f32_16x16x32_bf16 v[104:107], v[180:183], v[228:231], v[104:107]
  v_lshlrev_b32 v78, 16, v65
  v_and_b32 v79, 0xffff0000, v65
  v_add_f32 v74, v74, v78
  v_add_f32 v75, v75, v79
  s_waitcnt lgkmcnt(3)
  v_lshlrev_b32 v78, 16, v66
  v_mfma_f32_16x16x32_bf16 v[104:107], v[196:199], v[212:215], v[104:107]
  v_and_b32 v79, 0xffff0000, v66
  v_add_f32 v72, v72, v78
  v_add_f32 v73, v73, v79
  v_lshlrev_b32 v78, 16, v67
  v_mfma_f32_16x16x32_bf16 v[108:111], v[184:187], v[228:231], v[108:111]
  v_and_b32 v79, 0xffff0000, v67
  v_add_f32 v74, v74, v78
  v_add_f32 v75, v75, v79
  s_waitcnt lgkmcnt(2)
  v_lshlrev_b32 v78, 16, v68
  v_and_b32 v79, 0xffff0000, v68
  v_mfma_f32_16x16x32_bf16 v[108:111], v[196:199], v[216:219], v[108:111]
  v_add_f32 v72, v72, v78
  v_add_f32 v73, v73, v79
  v_lshlrev_b32 v78, 16, v69
  v_and_b32 v79, 0xffff0000, v69
  v_add_f32 v74, v74, v78
  v_mfma_f32_16x16x32_bf16 v[104:107], v[176:179], v[232:235], v[104:107]
  v_add_f32 v75, v75, v79
  s_waitcnt lgkmcnt(1)
  v_lshlrev_b32 v78, 16, v70
  v_and_b32 v79, 0xffff0000, v70
  v_add_f32 v72, v72, v78
  v_add_f32 v73, v73, v79
  v_mfma_f32_16x16x32_bf16 v[104:107], v[200:203], v[208:211], v[104:107]
  v_lshlrev_b32 v78, 16, v71
  v_and_b32 v79, 0xffff0000, v71
  v_add_f32 v74, v74, v78
  v_add_f32 v75, v75, v79
  v_mfma_f32_16x16x32_bf16 v[108:111], v[180:183], v[232:235], v[108:111]
  v_lshlrev_b32 v48, 16, v21
  s_waitcnt lgkmcnt(0)
  v_lshlrev_b32 v78, 16, v76
  v_and_b32 v79, 0xffff0000, v76
  v_fmac_f32 v72, v78, v48
  v_fmac_f32 v73, v79, v48
  v_mfma_f32_16x16x32_bf16 v[108:111], v[200:203], v[212:215], v[108:111]
  v_lshlrev_b32 v78, 16, v77
  v_and_b32 v79, 0xffff0000, v77
  v_fmac_f32 v74, v78, v48
  v_fmac_f32 v75, v79, v48
  v_cvt_pk_bf16_f32 v44, v72, v73
  v_mfma_f32_16x16x32_bf16 v[108:111], v[176:179], v[236:239], v[108:111]
  v_mov_b32 v45, s57
  v_cvt_pk_bf16_f32 v46, v74, v75
  v_mov_b32 v47, s57
  s_mul_i32 s53, s2, 24576
  s_add_u32 s53, s53, 247468032
  buffer_store_dwordx4 v[44:47], v19, s[24:27], s53 offen sc1
  v_mfma_f32_16x16x32_bf16 v[108:111], v[204:207], v[208:211], v[108:111]
  v_cvt_pk_bf16_f32 v80, v80, v81
  v_cvt_pk_bf16_f32 v81, v82, v83
  ds_write_b64 v52, v[80:81] offset:32768
  v_cvt_pk_bf16_f32 v84, v84, v85
  v_cvt_pk_bf16_f32 v85, v86, v87
  ds_write_b64 v52, v[84:85] offset:36864
  v_cvt_pk_bf16_f32 v88, v88, v89
  v_cvt_pk_bf16_f32 v89, v90, v91
  ds_write_b64 v52, v[88:89] offset:40960
  v_cvt_pk_bf16_f32 v92, v92, v93
  v_cvt_pk_bf16_f32 v93, v94, v95
  ds_write_b64 v52, v[92:93] offset:45056
  v_cvt_pk_bf16_f32 v96, v96, v97
  v_cvt_pk_bf16_f32 v97, v98, v99
  ds_write_b64 v52, v[96:97] offset:49152
  v_cvt_pk_bf16_f32 v100, v100, v101
  v_cvt_pk_bf16_f32 v101, v102, v103
  ds_write_b64 v52, v[100:101] offset:53248
  v_cvt_pk_bf16_f32 v104, v104, v105
  v_cvt_pk_bf16_f32 v105, v106, v107
  ds_write_b64 v52, v[104:105] offset:57344
  v_cvt_pk_bf16_f32 v108, v108, v109
  v_cvt_pk_bf16_f32 v109, v110, v111
  ds_write_b64 v52, v[108:109] offset:61440
  s_waitcnt lgkmcnt(0)
  s_barrier
  ds_read_b128 v[176:179], v50 offset:3584
  ds_read_b128 v[208:211], v51 offset:9216
  ds_read_b128 v[180:183], v50 offset:3072
  ds_read_b128 v[212:215], v51 offset:9728
  ds_read_b128 v[184:187], v50 offset:2560
  ds_read_b128 v[216:219], v51 offset:10240
  ds_read_b128 v[188:191], v50 offset:2048
  ds_read_b128 v[220:223], v51 offset:10752
  ds_read_b128 v[192:195], v50 offset:1536
  ds_read_b128 v[224:227], v51 offset:11264
  ds_read_b128 v[196:199], v50 offset:1024
  ds_read_b128 v[228:231], v51 offset:11776
  ds_read_b128 v[200:203], v50 offset:512
  ds_read_b128 v[232:235], v51 offset:12288
  ds_read_b128 v[204:207], v50 offset:0
  ds_read_b128 v[236:239], v51 offset:12800
  s_waitcnt lgkmcnt(14)
  v_mfma_f32_16x16x32_bf16 v[80:83], v[176:179], v[208:211], 0
  ds_read_b64 v[56:57], v53 offset:32768
  ds_read_b64 v[58:59], v53 offset:33280
  ds_read_b64 v[60:61], v53 offset:33792
  ds_read_b64 v[62:63], v53 offset:34304
  ds_read_b64 v[64:65], v53 offset:34816
  s_waitcnt lgkmcnt(15)
  v_mfma_f32_16x16x32_bf16 v[84:87], v[176:179], v[212:215], 0
  ds_read_b64 v[66:67], v53 offset:35328
  ds_read_b64 v[68:69], v53 offset:35840
  ds_read_b64 v[70:71], v53 offset:36352
  ds_read_b64 v[76:77], v55 offset:4608
  s_waitcnt lgkmcnt(8)
  v_lshlrev_b32 v72, 16, v56
  v_mfma_f32_16x16x32_bf16 v[84:87], v[180:183], v[208:211], v[84:87]
  v_and_b32 v73, 0xffff0000, v56
  v_lshlrev_b32 v74, 16, v57
  v_and_b32 v75, 0xffff0000, v57
  s_waitcnt lgkmcnt(7)
  v_lshlrev_b32 v78, 16, v58
  v_and_b32 v79, 0xffff0000, v58
  v_mfma_f32_16x16x32_bf16 v[88:91], v[180:183], v[212:215], 0
  v_add_f32 v72, v72, v78
  v_add_f32 v73, v73, v79
  v_lshlrev_b32 v78, 16, v59
  v_and_b32 v79, 0xffff0000, v59
  v_mfma_f32_16x16x32_bf16 v[88:91], v[176:179], v[216:219], v[88:91]
  v_add_f32 v74, v74, v78
  v_add_f32 v75, v75, v79
  s_waitcnt lgkmcnt(6)
  v_lshlrev_b32 v78, 16, v60
  v_and_b32 v79, 0xffff0000, v60
  v_add_f32 v72, v72, v78
  v_mfma_f32_16x16x32_bf16 v[88:91], v[184:187], v[208:211], v[88:91]
  v_add_f32 v73, v73, v79
  v_lshlrev_b32 v78, 16, v61
  v_and_b32 v79, 0xffff0000, v61
  v_add_f32 v74, v74, v78
  v_add_f32 v75, v75, v79
  v_mfma_f32_16x16x32_bf16 v[92:95], v[180:183], v[216:219], 0
  s_waitcnt lgkmcnt(5)
  v_lshlrev_b32 v78, 16, v62
  v_and_b32 v79, 0xffff0000, v62
  v_add_f32 v72, v72, v78
  v_add_f32 v73, v73, v79
  v_lshlrev_b32 v78, 16, v63
  v_mfma_f32_16x16x32_bf16 v[92:95], v[184:187], v[212:215], v[92:95]
  v_and_b32 v79, 0xffff0000, v63
  v_add_f32 v74, v74, v78
  v_add_f32 v75, v75, v79
  s_waitcnt lgkmcnt(4)
  v_lshlrev_b32 v78, 16, v64
  v_mfma_f32_16x16x32_bf16 v[96:99], v[184:187], v[216:219], 0
  v_and_b32 v79, 0xffff0000, v64
  v_add_f32 v72, v72, v78
  v_add_f32 v73, v73, v79
  v_lshlrev_b32 v78, 16, v65
  v_and_b32 v79, 0xffff0000, v65
  v_mfma_f32_16x16x32_bf16 v[92:95], v[176:179], v[220:223], v[92:95]
  v_add_f32 v74, v74, v78
  v_add_f32 v75, v75, v79
  s_waitcnt lgkmcnt(3)
  v_lshlrev_b32 v78, 16, v66
  v_and_b32 v79, 0xffff0000, v66
  v_add_f32 v72, v72, v78
  v_mfma_f32_16x16x32_bf16 v[92:95], v[188:191], v[208:211], v[92:95]
  v_add_f32 v73, v73, v79
  v_lshlrev_b32 v78, 16, v67
  v_and_b32 v79, 0xffff0000, v67
  v_add_f32 v74, v74, v78
  v_add_f32 v75, v75, v79
  v_mfma_f32_16x16x32_bf16 v[96:99], v[180:183], v[220:223], v[96:99]
  s_waitcnt lgkmcnt(2)
  v_lshlrev_b32 v78, 16, v68
  v_and_b32 v79, 0xffff0000, v68
  v_add_f32 v72, v72, v78
  v_add_f32 v73, v73, v79
  v_mfma_f32_16x16x32_bf16 v[96:99], v[188:191], v[212:215], v[96:99]
  v_lshlrev_b32 v78, 16, v69
  v_and_b32 v79, 0xffff0000, v69
  v_add_f32 v74, v74, v78
  v_add_f32 v75, v75, v79
  s_waitcnt lgkmcnt(1)
  v_lshlrev_b32 v78, 16, v70
  v_mfma_f32_16x16x32_bf16 v[100:103], v[184:187], v[220:223], 0
  v_and_b32 v79, 0xffff0000, v70
  v_add_f32 v72, v72, v78
  v_add_f32 v73, v73, v79
  v_lshlrev_b32 v78, 16, v71
  v_and_b32 v79, 0xffff0000, v71
  v_mfma_f32_16x16x32_bf16 v[100:103], v[188:191], v[216:219], v[100:103]
  v_add_f32 v74, v74, v78
  v_add_f32 v75, v75, v79
  v_lshlrev_b32 v48, 16, v22
  s_waitcnt lgkmcnt(0)
  v_lshlrev_b32 v78, 16, v76
  v_and_b32 v79, 0xffff0000, v76
  v_mfma_f32_16x16x32_bf16 v[104:107], v[188:191], v[220:223], 0
  v_fmac_f32 v72, v78, v48
  v_fmac_f32 v73, v79, v48
  v_lshlrev_b32 v78, 16, v77
  v_and_b32 v79, 0xffff0000, v77
  v_mfma_f32_16x16x32_bf16 v[96:99], v[176:179], v[224:227], v[96:99]
  v_fmac_f32 v74, v78, v48
  v_fmac_f32 v75, v79, v48
  v_cvt_pk_bf16_f32 v40, v72, v73
  v_mov_b32 v41, s57
  v_cvt_pk_bf16_f32 v42, v74, v75
  v_mfma_f32_16x16x32_bf16 v[96:99], v[192:195], v[208:211], v[96:99]
  v_mov_b32 v43, s57
  s_mul_i32 s53, s2, 24576
  s_add_u32 s53, s53, 247472128
  buffer_store_dwordx4 v[40:43], v19, s[24:27], s53 offen sc1
  ds_read_b64 v[56:57], v53 offset:49152
  ds_read_b64 v[58:59], v53 offset:49664
  ds_read_b64 v[60:61], v53 offset:50176
  v_mfma_f32_16x16x32_bf16 v[100:103], v[180:183], v[224:227], v[100:103]
  ds_read_b64 v[62:63], v53 offset:50688
  ds_read_b64 v[64:65], v53 offset:51200
  ds_read_b64 v[66:67], v53 offset:51712
  ds_read_b64 v[68:69], v53 offset:52224
  ds_read_b64 v[70:71], v53 offset:52736
  v_mfma_f32_16x16x32_bf16 v[100:103], v[192:195], v[212:215], v[100:103]
  ds_read_b64 v[76:77], v55 offset:6656
  s_waitcnt lgkmcnt(8)
  v_lshlrev_b32 v72, 16, v56
  v_and_b32 v73, 0xffff0000, v56
  v_lshlrev_b32 v74, 16, v57
  v_mfma_f32_16x16x32_bf16 v[104:107], v[184:187], v[224:227], v[104:107]
  v_and_b32 v75, 0xffff0000, v57
  s_waitcnt lgkmcnt(7)
  v_lshlrev_b32 v78, 16, v58
  v_and_b32 v79, 0xffff0000, v58
  v_add_f32 v72, v72, v78
  v_add_f32 v73, v73, v79
  v_mfma_f32_16x16x32_bf16 v[104:107], v[192:195], v[216:219], v[104:107]
  v_lshlrev_b32 v78, 16, v59
  v_and_b32 v79, 0xffff0000, v59
  v_add_f32 v74, v74, v78
  v_add_f32 v75, v75, v79
  s_waitcnt lgkmcnt(6)
  v_lshlrev_b32 v78, 16, v60
  v_mfma_f32_16x16x32_bf16 v[108:111], v[188:191], v[224:227], 0
  v_and_b32 v79, 0xffff0000, v60
  v_add_f32 v72, v72, v78
  v_add_f32 v73, v73, v79
  v_lshlrev_b32 v78, 16, v61
  v_and_b32 v79, 0xffff0000, v61
  v_mfma_f32_16x16x32_bf16 v[108:111], v[192:195], v[220:223], v[108:111]
  v_add_f32 v74, v74, v78
  v_add_f32 v75, v75, v79
  s_waitcnt lgkmcnt(5)
  v_lshlrev_b32 v78, 16, v62
  v_and_b32 v79, 0xffff0000, v62
  v_mfma_f32_16x16x32_bf16 v[100:103], v[176:179], v[228:231], v[100:103]
  v_add_f32 v72, v72, v78
  v_add_f32 v73, v73, v79
  v_lshlrev_b32 v78, 16, v63
  v_and_b32 v79, 0xffff0000, v63
  v_add_f32 v74, v74, v78
  v_mfma_f32_16x16x32_bf16 v[100:103], v[196:199], v[208:211], v[100:103]
  v_add_f32 v75, v75, v79
  s_waitcnt lgkmcnt(4)
  v_lshlrev_b32 v78, 16, v64
  v_and_b32 v79, 0xffff0000, v64
  v_add_f32 v72, v72, v78
  v_add_f32 v73, v73, v79
  v_mfma_f32_16x16x32_bf16 v[104:107], v[180:183], v[228:231], v[104:107]
  v_lshlrev_b32 v78, 16, v65
  v_and_b32 v79, 0xffff0000, v65
  v_add_f32 v74, v74, v78
  v_add_f32 v75, v75, v79
  s_waitcnt lgkmcnt(3)
  v_lshlrev_b32 v78, 16, v66
  v_mfma_f32_16x16x32_bf16 v[104:107], v[196:199], v[212:215], v[104:107]
  v_and_b32 v79, 0xffff0000, v66
  v_add_f32 v72, v72, v78
  v_add_f32 v73, v73, v79
  v_lshlrev_b32 v78, 16, v67
  v_mfma_f32_16x16x32_bf16 v[108:111], v[184:187], v[228:231], v[108:111]
  v_and_b32 v79, 0xffff0000, v67
  v_add_f32 v74, v74, v78
  v_add_f32 v75, v75, v79
  s_waitcnt lgkmcnt(2)
  v_lshlrev_b32 v78, 16, v68
  v_and_b32 v79, 0xffff0000, v68
  v_mfma_f32_16x16x32_bf16 v[108:111], v[196:199], v[216:219], v[108:111]
  v_add_f32 v72, v72, v78
  v_add_f32 v73, v73, v79
  v_lshlrev_b32 v78, 16, v69
  v_and_b32 v79, 0xffff0000, v69
  v_add_f32 v74, v74, v78
  v_mfma_f32_16x16x32_bf16 v[104:107], v[176:179], v[232:235], v[104:107]
  v_add_f32 v75, v75, v79
  s_waitcnt lgkmcnt(1)
  v_lshlrev_b32 v78, 16, v70
  v_and_b32 v79, 0xffff0000, v70
  v_add_f32 v72, v72, v78
  v_add_f32 v73, v73, v79
  v_mfma_f32_16x16x32_bf16 v[104:107], v[200:203], v[208:211], v[104:107]
  v_lshlrev_b32 v78, 16, v71
  v_and_b32 v79, 0xffff0000, v71
  v_add_f32 v74, v74, v78
  v_add_f32 v75, v75, v79
  v_mfma_f32_16x16x32_bf16 v[108:111], v[180:183], v[232:235], v[108:111]
  v_lshlrev_b32 v48, 16, v22
  s_waitcnt lgkmcnt(0)
  v_lshlrev_b32 v78, 16, v76
  v_and_b32 v79, 0xffff0000, v76
  v_fmac_f32 v72, v78, v48
  v_fmac_f32 v73, v79, v48
  v_mfma_f32_16x16x32_bf16 v[108:111], v[200:203], v[212:215], v[108:111]
  v_lshlrev_b32 v78, 16, v77
  v_and_b32 v79, 0xffff0000, v77
  v_fmac_f32 v74, v78, v48
  v_fmac_f32 v75, v79, v48
  v_cvt_pk_bf16_f32 v44, v72, v73
  v_mfma_f32_16x16x32_bf16 v[108:111], v[176:179], v[236:239], v[108:111]
  v_mov_b32 v45, s57
  v_cvt_pk_bf16_f32 v46, v74, v75
  v_mov_b32 v47, s57
  s_mul_i32 s53, s2, 24576
  s_add_u32 s53, s53, 247476224
  buffer_store_dwordx4 v[44:47], v19, s[24:27], s53 offen sc1
  v_mfma_f32_16x16x32_bf16 v[108:111], v[204:207], v[208:211], v[108:111]
  v_cvt_pk_bf16_f32 v80, v80, v81
  v_cvt_pk_bf16_f32 v81, v82, v83
  ds_write_b64 v52, v[80:81] offset:0
  v_cvt_pk_bf16_f32 v84, v84, v85
  v_cvt_pk_bf16_f32 v85, v86, v87
  ds_write_b64 v52, v[84:85] offset:4096
  v_cvt_pk_bf16_f32 v88, v88, v89
  v_cvt_pk_bf16_f32 v89, v90, v91
  ds_write_b64 v52, v[88:89] offset:8192
  v_cvt_pk_bf16_f32 v92, v92, v93
  v_cvt_pk_bf16_f32 v93, v94, v95
  ds_write_b64 v52, v[92:93] offset:12288
  v_cvt_pk_bf16_f32 v96, v96, v97
  v_cvt_pk_bf16_f32 v97, v98, v99
  ds_write_b64 v52, v[96:97] offset:16384
  v_cvt_pk_bf16_f32 v100, v100, v101
  v_cvt_pk_bf16_f32 v101, v102, v103
  ds_write_b64 v52, v[100:101] offset:20480
  v_cvt_pk_bf16_f32 v104, v104, v105
  v_cvt_pk_bf16_f32 v105, v106, v107
  ds_write_b64 v52, v[104:105] offset:24576
  v_cvt_pk_bf16_f32 v108, v108, v109
  v_cvt_pk_bf16_f32 v109, v110, v111
  ds_write_b64 v52, v[108:109] offset:28672
  s_waitcnt lgkmcnt(0)
  s_barrier
  ds_read_b64 v[56:57], v53 offset:0
  ds_read_b64 v[58:59], v53 offset:512
  ds_read_b64 v[60:61], v53 offset:1024
  ds_read_b64 v[62:63], v53 offset:1536
  ds_read_b64 v[64:65], v53 offset:2048
  ds_read_b64 v[66:67], v53 offset:2560
  ds_read_b64 v[68:69], v53 offset:3072
  ds_read_b64 v[70:71], v53 offset:3584
  ds_read_b64 v[76:77], v55 offset:9216
  s_waitcnt lgkmcnt(8)
  v_lshlrev_b32 v72, 16, v56
  v_and_b32 v73, 0xffff0000, v56
  v_lshlrev_b32 v74, 16, v57
  v_and_b32 v75, 0xffff0000, v57
  s_waitcnt lgkmcnt(7)
  v_lshlrev_b32 v78, 16, v58
  v_and_b32 v79, 0xffff0000, v58
  v_add_f32 v72, v72, v78
  v_add_f32 v73, v73, v79
  v_lshlrev_b32 v78, 16, v59
  v_and_b32 v79, 0xffff0000, v59
  v_add_f32 v74, v74, v78
  v_add_f32 v75, v75, v79
  s_waitcnt lgkmcnt(6)
  v_lshlrev_b32 v78, 16, v60
  v_and_b32 v79, 0xffff0000, v60
  v_add_f32 v72, v72, v78
  v_add_f32 v73, v73, v79
  v_lshlrev_b32 v78, 16, v61
  v_and_b32 v79, 0xffff0000, v61
  v_add_f32 v74, v74, v78
  v_add_f32 v75, v75, v79
  s_waitcnt lgkmcnt(5)
  v_lshlrev_b32 v78, 16, v62
  v_and_b32 v79, 0xffff0000, v62
  v_add_f32 v72, v72, v78
  v_add_f32 v73, v73, v79
  v_lshlrev_b32 v78, 16, v63
  v_and_b32 v79, 0xffff0000, v63
  v_add_f32 v74, v74, v78
  v_add_f32 v75, v75, v79
  s_waitcnt lgkmcnt(4)
  v_lshlrev_b32 v78, 16, v64
  v_and_b32 v79, 0xffff0000, v64
  v_add_f32 v72, v72, v78
  v_add_f32 v73, v73, v79
  v_lshlrev_b32 v78, 16, v65
  v_and_b32 v79, 0xffff0000, v65
  v_add_f32 v74, v74, v78
  v_add_f32 v75, v75, v79
  s_waitcnt lgkmcnt(3)
  v_lshlrev_b32 v78, 16, v66
  v_and_b32 v79, 0xffff0000, v66
  v_add_f32 v72, v72, v78
  v_add_f32 v73, v73, v79
  v_lshlrev_b32 v78, 16, v67
  v_and_b32 v79, 0xffff0000, v67
  v_add_f32 v74, v74, v78
  v_add_f32 v75, v75, v79
  s_waitcnt lgkmcnt(2)
  v_lshlrev_b32 v78, 16, v68
  v_and_b32 v79, 0xffff0000, v68
  v_add_f32 v72, v72, v78
  v_add_f32 v73, v73, v79
  v_lshlrev_b32 v78, 16, v69
  v_and_b32 v79, 0xffff0000, v69
  v_add_f32 v74, v74, v78
  v_add_f32 v75, v75, v79
  s_waitcnt lgkmcnt(1)
  v_lshlrev_b32 v78, 16, v70
  v_and_b32 v79, 0xffff0000, v70
  v_add_f32 v72, v72, v78
  v_add_f32 v73, v73, v79
  v_lshlrev_b32 v78, 16, v71
  v_and_b32 v79, 0xffff0000, v71
  v_add_f32 v74, v74, v78
  v_add_f32 v75, v75, v79
  v_lshlrev_b32 v48, 16, v23
  s_waitcnt lgkmcnt(0)
  v_lshlrev_b32 v78, 16, v76
  v_and_b32 v79, 0xffff0000, v76
  v_fmac_f32 v72, v78, v48
  v_fmac_f32 v73, v79, v48
  v_lshlrev_b32 v78, 16, v77
  v_and_b32 v79, 0xffff0000, v77
  v_fmac_f32 v74, v78, v48
  v_fmac_f32 v75, v79, v48
  v_cvt_pk_bf16_f32 v40, v72, v73
  v_mov_b32 v41, s57
  v_cvt_pk_bf16_f32 v42, v74, v75
  v_mov_b32 v43, s57
  s_mul_i32 s53, s2, 24576
  s_add_u32 s53, s53, 247480320
  buffer_store_dwordx4 v[40:43], v19, s[24:27], s53 offen sc1
  ds_read_b64 v[56:57], v53 offset:16384
  ds_read_b64 v[58:59], v53 offset:16896
  ds_read_b64 v[60:61], v53 offset:17408
  ds_read_b64 v[62:63], v53 offset:17920
  ds_read_b64 v[64:65], v53 offset:18432
  ds_read_b64 v[66:67], v53 offset:18944
  ds_read_b64 v[68:69], v53 offset:19456
  ds_read_b64 v[70:71], v53 offset:19968
  ds_read_b64 v[76:77], v55 offset:11264
  s_waitcnt lgkmcnt(8)
  v_lshlrev_b32 v72, 16, v56
  v_and_b32 v73, 0xffff0000, v56
  v_lshlrev_b32 v74, 16, v57
  v_and_b32 v75, 0xffff0000, v57
  s_waitcnt lgkmcnt(7)
  v_lshlrev_b32 v78, 16, v58
  v_and_b32 v79, 0xffff0000, v58
  v_add_f32 v72, v72, v78
  v_add_f32 v73, v73, v79
  v_lshlrev_b32 v78, 16, v59
  v_and_b32 v79, 0xffff0000, v59
  v_add_f32 v74, v74, v78
  v_add_f32 v75, v75, v79
  s_waitcnt lgkmcnt(6)
  v_lshlrev_b32 v78, 16, v60
  v_and_b32 v79, 0xffff0000, v60
  v_add_f32 v72, v72, v78
  v_add_f32 v73, v73, v79
  v_lshlrev_b32 v78, 16, v61
  v_and_b32 v79, 0xffff0000, v61
  v_add_f32 v74, v74, v78
  v_add_f32 v75, v75, v79
  s_waitcnt lgkmcnt(5)
  v_lshlrev_b32 v78, 16, v62
  v_and_b32 v79, 0xffff0000, v62
  v_add_f32 v72, v72, v78
  v_add_f32 v73, v73, v79
  v_lshlrev_b32 v78, 16, v63
  v_and_b32 v79, 0xffff0000, v63
  v_add_f32 v74, v74, v78
  v_add_f32 v75, v75, v79
  s_waitcnt lgkmcnt(4)
  v_lshlrev_b32 v78, 16, v64
  v_and_b32 v79, 0xffff0000, v64
  v_add_f32 v72, v72, v78
  v_add_f32 v73, v73, v79
  v_lshlrev_b32 v78, 16, v65
  v_and_b32 v79, 0xffff0000, v65
  v_add_f32 v74, v74, v78
  v_add_f32 v75, v75, v79
  s_waitcnt lgkmcnt(3)
  v_lshlrev_b32 v78, 16, v66
  v_and_b32 v79, 0xffff0000, v66
  v_add_f32 v72, v72, v78
  v_add_f32 v73, v73, v79
  v_lshlrev_b32 v78, 16, v67
  v_and_b32 v79, 0xffff0000, v67
  v_add_f32 v74, v74, v78
  v_add_f32 v75, v75, v79
  s_waitcnt lgkmcnt(2)
  v_lshlrev_b32 v78, 16, v68
  v_and_b32 v79, 0xffff0000, v68
  v_add_f32 v72, v72, v78
  v_add_f32 v73, v73, v79
  v_lshlrev_b32 v78, 16, v69
  v_and_b32 v79, 0xffff0000, v69
  v_add_f32 v74, v74, v78
  v_add_f32 v75, v75, v79
  s_waitcnt lgkmcnt(1)
  v_lshlrev_b32 v78, 16, v70
  v_and_b32 v79, 0xffff0000, v70
  v_add_f32 v72, v72, v78
  v_add_f32 v73, v73, v79
  v_lshlrev_b32 v78, 16, v71
  v_and_b32 v79, 0xffff0000, v71
  v_add_f32 v74, v74, v78
  v_add_f32 v75, v75, v79
  v_lshlrev_b32 v48, 16, v23
  s_waitcnt lgkmcnt(0)
  v_lshlrev_b32 v78, 16, v76
  v_and_b32 v79, 0xffff0000, v76
  v_fmac_f32 v72, v78, v48
  v_fmac_f32 v73, v79, v48
  v_lshlrev_b32 v78, 16, v77
  v_and_b32 v79, 0xffff0000, v77
  v_fmac_f32 v74, v78, v48
  v_fmac_f32 v75, v79, v48
  v_cvt_pk_bf16_f32 v44, v72, v73
  v_mov_b32 v45, s57
  v_cvt_pk_bf16_f32 v46, v74, v75
  v_mov_b32 v47, s57
  s_mul_i32 s53, s2, 24576
  s_add_u32 s53, s53, 247484416
  buffer_store_dwordx4 v[44:47], v19, s[24:27], s53 offen sc1
  s_lshl_b32 s54, s2, 2
  s_add_u32 s54, s54, 244527104
  v_cmp_eq_u32 vcc, 256, v0
  v_mov_b32 v48, 0
  s_nop 0
  v_cndmask_b32 v48, v20, v48, vcc
  v_mov_b32 v49, s57
  buffer_store_dword v49, v48, s[24:27], s54 offen sc1
  s_barrier
  s_branch L_convdone
L_noconv:
  s_mov_b32 s73, 0
  s_barrier
  s_cmp_lt_u32 s44, 4
  s_cbranch_scc1 L_ncA
  ds_read_b128 v[40:43], v4 offset:0
  ds_read_b128 v[44:47], v4 offset:1024
  s_waitcnt lgkmcnt(0)
  s_add_u32 s58, s56, 4293918720
  buffer_store_dwordx4 v[40:43], v19, s[24:27], s58 offen sc1
  s_add_u32 s58, s56, 4294508544
  buffer_store_dwordx4 v[44:47], v19, s[24:27], s58 offen sc1
L_ncA:
  s_lshl_b32 s53, s45, 7
  s_lshl_b32 s54, s46, 3
  s_add_u32 s53, s53, s54
  v_and_b32 v41, 7, v1
  v_add_u32 v41, s53, v41
  v_mul_u32_u24 v15, 1152, v41
  v_lshrrev_b32 v43, 3, v1
  v_lshlrev_b32 v43, 4, v43
  v_add_u32 v15, v15, v43
  s_mov_b32 s36, s60
  s_and_b32 s37, s61, 0xffff
  s_mov_b32 s38, 2359296
  s_mov_b32 s39, 0x20000
  s_lshl_b32 s54, s44, 7
  buffer_load_dwordx4 v[240:243], v15, s[36:39], s54 offen
  buffer_load_dwordx4 v[244:247], v15, s[36:39], 0 offen offset:1024
  buffer_load_dwordx4 v[248:251], v15, s[8:11], s54 offen sc1
  buffer_load_dwordx4 v[252:255], v15, s[8:11], 0 offen offset:1024 sc1
  s_waitcnt vmcnt(0)
  s_barrier
  s_lshl_b32 s54, s45, 7
  s_lshl_b32 s55, s46, 2
  s_add_u32 s54, s54, s55
  s_add_u32 s54, s54, 244523008
  v_cmp_eq_u32 vcc, 0, v0
  s_nop 1
  v_cndmask_b32 v44, v20, v0, vcc
  v_mov_b32 v45, s57
  buffer_store_dword v45, v44, s[24:27], s54 offen sc1
L_convdone:
  s_cmp_ge_u32 s44, 4
  s_cbranch_scc1 L_finB
  s_cmp_eq_u32 s73, 1
  s_cbranch_scc1 L_got_79
  s_lshl_b32 s54, s45, 7
  s_add_u32 s53, s54, 244514816
  v_lshlrev_b32 v44, 2, v2
  s_mov_b32 s5, 0x20000
L_fl_80:
  buffer_load_dword v45, v44, s[24:27], s53 offen sc1
  s_waitcnt vmcnt(0)
  v_xor_b32 v45, s57, v45
  v_cmp_ne_u32 vcc, 0, v45
  s_nop 4
  s_sub_u32 s5, s5, 1
  s_cmp_eq_u32 s5, 0
  s_cbranch_scc1 L_fld_81
  s_cmp_eq_u64 vcc, 0
  s_cbranch_scc1 L_fld_81
  s_sleep 2
  s_branch L_fl_80
L_fld_81:
  s_mov_b32 s73, 2
  s_cmp_eq_u32 s73, 2
  s_cbranch_scc0 L_pl_82
  buffer_load_dwordx4 v[112:115], v18, s[24:27], s59 offen sc1
  s_add_u32 s59, s59, 1024
L_pl_82:
  s_cmp_eq_u32 s73, 2
  s_cbranch_scc0 L_pl_83
  buffer_load_dwordx4 v[116:119], v18, s[24:27], s59 offen sc1
  s_add_u32 s59, s59, 1024
L_pl_83:
  s_cmp_eq_u32 s73, 2
  s_cbranch_scc0 L_pl_84
  buffer_load_dwordx4 v[120:123], v18, s[24:27], s59 offen sc1
  s_add_u32 s59, s59, 1024
L_pl_84:
  s_cmp_eq_u32 s73, 2
  s_cbranch_scc0 L_pl_85
  buffer_load_dwordx4 v[124:127], v18, s[24:27], s59 offen sc1
  s_add_u32 s59, s59, 1024
L_pl_85:
  s_cmp_eq_u32 s73, 2
  s_cbranch_scc0 L_pl_86
  buffer_load_dwordx4 v[128:131], v18, s[24:27], s59 offen sc1
  s_add_u32 s59, s59, 1024
L_pl_86:
  s_cmp_eq_u32 s73, 2
  s_cbranch_scc0 L_pl_87
  buffer_load_dwordx4 v[132:135], v18, s[24:27], s59 offen sc1
  s_add_u32 s59, s59, 1024
L_pl_87:
  s_cmp_eq_u32 s73, 2
  s_cbranch_scc0 L_pl_88
  buffer_load_dwordx4 v[136:139], v18, s[24:27], s59 offen sc1
  s_add_u32 s59, s59, 1024
L_pl_88:
  s_cmp_eq_u32 s73, 2
  s_cbranch_scc0 L_pl_89
  buffer_load_dwordx4 v[140:143], v18, s[24:27], s59 offen sc1
  s_add_u32 s59, s59, 1024
L_pl_89:
  s_cmp_eq_u32 s73, 2
  s_cbranch_scc0 L_pl_90
  buffer_load_dwordx4 v[144:147], v18, s[24:27], s59 offen sc1
  s_add_u32 s59, s59, 1024
L_pl_90:
  s_cmp_eq_u32 s73, 2
  s_cbranch_scc0 L_pl_91
  buffer_load_dwordx4 v[148:151], v18, s[24:27], s59 offen sc1
  s_add_u32 s59, s59, 1024
L_pl_91:
  s_cmp_eq_u32 s73, 2
  s_cbranch_scc0 L_pl_92
  buffer_load_dwordx4 v[152:155], v18, s[24:27], s59 offen sc1
  s_add_u32 s59, s59, 1024
L_pl_92:
  s_cmp_eq_u32 s73, 2
  s_cbranch_scc0 L_pl_93
  buffer_load_dwordx4 v[156:159], v18, s[24:27], s59 offen sc1
  s_add_u32 s59, s59, 1024
L_pl_93:
  s_cmp_eq_u32 s73, 2
  s_cbranch_scc0 L_pl_94
  buffer_load_dwordx4 v[160:163], v18, s[24:27], s59 offen sc1
  s_add_u32 s59, s59, 1024
L_pl_94:
  s_cmp_eq_u32 s73, 2
  s_cbranch_scc0 L_pl_95
  buffer_load_dwordx4 v[164:167], v18, s[24:27], s59 offen sc1
  s_add_u32 s59, s59, 1024
L_pl_95:
  s_cmp_eq_u32 s73, 2
  s_cbranch_scc0 L_pl_96
  buffer_load_dwordx4 v[168:171], v18, s[24:27], s59 offen sc1
  s_add_u32 s59, s59, 1024
L_pl_96:
  s_cmp_eq_u32 s73, 2
  s_cbranch_scc0 L_pl_97
  buffer_load_dwordx4 v[172:175], v18, s[24:27], s59 offen sc1
  s_add_u32 s59, s59, 1024
L_pl_97:
L_got_79:
  s_lshl_b32 s54, s45, 7
  s_add_u32 s53, s54, 244523008
  v_lshlrev_b32 v44, 2, v2
  s_mov_b32 s5, 0x20000
L_fl_98:
  buffer_load_dword v45, v44, s[24:27], s53 offen sc1
  s_waitcnt vmcnt(0)
  v_xor_b32 v45, s57, v45
  v_cmp_ne_u32 vcc, 0, v45
  s_nop 4
  s_sub_u32 s5, s5, 1
  s_cmp_eq_u32 s5, 0
  s_cbranch_scc1 L_fld_99
  s_cmp_eq_u64 vcc, 0
  s_cbranch_scc1 L_fld_99
  s_sleep 2
  s_branch L_fl_98
L_fld_99:
  s_lshl_b32 s53, s45, 4
  s_add_u32 s53, s53, s46
  s_mul_i32 s53, s53, 147456
  s_lshl_b32 s54, s44, 11
  s_add_u32 s53, s53, s54
  s_add_u32 s53, s53, 201457664
  buffer_load_dwordx4 v[176:179], v18, s[24:27], s53 offen sc1
  s_add_u32 s53, s53, 1024
  buffer_load_dwordx4 v[180:183], v18, s[24:27], s53 offen sc1
  v_mov_b32 v44, 0x3f80
  v_mov_b32 v45, 0x3f800000
  v_mov_b32 v200, 0
  v_mov_b32 v208, 0
  v_mov_b32 v201, 0
  v_mov_b32 v209, 0
  v_mov_b32 v202, 0
  v_mov_b32 v210, 0
  v_mov_b32 v203, 0
  v_mov_b32 v211, 0
  v_mov_b32 v204, 0
  v_mov_b32 v212, 0
  v_mov_b32 v205, 0
  v_mov_b32 v213, 0
  v_mov_b32 v206, 0
  v_mov_b32 v214, 0
  v_mov_b32 v207, 0
  v_mov_b32 v215, 0
  s_waitcnt vmcnt(2)
  v_dot2_f32_bf16 v200, v112, v44, v200
  v_dot2_f32_bf16 v201, v112, v45, v201
  v_dot2_f32_bf16 v202, v113, v44, v202
  v_dot2_f32_bf16 v203, v113, v45, v203
  v_dot2_f32_bf16 v204, v114, v44, v204
  v_dot2_f32_bf16 v205, v114, v45, v205
  v_dot2_f32_bf16 v206, v115, v44, v206
  v_dot2_f32_bf16 v207, v115, v45, v207
  v_dot2_f32_bf16 v200, v116, v44, v200
  v_dot2_f32_bf16 v201, v116, v45, v201
  v_dot2_f32_bf16 v202, v117, v44, v202
  v_dot2_f32_bf16 v203, v117, v45, v203
  v_dot2_f32_bf16 v204, v118, v44, v204
  v_dot2_f32_bf16 v205, v118, v45, v205
  v_dot2_f32_bf16 v206, v119, v44, v206
  v_dot2_f32_bf16 v207, v119, v45, v207
  v_dot2_f32_bf16 v200, v120, v44, v200
  v_dot2_f32_bf16 v201, v120, v45, v201
  v_dot2_f32_bf16 v202, v121, v44, v202
  v_dot2_f32_bf16 v203, v121, v45, v203
  v_dot2_f32_bf16 v204, v122, v44, v204
  v_dot2_f32_bf16 v205, v122, v45, v205
  v_dot2_f32_bf16 v206, v123, v44, v206
  v_dot2_f32_bf16 v207, v123, v45, v207
  v_dot2_f32_bf16 v200, v124, v44, v200
  v_dot2_f32_bf16 v201, v124, v45, v201
  v_dot2_f32_bf16 v202, v125, v44, v202
  v_dot2_f32_bf16 v203, v125, v45, v203
  v_dot2_f32_bf16 v204, v126, v44, v204
  v_dot2_f32_bf16 v205, v126, v45, v205
  v_dot2_f32_bf16 v206, v127, v44, v206
  v_dot2_f32_bf16 v207, v127, v45, v207
  v_dot2_f32_bf16 v200, v128, v44, v200
  v_dot2_f32_bf16 v201, v128, v45, v201
  v_dot2_f32_bf16 v202, v129, v44, v202
  v_dot2_f32_bf16 v203, v129, v45, v203
  v_dot2_f32_bf16 v204, v130, v44, v204
  v_dot2_f32_bf16 v205, v130, v45, v205
  v_dot2_f32_bf16 v206, v131, v44, v206
  v_dot2_f32_bf16 v207, v131, v45, v207
  v_dot2_f32_bf16 v200, v132, v44, v200
  v_dot2_f32_bf16 v201, v132, v45, v201
  v_dot2_f32_bf16 v202, v133, v44, v202
  v_dot2_f32_bf16 v203, v133, v45, v203
  v_dot2_f32_bf16 v204, v134, v44, v204
  v_dot2_f32_bf16 v205, v134, v45, v205
  v_dot2_f32_bf16 v206, v135, v44, v206
  v_dot2_f32_bf16 v207, v135, v45, v207
  v_dot2_f32_bf16 v200, v136, v44, v200
  v_dot2_f32_bf16 v201, v136, v45, v201
  v_dot2_f32_bf16 v202, v137, v44, v202
  v_dot2_f32_bf16 v203, v137, v45, v203
  v_dot2_f32_bf16 v204, v138, v44, v204
  v_dot2_f32_bf16 v205, v138, v45, v205
  v_dot2_f32_bf16 v206, v139, v44, v206
  v_dot2_f32_bf16 v207, v139, v45, v207
  v_dot2_f32_bf16 v200, v140, v44, v200
  v_dot2_f32_bf16 v201, v140, v45, v201
  v_dot2_f32_bf16 v202, v141, v44, v202
  v_dot2_f32_bf16 v203, v141, v45, v203
  v_dot2_f32_bf16 v204, v142, v44, v204
  v_dot2_f32_bf16 v205, v142, v45, v205
  v_dot2_f32_bf16 v206, v143, v44, v206
  v_dot2_f32_bf16 v207, v143, v45, v207
  v_dot2_f32_bf16 v200, v144, v44, v200
  v_dot2_f32_bf16 v201, v144, v45, v201
  v_dot2_f32_bf16 v202, v145, v44, v202
  v_dot2_f32_bf16 v203, v145, v45, v203
  v_dot2_f32_bf16 v204, v146, v44, v204
  v_dot2_f32_bf16 v205, v146, v45, v205
  v_dot2_f32_bf16 v206, v147, v44, v206
  v_dot2_f32_bf16 v207, v147, v45, v207
  v_dot2_f32_bf16 v200, v148, v44, v200
  v_dot2_f32_bf16 v201, v148, v45, v201
  v_dot2_f32_bf16 v202, v149, v44, v202
  v_dot2_f32_bf16 v203, v149, v45, v203
  v_dot2_f32_bf16 v204, v150, v44, v204
  v_dot2_f32_bf16 v205, v150, v45, v205
  v_dot2_f32_bf16 v206, v151, v44, v206
  v_dot2_f32_bf16 v207, v151, v45, v207
  v_dot2_f32_bf16 v200, v152, v44, v200
  v_dot2_f32_bf16 v201, v152, v45, v201
  v_dot2_f32_bf16 v202, v153, v44, v202
  v_dot2_f32_bf16 v203, v153, v45, v203
  v_dot2_f32_bf16 v204, v154, v44, v204
  v_dot2_f32_bf16 v205, v154, v45, v205
  v_dot2_f32_bf16 v206, v155, v44, v206
  v_dot2_f32_bf16 v207, v155, v45, v207
  v_dot2_f32_bf16 v200, v156, v44, v200
  v_dot2_f32_bf16 v201, v156, v45, v201
  v_dot2_f32_bf16 v202, v157, v44, v202
  v_dot2_f32_bf16 v203, v157, v45, v203
  v_dot2_f32_bf16 v204, v158, v44, v204
  v_dot2_f32_bf16 v205, v158, v45, v205
  v_dot2_f32_bf16 v206, v159, v44, v206
  v_dot2_f32_bf16 v207, v159, v45, v207
  v_dot2_f32_bf16 v200, v160, v44, v200
  v_dot2_f32_bf16 v201, v160, v45, v201
  v_dot2_f32_bf16 v202, v161, v44, v202
  v_dot2_f32_bf16 v203, v161, v45, v203
  v_dot2_f32_bf16 v204, v162, v44, v204
  v_dot2_f32_bf16 v205, v162, v45, v205
  v_dot2_f32_bf16 v206, v163, v44, v206
  v_dot2_f32_bf16 v207, v163, v45, v207
  v_dot2_f32_bf16 v200, v164, v44, v200
  v_dot2_f32_bf16 v201, v164, v45, v201
  v_dot2_f32_bf16 v202, v165, v44, v202
  v_dot2_f32_bf16 v203, v165, v45, v203
  v_dot2_f32_bf16 v204, v166, v44, v204
  v_dot2_f32_bf16 v205, v166, v45, v205
  v_dot2_f32_bf16 v206, v167, v44, v206
  v_dot2_f32_bf16 v207, v167, v45, v207
  v_dot2_f32_bf16 v200, v168, v44, v200
  v_dot2_f32_bf16 v201, v168, v45, v201
  v_dot2_f32_bf16 v202, v169, v44, v202
  v_dot2_f32_bf16 v203, v169, v45, v203
  v_dot2_f32_bf16 v204, v170, v44, v204
  v_dot2_f32_bf16 v205, v170, v45, v205
  v_dot2_f32_bf16 v206, v171, v44, v206
  v_dot2_f32_bf16 v207, v171, v45, v207
  v_dot2_f32_bf16 v200, v172, v44, v200
  v_dot2_f32_bf16 v201, v172, v45, v201
  v_dot2_f32_bf16 v202, v173, v44, v202
  v_dot2_f32_bf16 v203, v173, v45, v203
  v_dot2_f32_bf16 v204, v174, v44, v204
  v_dot2_f32_bf16 v205, v174, v45, v205
  v_dot2_f32_bf16 v206, v175, v44, v206
  v_dot2_f32_bf16 v207, v175, v45, v207
  s_lshl_b32 s59, s45, 7
  s_lshl_b32 s54, s46, 3
  s_add_u32 s59, s59, s54
  s_lshl_b32 s59, s59, 2
  s_add_u32 s59, s59, 247463936
  v_lshlrev_b32 v55, 13, v1
  s_lshl_b32 s54, s44, 20
  s_add_u32 s58, s54, s59
  s_add_u32 s7, s58, 524288
  s_add_u32 s59, s59, 4194304
  s_cmp_eq_u32 s44, 0
  s_cselect_b32 s55, 0, 0x80000000
  s_cselect_b32 s6, 0, 1024
  v_add_u32 v62, s55, v55
  v_lshlrev_b32 v56, 4, v1
  s_lshl_b32 s54, s44, 11
  v_add_u32 v56, s54, v56
  v_add_u32 v56, 33280, v56
  v_lshlrev_b32 v57, 4, v1
  v_add_u32 v57, s6, v57
  v_add_u32 v57, 41472, v57
  v_lshlrev_b32 v58, 2, v1
  v_add_u32 v59, 256, v58
  v_add_u32 v60, 512, v58
  s_mov_b32 s53, 244527104
  s_waitcnt vmcnt(0)
  v_dot2_f32_bf16 v208, v176, v44, v208
  v_dot2_f32_bf16 v209, v176, v45, v209
  v_dot2_f32_bf16 v210, v177, v44, v210
  v_dot2_f32_bf16 v211, v177, v45, v211
  v_dot2_f32_bf16 v212, v178, v44, v212
  v_dot2_f32_bf16 v213, v178, v45, v213
  v_dot2_f32_bf16 v214, v179, v44, v214
  v_dot2_f32_bf16 v215, v179, v45, v215
  v_dot2_f32_bf16 v208, v180, v44, v208
  v_dot2_f32_bf16 v209, v180, v45, v209
  v_dot2_f32_bf16 v210, v181, v44, v210
  v_dot2_f32_bf16 v211, v181, v45, v211
  v_dot2_f32_bf16 v212, v182, v44, v212
  v_dot2_f32_bf16 v213, v182, v45, v213
  v_dot2_f32_bf16 v214, v183, v44, v214
  v_dot2_f32_bf16 v215, v183, v45, v215
  v_lshlrev_b32 v46, 5, v1
  s_lshl_b32 s54, s44, 11
  v_add_u32 v46, s54, v46
  v_add_u32 v46, 0, v46
  ds_write_b128 v46, v[208:211]
  ds_write_b128 v46, v[212:215] offset:16
  s_mov_b32 s5, 0x20000
L_fl_100:
  buffer_load_dword v61, v58, s[24:27], s53 offen sc1
  buffer_load_dword v63, v59, s[24:27], s53 offen sc1
  buffer_load_dword v43, v60, s[24:27], s53 offen sc1
  s_waitcnt vmcnt(0)
  v_xor_b32 v61, s57, v61
  v_xor_b32 v63, s57, v63
  v_or_b32 v61, v61, v63
  v_xor_b32 v43, s57, v43
  v_or_b32 v61, v61, v43
  v_cmp_ne_u32 vcc, 0, v61
  s_nop 4
  s_sub_u32 s5, s5, 1
  s_cmp_eq_u32 s5, 0
  s_cbranch_scc1 L_fld_101
  s_cmp_eq_u64 vcc, 0
  s_cbranch_scc1 L_fld_101
  s_sleep 2
  s_branch L_fl_100
L_fld_101:
  s_mov_b32 s5, 0x8000
L_zr_102:
  buffer_load_dwordx4 v[216:219], v55, s[24:27], s58 offen sc1
  buffer_load_dwordx4 v[220:223], v55, s[24:27], s58 offen offset:16 sc1
  buffer_load_dwordx4 v[224:227], v55, s[24:27], s7 offen sc1
  buffer_load_dwordx4 v[228:231], v55, s[24:27], s7 offen offset:16 sc1
  buffer_load_dwordx4 v[232:235], v62, s[24:27], s59 offen sc1
  buffer_load_dwordx4 v[236:239], v62, s[24:27], s59 offen offset:16 sc1
  s_waitcnt vmcnt(0)
  v_xor_b32 v40, s57, v217
  v_xor_b32 v41, s57, v219
  v_or_b32 v40, v40, v41
  v_xor_b32 v41, s57, v221
  v_or_b32 v40, v40, v41
  v_xor_b32 v41, s57, v223
  v_or_b32 v40, v40, v41
  v_xor_b32 v41, s57, v225
  v_or_b32 v40, v40, v41
  v_xor_b32 v41, s57, v227
  v_or_b32 v40, v40, v41
  v_xor_b32 v41, s57, v229
  v_or_b32 v40, v40, v41
  v_xor_b32 v41, s57, v231
  v_or_b32 v40, v40, v41
  s_cmp_lg_u32 s44, 0
  s_cbranch_scc1 L_zrd_103x
  v_xor_b32 v41, s57, v233
  v_or_b32 v40, v40, v41
  v_xor_b32 v41, s57, v235
  v_or_b32 v40, v40, v41
  v_xor_b32 v41, s57, v237
  v_or_b32 v40, v40, v41
  v_xor_b32 v41, s57, v239
  v_or_b32 v40, v40, v41
L_zrd_103x:
  v_cmp_ne_u32 vcc, 0, v40
  s_nop 4
  s_cmp_eq_u64 vcc, 0
  s_cbranch_scc1 L_zrd_103
  s_sub_u32 s5, s5, 1
  s_cmp_eq_u32 s5, 0
  s_cbranch_scc1 L_zrd_103
  s_sleep 2
  s_branch L_zr_102
L_zrd_103:
  v_mov_b32 v217, v218
  v_mov_b32 v218, v220
  v_mov_b32 v219, v222
  v_mov_b32 v225, v226
  v_mov_b32 v226, v228
  v_mov_b32 v227, v230
  v_mov_b32 v233, v234
  v_mov_b32 v234, v236
  v_mov_b32 v235, v238
  ds_write_b128 v56, v[216:219]
  ds_write_b128 v56, v[224:227] offset:1024
  ds_write_b128 v57, v[232:235]
  s_branch L_finJ
L_finB:
  s_setprio 3
  s_lshl_b32 s54, s45, 7
  s_add_u32 s53, s54, 244523008
  v_lshlrev_b32 v44, 2, v2
  s_mov_b32 s5, 0x20000
L_fl_104:
  buffer_load_dword v45, v44, s[24:27], s53 offen sc1
  s_waitcnt vmcnt(0)
  v_xor_b32 v45, s57, v45
  v_cmp_ne_u32 vcc, 0, v45
  s_nop 4
  s_sub_u32 s5, s5, 1
  s_cmp_eq_u32 s5, 0
  s_cbranch_scc1 L_fld_105
  s_cmp_eq_u64 vcc, 0
  s_cbranch_scc1 L_fld_105
  s_sleep 2
  s_branch L_fl_104
L_fld_105:
  s_mov_b32 s73, 2
  s_cmp_eq_u32 s73, 2
  s_cbranch_scc0 L_pl_106
  buffer_load_dwordx4 v[112:115], v18, s[24:27], s59 offen sc1
  s_add_u32 s59, s59, 1024
L_pl_106:
  s_cmp_eq_u32 s73, 2
  s_cbranch_scc0 L_pl_107
  buffer_load_dwordx4 v[116:119], v18, s[24:27], s59 offen sc1
  s_add_u32 s59, s59, 1024
L_pl_107:
  s_cmp_eq_u32 s73, 2
  s_cbranch_scc0 L_pl_108
  buffer_load_dwordx4 v[120:123], v18, s[24:27], s59 offen sc1
  s_add_u32 s59, s59, 1024
L_pl_108:
  s_cmp_eq_u32 s73, 2
  s_cbranch_scc0 L_pl_109
  buffer_load_dwordx4 v[124:127], v18, s[24:27], s59 offen sc1
  s_add_u32 s59, s59, 1024
L_pl_109:
  s_cmp_eq_u32 s73, 2
  s_cbranch_scc0 L_pl_110
  buffer_load_dwordx4 v[128:131], v18, s[24:27], s59 offen sc1
  s_add_u32 s59, s59, 1024
L_pl_110:
  s_cmp_eq_u32 s73, 2
  s_cbranch_scc0 L_pl_111
  buffer_load_dwordx4 v[132:135], v18, s[24:27], s59 offen sc1
  s_add_u32 s59, s59, 1024
L_pl_111:
  s_cmp_eq_u32 s73, 2
  s_cbranch_scc0 L_pl_112
  buffer_load_dwordx4 v[136:139], v18, s[24:27], s59 offen sc1
  s_add_u32 s59, s59, 1024
L_pl_112:
  s_cmp_eq_u32 s73, 2
  s_cbranch_scc0 L_pl_113
  buffer_load_dwordx4 v[140:143], v18, s[24:27], s59 offen sc1
  s_add_u32 s59, s59, 1024
L_pl_113:
  s_cmp_eq_u32 s73, 2
  s_cbranch_scc0 L_pl_114
  buffer_load_dwordx4 v[144:147], v18, s[24:27], s59 offen sc1
  s_add_u32 s59, s59, 1024
L_pl_114:
  s_cmp_eq_u32 s73, 2
  s_cbranch_scc0 L_pl_115
  buffer_load_dwordx4 v[148:151], v18, s[24:27], s59 offen sc1
  s_add_u32 s59, s59, 1024
L_pl_115:
  s_cmp_eq_u32 s73, 2
  s_cbranch_scc0 L_pl_116
  buffer_load_dwordx4 v[152:155], v18, s[24:27], s59 offen sc1
  s_add_u32 s59, s59, 1024
L_pl_116:
  s_cmp_eq_u32 s73, 2
  s_cbranch_scc0 L_pl_117
  buffer_load_dwordx4 v[156:159], v18, s[24:27], s59 offen sc1
  s_add_u32 s59, s59, 1024
L_pl_117:
  s_cmp_eq_u32 s73, 2
  s_cbranch_scc0 L_pl_118
  buffer_load_dwordx4 v[160:163], v18, s[24:27], s59 offen sc1
  s_add_u32 s59, s59, 1024
L_pl_118:
  s_cmp_eq_u32 s73, 2
  s_cbranch_scc0 L_pl_119
  buffer_load_dwordx4 v[164:167], v18, s[24:27], s59 offen sc1
  s_add_u32 s59, s59, 1024
L_pl_119:
  s_cmp_eq_u32 s73, 2
  s_cbranch_scc0 L_pl_120
  buffer_load_dwordx4 v[168:171], v18, s[24:27], s59 offen sc1
  s_add_u32 s59, s59, 1024
L_pl_120:
  s_cmp_eq_u32 s73, 2
  s_cbranch_scc0 L_pl_121
  buffer_load_dwordx4 v[172:175], v18, s[24:27], s59 offen sc1
  s_add_u32 s59, s59, 1024
L_pl_121:
  s_lshl_b32 s53, s45, 4
  s_add_u32 s53, s53, s46
  s_mul_i32 s53, s53, 147456
  s_lshl_b32 s54, s44, 11
  s_add_u32 s53, s53, s54
  s_add_u32 s53, s53, 201457664
  buffer_load_dwordx4 v[176:179], v18, s[24:27], s53 offen sc1
  s_add_u32 s53, s53, 1024
  buffer_load_dwordx4 v[180:183], v18, s[24:27], s53 offen sc1
  s_setprio 0
  v_mov_b32 v44, 0x3f80
  v_mov_b32 v45, 0x3f800000
  v_mov_b32 v200, 0
  v_mov_b32 v208, 0
  v_mov_b32 v201, 0
  v_mov_b32 v209, 0
  v_mov_b32 v202, 0
  v_mov_b32 v210, 0
  v_mov_b32 v203, 0
  v_mov_b32 v211, 0
  v_mov_b32 v204, 0
  v_mov_b32 v212, 0
  v_mov_b32 v205, 0
  v_mov_b32 v213, 0
  v_mov_b32 v206, 0
  v_mov_b32 v214, 0
  v_mov_b32 v207, 0
  v_mov_b32 v215, 0
  s_waitcnt vmcnt(17)
  v_dot2_f32_bf16 v200, v112, v44, v200
  v_dot2_f32_bf16 v201, v112, v45, v201
  v_dot2_f32_bf16 v202, v113, v44, v202
  v_dot2_f32_bf16 v203, v113, v45, v203
  v_dot2_f32_bf16 v204, v114, v44, v204
  v_dot2_f32_bf16 v205, v114, v45, v205
  v_dot2_f32_bf16 v206, v115, v44, v206
  v_dot2_f32_bf16 v207, v115, v45, v207
  s_waitcnt vmcnt(16)
  v_dot2_f32_bf16 v200, v116, v44, v200
  v_dot2_f32_bf16 v201, v116, v45, v201
  v_dot2_f32_bf16 v202, v117, v44, v202
  v_dot2_f32_bf16 v203, v117, v45, v203
  v_dot2_f32_bf16 v204, v118, v44, v204
  v_dot2_f32_bf16 v205, v118, v45, v205
  v_dot2_f32_bf16 v206, v119, v44, v206
  v_dot2_f32_bf16 v207, v119, v45, v207
  s_waitcnt vmcnt(15)
  v_dot2_f32_bf16 v200, v120, v44, v200
  v_dot2_f32_bf16 v201, v120, v45, v201
  v_dot2_f32_bf16 v202, v121, v44, v202
  v_dot2_f32_bf16 v203, v121, v45, v203
  v_dot2_f32_bf16 v204, v122, v44, v204
  v_dot2_f32_bf16 v205, v122, v45, v205
  v_dot2_f32_bf16 v206, v123, v44, v206
  v_dot2_f32_bf16 v207, v123, v45, v207
  s_waitcnt vmcnt(14)
  v_dot2_f32_bf16 v200, v124, v44, v200
  v_dot2_f32_bf16 v201, v124, v45, v201
  v_dot2_f32_bf16 v202, v125, v44, v202
  v_dot2_f32_bf16 v203, v125, v45, v203
  v_dot2_f32_bf16 v204, v126, v44, v204
  v_dot2_f32_bf16 v205, v126, v45, v205
  v_dot2_f32_bf16 v206, v127, v44, v206
  v_dot2_f32_bf16 v207, v127, v45, v207
  s_waitcnt vmcnt(13)
  v_dot2_f32_bf16 v200, v128, v44, v200
  v_dot2_f32_bf16 v201, v128, v45, v201
  v_dot2_f32_bf16 v202, v129, v44, v202
  v_dot2_f32_bf16 v203, v129, v45, v203
  v_dot2_f32_bf16 v204, v130, v44, v204
  v_dot2_f32_bf16 v205, v130, v45, v205
  v_dot2_f32_bf16 v206, v131, v44, v206
  v_dot2_f32_bf16 v207, v131, v45, v207
  s_waitcnt vmcnt(12)
  v_dot2_f32_bf16 v200, v132, v44, v200
  v_dot2_f32_bf16 v201, v132, v45, v201
  v_dot2_f32_bf16 v202, v133, v44, v202
  v_dot2_f32_bf16 v203, v133, v45, v203
  v_dot2_f32_bf16 v204, v134, v44, v204
  v_dot2_f32_bf16 v205, v134, v45, v205
  v_dot2_f32_bf16 v206, v135, v44, v206
  v_dot2_f32_bf16 v207, v135, v45, v207
  s_waitcnt vmcnt(11)
  v_dot2_f32_bf16 v200, v136, v44, v200
  v_dot2_f32_bf16 v201, v136, v45, v201
  v_dot2_f32_bf16 v202, v137, v44, v202
  v_dot2_f32_bf16 v203, v137, v45, v203
  v_dot2_f32_bf16 v204, v138, v44, v204
  v_dot2_f32_bf16 v205, v138, v45, v205
  v_dot2_f32_bf16 v206, v139, v44, v206
  v_dot2_f32_bf16 v207, v139, v45, v207
  s_waitcnt vmcnt(10)
  v_dot2_f32_bf16 v200, v140, v44, v200
  v_dot2_f32_bf16 v201, v140, v45, v201
  v_dot2_f32_bf16 v202, v141, v44, v202
  v_dot2_f32_bf16 v203, v141, v45, v203
  v_dot2_f32_bf16 v204, v142, v44, v204
  v_dot2_f32_bf16 v205, v142, v45, v205
  v_dot2_f32_bf16 v206, v143, v44, v206
  v_dot2_f32_bf16 v207, v143, v45, v207
  s_waitcnt vmcnt(9)
  v_dot2_f32_bf16 v200, v144, v44, v200
  v_dot2_f32_bf16 v201, v144, v45, v201
  v_dot2_f32_bf16 v202, v145, v44, v202
  v_dot2_f32_bf16 v203, v145, v45, v203
  v_dot2_f32_bf16 v204, v146, v44, v204
  v_dot2_f32_bf16 v205, v146, v45, v205
  v_dot2_f32_bf16 v206, v147, v44, v206
  v_dot2_f32_bf16 v207, v147, v45, v207
  s_waitcnt vmcnt(8)
  v_dot2_f32_bf16 v200, v148, v44, v200
  v_dot2_f32_bf16 v201, v148, v45, v201
  v_dot2_f32_bf16 v202, v149, v44, v202
  v_dot2_f32_bf16 v203, v149, v45, v203
  v_dot2_f32_bf16 v204, v150, v44, v204
  v_dot2_f32_bf16 v205, v150, v45, v205
  v_dot2_f32_bf16 v206, v151, v44, v206
  v_dot2_f32_bf16 v207, v151, v45, v207
  s_waitcnt vmcnt(7)
  v_dot2_f32_bf16 v200, v152, v44, v200
  v_dot2_f32_bf16 v201, v152, v45, v201
  v_dot2_f32_bf16 v202, v153, v44, v202
  v_dot2_f32_bf16 v203, v153, v45, v203
  v_dot2_f32_bf16 v204, v154, v44, v204
  v_dot2_f32_bf16 v205, v154, v45, v205
  v_dot2_f32_bf16 v206, v155, v44, v206
  v_dot2_f32_bf16 v207, v155, v45, v207
  s_waitcnt vmcnt(6)
  v_dot2_f32_bf16 v200, v156, v44, v200
  v_dot2_f32_bf16 v201, v156, v45, v201
  v_dot2_f32_bf16 v202, v157, v44, v202
  v_dot2_f32_bf16 v203, v157, v45, v203
  v_dot2_f32_bf16 v204, v158, v44, v204
  v_dot2_f32_bf16 v205, v158, v45, v205
  v_dot2_f32_bf16 v206, v159, v44, v206
  v_dot2_f32_bf16 v207, v159, v45, v207
  s_waitcnt vmcnt(5)
  v_dot2_f32_bf16 v200, v160, v44, v200
  v_dot2_f32_bf16 v201, v160, v45, v201
  v_dot2_f32_bf16 v202, v161, v44, v202
  v_dot2_f32_bf16 v203, v161, v45, v203
  v_dot2_f32_bf16 v204, v162, v44, v204
  v_dot2_f32_bf16 v205, v162, v45, v205
  v_dot2_f32_bf16 v206, v163, v44, v206
  v_dot2_f32_bf16 v207, v163, v45, v207
  s_waitcnt vmcnt(4)
  v_dot2_f32_bf16 v200, v164, v44, v200
  v_dot2_f32_bf16 v201, v164, v45, v201
  v_dot2_f32_bf16 v202, v165, v44, v202
  v_dot2_f32_bf16 v203, v165, v45, v203
  v_dot2_f32_bf16 v204, v166, v44, v204
  v_dot2_f32_bf16 v205, v166, v45, v205
  v_dot2_f32_bf16 v206, v167, v44, v206
  v_dot2_f32_bf16 v207, v167, v45, v207
  s_waitcnt vmcnt(3)
  v_dot2_f32_bf16 v200, v168, v44, v200
  v_dot2_f32_bf16 v201, v168, v45, v201
  v_dot2_f32_bf16 v202, v169, v44, v202
  v_dot2_f32_bf16 v203, v169, v45, v203
  v_dot2_f32_bf16 v204, v170, v44, v204
  v_dot2_f32_bf16 v205, v170, v45, v205
  v_dot2_f32_bf16 v206, v171, v44, v206
  v_dot2_f32_bf16 v207, v171, v45, v207
  s_waitcnt vmcnt(2)
  v_dot2_f32_bf16 v200, v172, v44, v200
  v_dot2_f32_bf16 v201, v172, v45, v201
  v_dot2_f32_bf16 v202, v173, v44, v202
  v_dot2_f32_bf16 v203, v173, v45, v203
  v_dot2_f32_bf16 v204, v174, v44, v204
  v_dot2_f32_bf16 v205, v174, v45, v205
  v_dot2_f32_bf16 v206, v175, v44, v206
  v_dot2_f32_bf16 v207, v175, v45, v207
  s_waitcnt vmcnt(0)
  v_dot2_f32_bf16 v208, v176, v44, v208
  v_dot2_f32_bf16 v209, v176, v45, v209
  v_dot2_f32_bf16 v210, v177, v44, v210
  v_dot2_f32_bf16 v211, v177, v45, v211
  v_dot2_f32_bf16 v212, v178, v44, v212
  v_dot2_f32_bf16 v213, v178, v45, v213
  v_dot2_f32_bf16 v214, v179, v44, v214
  v_dot2_f32_bf16 v215, v179, v45, v215
  v_dot2_f32_bf16 v208, v180, v44, v208
  v_dot2_f32_bf16 v209, v180, v45, v209
  v_dot2_f32_bf16 v210, v181, v44, v210
  v_dot2_f32_bf16 v211, v181, v45, v211
  v_dot2_f32_bf16 v212, v182, v44, v212
  v_dot2_f32_bf16 v213, v182, v45, v213
  v_dot2_f32_bf16 v214, v183, v44, v214
  v_dot2_f32_bf16 v215, v183, v45, v215
  v_lshlrev_b32 v46, 5, v1
  s_lshl_b32 s54, s44, 11
  v_add_u32 v46, s54, v46
  v_add_u32 v46, 0, v46
  ds_write_b128 v46, v[208:211]
  ds_write_b128 v46, v[212:215] offset:16
L_finJ:
  v_bfe_u32 v50, v1, 2, 2
  v_lshlrev_b32 v51, 4, v3
  v_add_u32 v50, v50, v51
  v_bfe_u32 v51, v1, 1, 1
  v_lshlrev_b32 v51, 3, v51
  v_add_u32 v50, v50, v51
  v_lshlrev_b32 v50, 4, v50
  v_and_b32 v51, 1, v1
  v_lshlrev_b32 v51, 3, v51
  v_add_u32 v50, v50, v51
  v_add_u32 v51, s47, v50
  v_add_u32 v51, 33280, v51
  v_add_u32 v52, 41472, v50
  v_lshlrev_b32 v46, 5, v1
  v_add_u32 v46, 0, v46
  s_waitcnt lgkmcnt(0)
  s_barrier
  ds_read_b64_tr_b16 v[216:217], v51
  ds_read_b64_tr_b16 v[218:219], v51 offset:64
  ds_read_b64_tr_b16 v[220:221], v52
  ds_read_b64_tr_b16 v[222:223], v52 offset:64
  ds_read_b128 v[112:115], v46 offset:0
  ds_read_b128 v[116:119], v46 offset:16
  ds_read_b128 v[120:123], v46 offset:2048
  ds_read_b128 v[124:127], v46 offset:2064
  ds_read_b128 v[128:131], v46 offset:4096
  ds_read_b128 v[132:135], v46 offset:4112
  ds_read_b128 v[136:139], v46 offset:6144
  ds_read_b128 v[140:143], v46 offset:6160
  ds_read_b128 v[144:147], v46 offset:8192
  ds_read_b128 v[148:151], v46 offset:8208
  ds_read_b128 v[152:155], v46 offset:10240
  ds_read_b128 v[156:159], v46 offset:10256
  ds_read_b128 v[160:163], v46 offset:12288
  ds_read_b128 v[164:167], v46 offset:12304
  ds_read_b128 v[168:171], v46 offset:14336
  ds_read_b128 v[172:175], v46 offset:14352
  v_lshlrev_b32 v56, 16, v240
  v_and_b32 v57, 0xffff0000, v240
  v_lshlrev_b32 v58, 16, v248
  v_and_b32 v59, 0xffff0000, v248
  s_waitcnt lgkmcnt(15)
  v_lshlrev_b32 v60, 16, v216
  v_and_b32 v61, 0xffff0000, v216
  v_fmac_f32 v56, v58, v60
  v_fmac_f32 v57, v59, v61
  v_add_f32 v56, v56, v200
  v_add_f32 v57, v57, v201
  v_cvt_pk_bf16_f32 v64, v56, v57
  v_lshlrev_b32 v56, 16, v241
  v_and_b32 v57, 0xffff0000, v241
  v_lshlrev_b32 v58, 16, v249
  v_and_b32 v59, 0xffff0000, v249
  v_lshlrev_b32 v60, 16, v217
  v_and_b32 v61, 0xffff0000, v217
  v_fmac_f32 v56, v58, v60
  v_fmac_f32 v57, v59, v61
  v_add_f32 v56, v56, v202
  v_add_f32 v57, v57, v203
  v_cvt_pk_bf16_f32 v65, v56, v57
  v_lshlrev_b32 v56, 16, v242
  v_and_b32 v57, 0xffff0000, v242
  v_lshlrev_b32 v58, 16, v250
  v_and_b32 v59, 0xffff0000, v250
  v_lshlrev_b32 v60, 16, v218
  v_and_b32 v61, 0xffff0000, v218
  v_fmac_f32 v56, v58, v60
  v_fmac_f32 v57, v59, v61
  v_add_f32 v56, v56, v204
  v_add_f32 v57, v57, v205
  v_cvt_pk_bf16_f32 v66, v56, v57
  v_lshlrev_b32 v56, 16, v243
  v_and_b32 v57, 0xffff0000, v243
  v_lshlrev_b32 v58, 16, v251
  v_and_b32 v59, 0xffff0000, v251
  v_lshlrev_b32 v60, 16, v219
  v_and_b32 v61, 0xffff0000, v219
  v_fmac_f32 v56, v58, v60
  v_fmac_f32 v57, v59, v61
  v_add_f32 v56, v56, v206
  v_add_f32 v57, v57, v207
  v_cvt_pk_bf16_f32 v67, v56, v57
  s_lshl_b32 s54, s44, 7
  buffer_store_dwordx4 v[64:67], v15, s[32:35], s54 offen
  s_cmp_lg_u32 s44, 0
  s_cbranch_scc1 L_finE
  s_waitcnt lgkmcnt(13)
  v_pk_add_f32 v[112:113], v[112:113], v[120:121]
  v_pk_add_f32 v[114:115], v[114:115], v[122:123]
  s_waitcnt lgkmcnt(12)
  v_pk_add_f32 v[116:117], v[116:117], v[124:125]
  v_pk_add_f32 v[118:119], v[118:119], v[126:127]
  s_waitcnt lgkmcnt(11)
  v_pk_add_f32 v[112:113], v[112:113], v[128:129]
  v_pk_add_f32 v[114:115], v[114:115], v[130:131]
  s_waitcnt lgkmcnt(10)
  v_pk_add_f32 v[116:117], v[116:117], v[132:133]
  v_pk_add_f32 v[118:119], v[118:119], v[134:135]
  s_waitcnt lgkmcnt(9)
  v_pk_add_f32 v[112:113], v[112:113], v[136:137]
  v_pk_add_f32 v[114:115], v[114:115], v[138:139]
  s_waitcnt lgkmcnt(8)
  v_pk_add_f32 v[116:117], v[116:117], v[140:141]
  v_pk_add_f32 v[118:119], v[118:119], v[142:143]
  s_waitcnt lgkmcnt(7)
  v_pk_add_f32 v[112:113], v[112:113], v[144:145]
  v_pk_add_f32 v[114:115], v[114:115], v[146:147]
  s_waitcnt lgkmcnt(6)
  v_pk_add_f32 v[116:117], v[116:117], v[148:149]
  v_pk_add_f32 v[118:119], v[118:119], v[150:151]
  s_waitcnt lgkmcnt(5)
  v_pk_add_f32 v[112:113], v[112:113], v[152:153]
  v_pk_add_f32 v[114:115], v[114:115], v[154:155]
  s_waitcnt lgkmcnt(4)
  v_pk_add_f32 v[116:117], v[116:117], v[156:157]
  v_pk_add_f32 v[118:119], v[118:119], v[158:159]
  s_waitcnt lgkmcnt(3)
  v_pk_add_f32 v[112:113], v[112:113], v[160:161]
  v_pk_add_f32 v[114:115], v[114:115], v[162:163]
  s_waitcnt lgkmcnt(2)
  v_pk_add_f32 v[116:117], v[116:117], v[164:165]
  v_pk_add_f32 v[118:119], v[118:119], v[166:167]
  s_waitcnt lgkmcnt(1)
  v_pk_add_f32 v[112:113], v[112:113], v[168:169]
  v_pk_add_f32 v[114:115], v[114:115], v[170:171]
  s_waitcnt lgkmcnt(0)
  v_pk_add_f32 v[116:117], v[116:117], v[172:173]
  v_pk_add_f32 v[118:119], v[118:119], v[174:175]
  v_lshlrev_b32 v56, 16, v244
  v_and_b32 v57, 0xffff0000, v244
  v_lshlrev_b32 v58, 16, v252
  v_and_b32 v59, 0xffff0000, v252
  v_lshlrev_b32 v60, 16, v220
  v_and_b32 v61, 0xffff0000, v220
  v_fmac_f32 v56, v58, v60
  v_fmac_f32 v57, v59, v61
  v_add_f32 v56, v56, v112
  v_add_f32 v57, v57, v113
  v_cvt_pk_bf16_f32 v68, v56, v57
  v_lshlrev_b32 v56, 16, v245
  v_and_b32 v57, 0xffff0000, v245
  v_lshlrev_b32 v58, 16, v253
  v_and_b32 v59, 0xffff0000, v253
  v_lshlrev_b32 v60, 16, v221
  v_and_b32 v61, 0xffff0000, v221
  v_fmac_f32 v56, v58, v60
  v_fmac_f32 v57, v59, v61
  v_add_f32 v56, v56, v114
  v_add_f32 v57, v57, v115
  v_cvt_pk_bf16_f32 v69, v56, v57
  v_lshlrev_b32 v56, 16, v246
  v_and_b32 v57, 0xffff0000, v246
  v_lshlrev_b32 v58, 16, v254
  v_and_b32 v59, 0xffff0000, v254
  v_lshlrev_b32 v60, 16, v222
  v_and_b32 v61, 0xffff0000, v222
  v_fmac_f32 v56, v58, v60
  v_fmac_f32 v57, v59, v61
  v_add_f32 v56, v56, v116
  v_add_f32 v57, v57, v117
  v_cvt_pk_bf16_f32 v70, v56, v57
  v_lshlrev_b32 v56, 16, v247
  v_and_b32 v57, 0xffff0000, v247
  v_lshlrev_b32 v58, 16, v255
  v_and_b32 v59, 0xffff0000, v255
  v_lshlrev_b32 v60, 16, v223
  v_and_b32 v61, 0xffff0000, v223
  v_fmac_f32 v56, v58, v60
  v_fmac_f32 v57, v59, v61
  v_add_f32 v56, v56, v118
  v_add_f32 v57, v57, v119
  v_cvt_pk_bf16_f32 v71, v56, v57
  buffer_store_dwordx4 v[68:71], v15, s[32:35], 0 offen offset:1024
L_finE:
  s_waitcnt vmcnt(0) lgkmcnt(0)
L_end:
  s_endpgm
.section .rodata,"a"
.p2align 6
.amdhsa_kernel parallel_sum__ssm_conv_h3__glu_gated_geglu__prompt_kernel
  .amdhsa_next_free_vgpr 256
  .amdhsa_next_free_sgpr 102
  .amdhsa_accum_offset 256
  .amdhsa_group_segment_fixed_size 0
  .amdhsa_kernarg_size 104
  .amdhsa_user_sgpr_count 2
  .amdhsa_user_sgpr_kernarg_segment_ptr 1
  .amdhsa_system_sgpr_workgroup_id_x 1
.end_amdhsa_kernel
```
